```python
import torch

def _softmax(x, axis=-1):
    return torch.softmax(x, dim=axis)
def _gelu(x):
    return torch.nn.functional.gelu(x, approximate="tanh")
def _silu(x):
    return torch.nn.functional.silu(x)
def _sigmoid(x):
    return torch.sigmoid(x)
def _layernorm(x, axis=-1, eps=1e-5):
    m = x.mean(dim=axis, keepdim=True)
    v = x.var(dim=axis, keepdim=True, unbiased=False)
    return (x - m) / torch.sqrt(v + eps)
def _scatter_add(tgt, idx, src, axis=0):
    return tgt.clone().index_add_(axis, idx, src)
def _segment_sum(src, seg, n):
    out = torch.zeros((n,) + src.shape[1:], dtype=src.dtype)
    return out.index_add_(0, seg, src)
def _pad(x, pw):
    flat = tuple(v for pair in reversed(pw) for v in pair)
    return torch.nn.functional.pad(x, flat)

kernel_name = 'parallel_sum__mha_block_cached__mixer_channel_mlp__decode'

def setup_inputs():

    _w = (lambda a: (lambda t: t.to(torch.bfloat16) if t.is_floating_point() else t)(torch.as_tensor(a)))
    def _A_setup():
        B, Sq, D = 8, 1, 1024
        H, Sk, Dh = 32, 4096, 128
        return {
            "x": _w((lambda *s: torch.randn(*s, dtype=torch.bfloat16) * 0.05)(B, Sq, D)),
            "k_cache": _w((lambda *s: torch.randn(*s, dtype=torch.bfloat16) * 3.2)(B, H, Sk, Dh)),
            "v_cache": _w((lambda *s: torch.randn(*s, dtype=torch.bfloat16) * 0.4)(B, H, Sk, Dh)),
            "wq": _w((lambda *s: torch.randn(*s, dtype=torch.bfloat16) * 3.2)(D, H * Dh) * (D ** -0.5)),
            "wo": _w((lambda *s: torch.randn(*s, dtype=torch.bfloat16) * 0.4)(H * Dh, D) * ((H * Dh) ** -0.5)),
        }
    _A_in = _A_setup()

    def _B_setup():
        B, S, D, F = 8, 1, 1024, 3584
        return {
            "x": _w((lambda *s: torch.randn(*s, dtype=torch.bfloat16) * 0.05)(B, S, D)),
            "w1": _w((lambda *s: torch.randn(*s, dtype=torch.bfloat16) * 3.2)(D, F) * (D ** -0.5)),
            "b1": _w((lambda *s: torch.randn(*s, dtype=torch.bfloat16) * 1.6)(F)),
            "w2": _w((lambda *s: torch.randn(*s, dtype=torch.bfloat16) * 0.1)(F, D) * (F ** -0.5)),
            "b2": _w((lambda *s: torch.randn(*s, dtype=torch.bfloat16) * 0.1)(D)),
        }
    _B_in = _B_setup()

    return {
        "A_x": _A_in["x"],
        "A_k_cache": _A_in["k_cache"],
        "A_v_cache": _A_in["v_cache"],
        "A_wq": _A_in["wq"],
        "A_wo": _A_in["wo"],
        "B_x": _B_in["x"],
        "B_w1": _B_in["w1"],
        "B_b1": _B_in["b1"],
        "B_w2": _B_in["w2"],
        "B_b2": _B_in["b2"],
    }

def reference(A_x, A_k_cache, A_v_cache, A_wq, A_wo, B_x, B_w1, B_b1, B_w2, B_b2):
    def _A_ref(x, k_cache, v_cache, wq, wo):
        B, Sq, D = x.shape
        H, Dh = 32, 128
        q = (lambda x, *d: x.permute(*d))((x @ wq).reshape(B, Sq, H, Dh), 0, 2, 1, 3)
        scores = torch.einsum("bhqd,bhkd->bhqk", q, k_cache) * (Dh ** -0.5)
        p = _softmax(scores, axis=-1)
        o = torch.einsum("bhqk,bhkd->bhqd", p, v_cache)
        return (lambda x, *d: x.permute(*d))(o, 0, 2, 1, 3).reshape(B, Sq, H * Dh) @ wo

    def _B_ref(x, w1, b1, w2, b2):
        y = _layernorm(x, axis=-1)
        h = _gelu(torch.einsum("bsd,df->bsf", y, w1) + b1)
        return torch.einsum("bsf,fd->bsd", h, w2) + b2

    x = A_x
    xn = _layernorm(x, axis=-1)
    return x + _A_ref(xn, A_k_cache, A_v_cache, A_wq, A_wo) + _B_ref(xn, B_w1, B_b1, B_w2, B_b2)
```

```asm
; @launch grid=(256,1,1) block=(512,1,1) lds=114688
.amdgcn_target "amdgcn-amd-amdhsa--gfx950"
.text
.globl parallel_sum__mha_block_cached__mixer_channel_mlp__decode_kernel
.p2align 8
.type parallel_sum__mha_block_cached__mixer_channel_mlp__decode_kernel,@function
parallel_sum__mha_block_cached__mixer_channel_mlp__decode_kernel:
  s_cmp_ge_u32 s2, 256
  s_cbranch_scc1 L_done
  s_load_dwordx16 s[4:19], s[0:1], 0
  s_load_dwordx8 s[20:27], s[0:1], 64
  s_load_dwordx2 s[28:29], s[0:1], 96
  s_lshr_b32 s72, s2, 3
  s_and_b32 s72, s72, 3
  s_mul_i32 s72, s72, 2
  s_add_u32 s72, s72, s2
  s_and_b32 s72, s72, 7
  s_and_b32 s2, s2, 0xf8
  s_or_b32 s2, s2, s72
  v_and_b32 v1, 63, v0
  v_lshrrev_b32 v16, 6, v0
  v_lshrrev_b32 v2, 4, v1
  v_readfirstlane_b32 s64, v16
  v_and_b32 v3, 15, v1
  v_lshlrev_b32 v4, 4, v1
  v_lshlrev_b32 v5, 5, v1
  v_lshlrev_b32 v6, 3, v1
  v_mov_b32 v7, 0
  v_lshlrev_b32 v15, 4, v3
  v_lshl_add_u32 v13, v2, 13, v15
  s_and_b32 s66, s2, 31
  s_lshr_b32 s65, s2, 5
  s_and_b32 s78, s64, 3
  s_mov_b32 s90, 0x01000100
  s_mov_b32 s91, 0x03020302
  s_mov_b32 s92, 0xffff0000
  s_mov_b32 s80, 0xaaaaaaaa
  s_mov_b32 s81, 0xaaaaaaaa
  s_mov_b32 s82, 0xcccccccc
  s_mov_b32 s83, 0xcccccccc
  s_mov_b32 s79, 0
  s_waitcnt lgkmcnt(0)
  s_mov_b32 s44, s4
  s_mov_b32 s45, s5
  s_mov_b32 s46, 16384
  s_mov_b32 s47, 0x00020000
  s_lshl_b32 s71, s64, 11
  buffer_load_dwordx4 v[24:27], v4, s[44:47], s71 offen
  buffer_load_dwordx4 v[28:31], v4, s[44:47], s71 offen offset:1024
  s_mov_b32 s52, s26
  s_mov_b32 s53, s27
  s_mov_b32 s54, 256
  s_mov_b32 s55, 0x00020000
  s_mov_b32 s48, s28
  s_mov_b32 s49, s29
  s_mov_b32 s50, 6291456
  s_mov_b32 s51, 0x00020000
  s_mov_b32 s43, 0x00020000
  s_cmp_ge_u32 s64, 4
  s_cbranch_scc1 L_aux_pro
  s_lshl_b32 s72, s2, 20
  s_add_u32 s32, s6, s72
  s_addc_u32 s33, s7, 0
  s_mov_b32 s34, 0x100000
  s_mov_b32 s35, 0x00020000
  s_add_u32 s36, s8, s72
  s_addc_u32 s37, s9, 0
  s_mov_b32 s38, 0x100000
  s_mov_b32 s39, 0x00020000
  v_lshl_add_u32 v21, v16, 12, v4
  s_mov_b32 s70, 0
  buffer_load_dwordx4 a[0:3], v21, s[32:35], s70 offen offset:0 nt
  buffer_load_dwordx4 a[4:7], v21, s[32:35], s70 offen offset:1024 nt
  buffer_load_dwordx4 a[8:11], v21, s[32:35], s70 offen offset:2048 nt
  buffer_load_dwordx4 a[12:15], v21, s[32:35], s70 offen offset:3072 nt
  s_add_u32 s70, s70, 16384
  buffer_load_dwordx4 a[16:19], v21, s[32:35], s70 offen offset:0 nt
  buffer_load_dwordx4 a[20:23], v21, s[32:35], s70 offen offset:1024 nt
  buffer_load_dwordx4 a[24:27], v21, s[32:35], s70 offen offset:2048 nt
  buffer_load_dwordx4 a[28:31], v21, s[32:35], s70 offen offset:3072 nt
  s_add_u32 s70, s70, 16384
  s_mov_b32 s60, s24
  s_mov_b32 s61, s25
  s_mov_b32 s62, 16384
  s_mov_b32 s63, 0x00020000
  v_and_b32 v14, 1, v3
  v_lshlrev_b32 v14, 4, v14
  v_mov_b32 v15, 0xffff
  v_lshlrev_b32 v15, v14, v15
  v_bfe_u32 v14, v3, 1, 2
  v_cmp_eq_u32 vcc, 0, v14
  s_nop 1
  v_cndmask_b32 v8, 0, v15, vcc
  v_cmp_eq_u32 vcc, 1, v14
  s_nop 1
  v_cndmask_b32 v9, 0, v15, vcc
  v_cmp_eq_u32 vcc, 2, v14
  s_nop 1
  v_cndmask_b32 v10, 0, v15, vcc
  v_cmp_eq_u32 vcc, 3, v14
  s_nop 1
  v_cndmask_b32 v11, 0, v15, vcc
  v_lshlrev_b32 v14, 4, v2
  v_lshl_add_u32 v20, v16, 9, v14
  v_and_b32 v15, 1, v2
  v_lshlrev_b32 v15, 4, v15
  v_lshl_add_u32 v12, v3, 5, v15
  s_cmp_eq_u32 s64, 0
  s_cbranch_scc0 L_ci_1
  v_mov_b32 v14, 0
  v_mov_b32 v15, 0
  v_mov_b32 v16, 0
  v_mov_b32 v17, 0
  ds_write_b128 v7, v[14:17] offset:31040
  ds_write_b128 v7, v[14:17] offset:31056
L_ci_1:
  v_lshrrev_b32 v16, 6, v0
  v_lshlrev_b32 v14, 4, v2
  v_lshl_add_u32 v22, v16, 12, v14
  v_bfe_u32 v15, v3, 1, 1
  v_lshl_add_u32 v23, v15, 7, v22
  v_and_b32 v15, 1, v3
  v_lshl_add_u32 v23, v15, 6, v23
  v_bfe_u32 v15, v3, 2, 1
  v_lshl_add_u32 v23, v15, 3, v23
  v_lshrrev_b32 v15, 3, v3
  v_lshl_add_u32 v23, v15, 2, v23
  s_lshl_b32 s72, s64, 12
  s_add_u32 s72, s72, 49152
  v_add_u32 v17, s72, v5
  s_waitcnt vmcnt(8)
  v_lshlrev_b32 v32, 16, v24
  v_and_b32 v33, s92, v24
  v_lshlrev_b32 v34, 16, v25
  v_and_b32 v35, s92, v25
  v_lshlrev_b32 v36, 16, v26
  v_and_b32 v37, s92, v26
  v_lshlrev_b32 v38, 16, v27
  v_and_b32 v39, s92, v27
  v_lshlrev_b32 v40, 16, v28
  v_and_b32 v41, s92, v28
  v_lshlrev_b32 v42, 16, v29
  v_and_b32 v43, s92, v29
  v_lshlrev_b32 v44, 16, v30
  v_and_b32 v45, s92, v30
  v_lshlrev_b32 v46, 16, v31
  v_and_b32 v47, s92, v31
  v_add_f32 v48, v32, v33
  v_add_f32 v49, v34, v35
  v_add_f32 v50, v36, v37
  v_add_f32 v51, v38, v39
  v_add_f32 v48, v48, v40
  v_add_f32 v48, v48, v41
  v_add_f32 v49, v49, v42
  v_add_f32 v49, v49, v43
  v_add_f32 v50, v50, v44
  v_add_f32 v50, v50, v45
  v_add_f32 v51, v51, v46
  v_add_f32 v51, v51, v47
  v_add_f32 v48, v48, v49
  v_add_f32 v50, v50, v51
  v_add_f32 v48, v48, v50
  s_nop 1
  v_add_f32_dpp v48, v48, v48 row_ror:8 row_mask:0xf bank_mask:0xf
  s_nop 1
  v_add_f32_dpp v48, v48, v48 row_ror:4 row_mask:0xf bank_mask:0xf
  s_nop 1
  v_add_f32_dpp v48, v48, v48 row_ror:2 row_mask:0xf bank_mask:0xf
  s_nop 1
  v_add_f32_dpp v48, v48, v48 row_ror:1 row_mask:0xf bank_mask:0xf
  s_nop 0
  v_readlane_b32 s86, v48, 0
  v_readlane_b32 s87, v48, 16
  v_readlane_b32 s88, v48, 32
  v_readlane_b32 s89, v48, 48
  s_nop 1
  v_mov_b32 v48, s86
  v_add_f32 v48, s87, v48
  v_add_f32 v48, s88, v48
  v_add_f32 v48, s89, v48
  v_mul_f32 v48, 0x3a800000, v48
  v_cvt_pk_bf16_f32 v49, v48, v48
  v_lshlrev_b32 v49, 16, v49
  v_mov_b32 v50, 0
  v_mov_b32 v51, 0
  v_sub_f32 v52, v32, v48
  v_fmac_f32 v50, v52, v52
  v_sub_f32 v53, v33, v48
  v_fmac_f32 v51, v53, v53
  v_sub_f32 v52, v34, v48
  v_fmac_f32 v50, v52, v52
  v_sub_f32 v53, v35, v48
  v_fmac_f32 v51, v53, v53
  v_sub_f32 v52, v36, v48
  v_fmac_f32 v50, v52, v52
  v_sub_f32 v53, v37, v48
  v_fmac_f32 v51, v53, v53
  v_sub_f32 v52, v38, v48
  v_fmac_f32 v50, v52, v52
  v_sub_f32 v53, v39, v48
  v_fmac_f32 v51, v53, v53
  v_sub_f32 v52, v40, v48
  v_fmac_f32 v50, v52, v52
  v_sub_f32 v53, v41, v48
  v_fmac_f32 v51, v53, v53
  v_sub_f32 v52, v42, v48
  v_fmac_f32 v50, v52, v52
  v_sub_f32 v53, v43, v48
  v_fmac_f32 v51, v53, v53
  v_sub_f32 v52, v44, v48
  v_fmac_f32 v50, v52, v52
  v_sub_f32 v53, v45, v48
  v_fmac_f32 v51, v53, v53
  v_sub_f32 v52, v46, v48
  v_fmac_f32 v50, v52, v52
  v_sub_f32 v53, v47, v48
  v_fmac_f32 v51, v53, v53
  v_add_f32 v50, v50, v51
  s_nop 1
  v_add_f32_dpp v50, v50, v50 row_ror:8 row_mask:0xf bank_mask:0xf
  s_nop 1
  v_add_f32_dpp v50, v50, v50 row_ror:4 row_mask:0xf bank_mask:0xf
  s_nop 1
  v_add_f32_dpp v50, v50, v50 row_ror:2 row_mask:0xf bank_mask:0xf
  s_nop 1
  v_add_f32_dpp v50, v50, v50 row_ror:1 row_mask:0xf bank_mask:0xf
  s_nop 0
  v_readlane_b32 s86, v50, 0
  v_readlane_b32 s87, v50, 16
  v_readlane_b32 s88, v50, 32
  v_readlane_b32 s89, v50, 48
  s_nop 1
  v_mov_b32 v50, s86
  v_add_f32 v50, s87, v50
  v_add_f32 v50, s88, v50
  v_add_f32 v50, s89, v50
  v_mul_f32 v50, 0x3a800000, v50
  v_cvt_pk_bf16_f32 v50, v50, v50
  v_lshlrev_b32 v50, 16, v50
  v_add_f32 v50, 0x3727c5ac, v50
  v_cvt_pk_bf16_f32 v50, v50, v50
  v_lshlrev_b32 v50, 16, v50
  v_sqrt_f32 v50, v50
  s_nop 0
  v_cvt_pk_bf16_f32 v50, v50, v50
  v_lshlrev_b32 v50, 16, v50
  v_rcp_f32 v51, v50
  s_nop 0
  v_sub_f32 v32, v32, v49
  v_sub_f32 v33, v33, v49
  v_cvt_pk_bf16_f32 v52, v32, v33
  v_lshlrev_b32 v32, 16, v52
  v_and_b32 v33, s92, v52
  v_mul_f32 v52, v32, v51
  v_mul_f32 v53, v33, v51
  v_fma_f32 v54, -v52, v50, v32
  v_fma_f32 v55, -v53, v50, v33
  v_fmac_f32 v52, v54, v51
  v_fmac_f32 v53, v55, v51
  v_cvt_pk_bf16_f32 v24, v52, v53
  v_sub_f32 v34, v34, v49
  v_sub_f32 v35, v35, v49
  v_cvt_pk_bf16_f32 v52, v34, v35
  v_lshlrev_b32 v34, 16, v52
  v_and_b32 v35, s92, v52
  v_mul_f32 v52, v34, v51
  v_mul_f32 v53, v35, v51
  v_fma_f32 v54, -v52, v50, v34
  v_fma_f32 v55, -v53, v50, v35
  v_fmac_f32 v52, v54, v51
  v_fmac_f32 v53, v55, v51
  v_cvt_pk_bf16_f32 v25, v52, v53
  v_sub_f32 v36, v36, v49
  v_sub_f32 v37, v37, v49
  v_cvt_pk_bf16_f32 v52, v36, v37
  v_lshlrev_b32 v36, 16, v52
  v_and_b32 v37, s92, v52
  v_mul_f32 v52, v36, v51
  v_mul_f32 v53, v37, v51
  v_fma_f32 v54, -v52, v50, v36
  v_fma_f32 v55, -v53, v50, v37
  v_fmac_f32 v52, v54, v51
  v_fmac_f32 v53, v55, v51
  v_cvt_pk_bf16_f32 v26, v52, v53
  v_sub_f32 v38, v38, v49
  v_sub_f32 v39, v39, v49
  v_cvt_pk_bf16_f32 v52, v38, v39
  v_lshlrev_b32 v38, 16, v52
  v_and_b32 v39, s92, v52
  v_mul_f32 v52, v38, v51
  v_mul_f32 v53, v39, v51
  v_fma_f32 v54, -v52, v50, v38
  v_fma_f32 v55, -v53, v50, v39
  v_fmac_f32 v52, v54, v51
  v_fmac_f32 v53, v55, v51
  v_cvt_pk_bf16_f32 v27, v52, v53
  v_sub_f32 v40, v40, v49
  v_sub_f32 v41, v41, v49
  v_cvt_pk_bf16_f32 v52, v40, v41
  v_lshlrev_b32 v40, 16, v52
  v_and_b32 v41, s92, v52
  v_mul_f32 v52, v40, v51
  v_mul_f32 v53, v41, v51
  v_fma_f32 v54, -v52, v50, v40
  v_fma_f32 v55, -v53, v50, v41
  v_fmac_f32 v52, v54, v51
  v_fmac_f32 v53, v55, v51
  v_cvt_pk_bf16_f32 v28, v52, v53
  v_sub_f32 v42, v42, v49
  v_sub_f32 v43, v43, v49
  v_cvt_pk_bf16_f32 v52, v42, v43
  v_lshlrev_b32 v42, 16, v52
  v_and_b32 v43, s92, v52
  v_mul_f32 v52, v42, v51
  v_mul_f32 v53, v43, v51
  v_fma_f32 v54, -v52, v50, v42
  v_fma_f32 v55, -v53, v50, v43
  v_fmac_f32 v52, v54, v51
  v_fmac_f32 v53, v55, v51
  v_cvt_pk_bf16_f32 v29, v52, v53
  v_sub_f32 v44, v44, v49
  v_sub_f32 v45, v45, v49
  v_cvt_pk_bf16_f32 v52, v44, v45
  v_lshlrev_b32 v44, 16, v52
  v_and_b32 v45, s92, v52
  v_mul_f32 v52, v44, v51
  v_mul_f32 v53, v45, v51
  v_fma_f32 v54, -v52, v50, v44
  v_fma_f32 v55, -v53, v50, v45
  v_fmac_f32 v52, v54, v51
  v_fmac_f32 v53, v55, v51
  v_cvt_pk_bf16_f32 v30, v52, v53
  v_sub_f32 v46, v46, v49
  v_sub_f32 v47, v47, v49
  v_cvt_pk_bf16_f32 v52, v46, v47
  v_lshlrev_b32 v46, 16, v52
  v_and_b32 v47, s92, v52
  v_mul_f32 v52, v46, v51
  v_mul_f32 v53, v47, v51
  v_fma_f32 v54, -v52, v50, v46
  v_fma_f32 v55, -v53, v50, v47
  v_fmac_f32 v52, v54, v51
  v_fmac_f32 v53, v55, v51
  v_cvt_pk_bf16_f32 v31, v52, v53
  v_perm_b32 v32, v24, v24, s90
  v_perm_b32 v33, v24, v24, s91
  v_perm_b32 v34, v25, v25, s90
  v_perm_b32 v35, v25, v25, s91
  v_perm_b32 v36, v26, v26, s90
  v_perm_b32 v37, v26, v26, s91
  v_perm_b32 v38, v27, v27, s90
  v_perm_b32 v39, v27, v27, s91
  v_perm_b32 v40, v28, v28, s90
  v_perm_b32 v41, v28, v28, s91
  v_perm_b32 v42, v29, v29, s90
  v_perm_b32 v43, v29, v29, s91
  v_perm_b32 v44, v30, v30, s90
  v_perm_b32 v45, v30, v30, s91
  v_perm_b32 v46, v31, v31, s90
  v_perm_b32 v47, v31, v31, s91
  ds_write_b128 v17, v[32:35] offset:0
  ds_write_b128 v17, v[36:39] offset:16
  ds_write_b128 v17, v[40:43] offset:2048
  ds_write_b128 v17, v[44:47] offset:2064
  s_waitcnt lgkmcnt(0)
  s_barrier
  s_waitcnt vmcnt(7)
  buffer_load_dwordx4 a[32:35], v21, s[32:35], s70 offen offset:0 nt
  s_waitcnt vmcnt(7)
  buffer_load_dwordx4 a[36:39], v21, s[32:35], s70 offen offset:1024 nt
  s_waitcnt vmcnt(7)
  buffer_load_dwordx4 a[40:43], v21, s[32:35], s70 offen offset:2048 nt
  s_waitcnt vmcnt(7)
  buffer_load_dwordx4 a[44:47], v21, s[32:35], s70 offen offset:3072 nt
  s_add_u32 s70, s70, 16384
  s_waitcnt vmcnt(7)
  buffer_load_dwordx4 a[48:51], v21, s[32:35], s70 offen offset:0 nt
  s_waitcnt vmcnt(7)
  buffer_load_dwordx4 a[52:55], v21, s[32:35], s70 offen offset:1024 nt
  s_waitcnt vmcnt(7)
  buffer_load_dwordx4 a[56:59], v21, s[32:35], s70 offen offset:2048 nt
  s_waitcnt vmcnt(7)
  buffer_load_dwordx4 a[60:63], v21, s[32:35], s70 offen offset:3072 nt
  s_add_u32 s70, s70, 16384
  s_waitcnt vmcnt(7)
  buffer_load_dwordx4 a[64:67], v21, s[32:35], s70 offen offset:0 nt
  s_waitcnt vmcnt(7)
  buffer_load_dwordx4 a[68:71], v21, s[32:35], s70 offen offset:1024 nt
  s_waitcnt vmcnt(7)
  buffer_load_dwordx4 a[72:75], v21, s[32:35], s70 offen offset:2048 nt
  s_waitcnt vmcnt(7)
  buffer_load_dwordx4 a[76:79], v21, s[32:35], s70 offen offset:3072 nt
  s_add_u32 s70, s70, 16384
  s_waitcnt vmcnt(7)
  buffer_load_dwordx4 a[80:83], v21, s[32:35], s70 offen offset:0 nt
  s_waitcnt vmcnt(7)
  buffer_load_dwordx4 a[84:87], v21, s[32:35], s70 offen offset:1024 nt
  s_waitcnt vmcnt(7)
  buffer_load_dwordx4 a[88:91], v21, s[32:35], s70 offen offset:2048 nt
  s_waitcnt vmcnt(7)
  buffer_load_dwordx4 a[92:95], v21, s[32:35], s70 offen offset:3072 nt
  s_add_u32 s70, s70, 16384
  s_waitcnt vmcnt(7)
  buffer_load_dwordx4 a[96:99], v21, s[32:35], s70 offen offset:0 nt
  s_waitcnt vmcnt(7)
  buffer_load_dwordx4 a[100:103], v21, s[32:35], s70 offen offset:1024 nt
  s_waitcnt vmcnt(7)
  buffer_load_dwordx4 a[104:107], v21, s[32:35], s70 offen offset:2048 nt
  s_waitcnt vmcnt(7)
  buffer_load_dwordx4 a[108:111], v21, s[32:35], s70 offen offset:3072 nt
  s_add_u32 s70, s70, 16384
  s_waitcnt vmcnt(7)
  buffer_load_dwordx4 a[112:115], v21, s[32:35], s70 offen offset:0 nt
  s_waitcnt vmcnt(7)
  buffer_load_dwordx4 a[116:119], v21, s[32:35], s70 offen offset:1024 nt
  s_waitcnt vmcnt(7)
  buffer_load_dwordx4 a[120:123], v21, s[32:35], s70 offen offset:2048 nt
  s_waitcnt vmcnt(7)
  buffer_load_dwordx4 a[124:127], v21, s[32:35], s70 offen offset:3072 nt
  s_add_u32 s70, s70, 16384
  s_waitcnt vmcnt(7)
  buffer_load_dwordx4 v[64:67], v21, s[32:35], s70 offen offset:0 nt
  s_waitcnt vmcnt(7)
  buffer_load_dwordx4 v[68:71], v21, s[32:35], s70 offen offset:1024 nt
  s_waitcnt vmcnt(7)
  buffer_load_dwordx4 v[72:75], v21, s[32:35], s70 offen offset:2048 nt
  s_waitcnt vmcnt(7)
  buffer_load_dwordx4 v[76:79], v21, s[32:35], s70 offen offset:3072 nt
  s_add_u32 s70, s70, 16384
  s_waitcnt vmcnt(7)
  buffer_load_dwordx4 v[80:83], v21, s[32:35], s70 offen offset:0 nt
  s_waitcnt vmcnt(7)
  buffer_load_dwordx4 v[84:87], v21, s[32:35], s70 offen offset:1024 nt
  s_waitcnt vmcnt(7)
  buffer_load_dwordx4 v[88:91], v21, s[32:35], s70 offen offset:2048 nt
  s_waitcnt vmcnt(7)
  buffer_load_dwordx4 v[92:95], v21, s[32:35], s70 offen offset:3072 nt
  s_add_u32 s70, s70, 16384
  s_waitcnt vmcnt(7)
  buffer_load_dwordx4 v[96:99], v21, s[32:35], s70 offen offset:0 nt
  s_waitcnt vmcnt(7)
  buffer_load_dwordx4 v[100:103], v21, s[32:35], s70 offen offset:1024 nt
  s_waitcnt vmcnt(7)
  buffer_load_dwordx4 v[104:107], v21, s[32:35], s70 offen offset:2048 nt
  s_waitcnt vmcnt(7)
  buffer_load_dwordx4 v[108:111], v21, s[32:35], s70 offen offset:3072 nt
  s_add_u32 s70, s70, 16384
  s_waitcnt vmcnt(7)
  buffer_load_dwordx4 v[112:115], v21, s[32:35], s70 offen offset:0 nt
  s_waitcnt vmcnt(7)
  buffer_load_dwordx4 v[116:119], v21, s[32:35], s70 offen offset:1024 nt
  s_waitcnt vmcnt(7)
  buffer_load_dwordx4 v[120:123], v21, s[32:35], s70 offen offset:2048 nt
  s_waitcnt vmcnt(7)
  buffer_load_dwordx4 v[124:127], v21, s[32:35], s70 offen offset:3072 nt
  s_add_u32 s70, s70, 16384
L_lspin_2:
  ds_read_b32 v19, v7 offset:31048
  s_waitcnt lgkmcnt(0)
  v_readfirstlane_b32 s72, v19
  s_nop 0
  s_cmp_ge_u32 s72, 1
  s_cbranch_scc1 L_lspin_2_ok
  s_sleep 2
  s_branch L_lspin_2
L_lspin_2_ok:
  v_lshlrev_b32 v14, 4, v3
  ds_read_b128 v[24:27], v14 offset:30720
  v_mov_b32 v63, 0xff800000
  s_waitcnt lgkmcnt(0)
  v_accvgpr_read_b32 v48, a0
  v_accvgpr_read_b32 v49, a1
  v_accvgpr_read_b32 v50, a2
  v_accvgpr_read_b32 v51, a3
  v_dot2_f32_bf16 v32, v48, v24, 0
  v_dot2_f32_bf16 v32, v49, v25, v32
  v_dot2_f32_bf16 v32, v50, v26, v32
  v_dot2_f32_bf16 v32, v51, v27, v32
  v_accvgpr_read_b32 v52, a4
  v_accvgpr_read_b32 v53, a5
  v_accvgpr_read_b32 v54, a6
  v_accvgpr_read_b32 v55, a7
  v_dot2_f32_bf16 v33, v52, v24, 0
  v_dot2_f32_bf16 v33, v53, v25, v33
  v_dot2_f32_bf16 v33, v54, v26, v33
  v_dot2_f32_bf16 v33, v55, v27, v33
  v_accvgpr_read_b32 v48, a8
  v_accvgpr_read_b32 v49, a9
  v_accvgpr_read_b32 v50, a10
  v_accvgpr_read_b32 v51, a11
  v_dot2_f32_bf16 v34, v48, v24, 0
  v_dot2_f32_bf16 v34, v49, v25, v34
  v_dot2_f32_bf16 v34, v50, v26, v34
  v_dot2_f32_bf16 v34, v51, v27, v34
  v_accvgpr_read_b32 v52, a12
  v_accvgpr_read_b32 v53, a13
  v_accvgpr_read_b32 v54, a14
  v_accvgpr_read_b32 v55, a15
  v_dot2_f32_bf16 v35, v52, v24, 0
  v_dot2_f32_bf16 v35, v53, v25, v35
  v_dot2_f32_bf16 v35, v54, v26, v35
  v_dot2_f32_bf16 v35, v55, v27, v35
  v_accvgpr_read_b32 v48, a16
  v_accvgpr_read_b32 v49, a17
  v_accvgpr_read_b32 v50, a18
  v_accvgpr_read_b32 v51, a19
  v_dot2_f32_bf16 v36, v48, v24, 0
  v_dot2_f32_bf16 v36, v49, v25, v36
  v_dot2_f32_bf16 v36, v50, v26, v36
  v_dot2_f32_bf16 v36, v51, v27, v36
  v_accvgpr_read_b32 v52, a20
  v_accvgpr_read_b32 v53, a21
  v_accvgpr_read_b32 v54, a22
  v_accvgpr_read_b32 v55, a23
  v_dot2_f32_bf16 v37, v52, v24, 0
  v_dot2_f32_bf16 v37, v53, v25, v37
  v_dot2_f32_bf16 v37, v54, v26, v37
  v_dot2_f32_bf16 v37, v55, v27, v37
  v_accvgpr_read_b32 v48, a24
  v_accvgpr_read_b32 v49, a25
  v_accvgpr_read_b32 v50, a26
  v_accvgpr_read_b32 v51, a27
  v_dot2_f32_bf16 v38, v48, v24, 0
  v_dot2_f32_bf16 v38, v49, v25, v38
  v_dot2_f32_bf16 v38, v50, v26, v38
  v_dot2_f32_bf16 v38, v51, v27, v38
  v_accvgpr_read_b32 v52, a28
  v_accvgpr_read_b32 v53, a29
  v_accvgpr_read_b32 v54, a30
  v_accvgpr_read_b32 v55, a31
  v_dot2_f32_bf16 v39, v52, v24, 0
  v_dot2_f32_bf16 v39, v53, v25, v39
  v_dot2_f32_bf16 v39, v54, v26, v39
  v_dot2_f32_bf16 v39, v55, v27, v39
  v_accvgpr_read_b32 v48, a32
  v_accvgpr_read_b32 v49, a33
  v_accvgpr_read_b32 v50, a34
  v_accvgpr_read_b32 v51, a35
  v_dot2_f32_bf16 v40, v48, v24, 0
  v_dot2_f32_bf16 v40, v49, v25, v40
  v_dot2_f32_bf16 v40, v50, v26, v40
  v_dot2_f32_bf16 v40, v51, v27, v40
  v_accvgpr_read_b32 v52, a36
  v_accvgpr_read_b32 v53, a37
  v_accvgpr_read_b32 v54, a38
  v_accvgpr_read_b32 v55, a39
  v_dot2_f32_bf16 v41, v52, v24, 0
  v_dot2_f32_bf16 v41, v53, v25, v41
  v_dot2_f32_bf16 v41, v54, v26, v41
  v_dot2_f32_bf16 v41, v55, v27, v41
  v_accvgpr_read_b32 v48, a40
  v_accvgpr_read_b32 v49, a41
  v_accvgpr_read_b32 v50, a42
  v_accvgpr_read_b32 v51, a43
  v_dot2_f32_bf16 v42, v48, v24, 0
  v_dot2_f32_bf16 v42, v49, v25, v42
  v_dot2_f32_bf16 v42, v50, v26, v42
  v_dot2_f32_bf16 v42, v51, v27, v42
  v_accvgpr_read_b32 v52, a44
  v_accvgpr_read_b32 v53, a45
  v_accvgpr_read_b32 v54, a46
  v_accvgpr_read_b32 v55, a47
  v_dot2_f32_bf16 v43, v52, v24, 0
  v_dot2_f32_bf16 v43, v53, v25, v43
  v_dot2_f32_bf16 v43, v54, v26, v43
  v_dot2_f32_bf16 v43, v55, v27, v43
  v_accvgpr_read_b32 v48, a48
  v_accvgpr_read_b32 v49, a49
  v_accvgpr_read_b32 v50, a50
  v_accvgpr_read_b32 v51, a51
  v_dot2_f32_bf16 v44, v48, v24, 0
  v_dot2_f32_bf16 v44, v49, v25, v44
  v_dot2_f32_bf16 v44, v50, v26, v44
  v_dot2_f32_bf16 v44, v51, v27, v44
  v_accvgpr_read_b32 v52, a52
  v_accvgpr_read_b32 v53, a53
  v_accvgpr_read_b32 v54, a54
  v_accvgpr_read_b32 v55, a55
  v_dot2_f32_bf16 v45, v52, v24, 0
  v_dot2_f32_bf16 v45, v53, v25, v45
  v_dot2_f32_bf16 v45, v54, v26, v45
  v_dot2_f32_bf16 v45, v55, v27, v45
  v_accvgpr_read_b32 v48, a56
  v_accvgpr_read_b32 v49, a57
  v_accvgpr_read_b32 v50, a58
  v_accvgpr_read_b32 v51, a59
  v_dot2_f32_bf16 v46, v48, v24, 0
  v_dot2_f32_bf16 v46, v49, v25, v46
  v_dot2_f32_bf16 v46, v50, v26, v46
  v_dot2_f32_bf16 v46, v51, v27, v46
  v_accvgpr_read_b32 v52, a60
  v_accvgpr_read_b32 v53, a61
  v_accvgpr_read_b32 v54, a62
  v_accvgpr_read_b32 v55, a63
  v_dot2_f32_bf16 v47, v52, v24, 0
  v_dot2_f32_bf16 v47, v53, v25, v47
  v_dot2_f32_bf16 v47, v54, v26, v47
  v_dot2_f32_bf16 v47, v55, v27, v47
  s_nop 2
  v_add_f32_dpp v32, v32, v32 row_ror:8 row_mask:0xf bank_mask:0x3
  v_add_f32_dpp v32, v33, v33 row_ror:8 row_mask:0xf bank_mask:0xc
  v_add_f32_dpp v34, v34, v34 row_ror:8 row_mask:0xf bank_mask:0x3
  v_add_f32_dpp v34, v35, v35 row_ror:8 row_mask:0xf bank_mask:0xc
  v_add_f32_dpp v36, v36, v36 row_ror:8 row_mask:0xf bank_mask:0x3
  v_add_f32_dpp v36, v37, v37 row_ror:8 row_mask:0xf bank_mask:0xc
  v_add_f32_dpp v38, v38, v38 row_ror:8 row_mask:0xf bank_mask:0x3
  v_add_f32_dpp v38, v39, v39 row_ror:8 row_mask:0xf bank_mask:0xc
  v_add_f32_dpp v40, v40, v40 row_ror:8 row_mask:0xf bank_mask:0x3
  v_add_f32_dpp v40, v41, v41 row_ror:8 row_mask:0xf bank_mask:0xc
  v_add_f32_dpp v42, v42, v42 row_ror:8 row_mask:0xf bank_mask:0x3
  v_add_f32_dpp v42, v43, v43 row_ror:8 row_mask:0xf bank_mask:0xc
  v_add_f32_dpp v44, v44, v44 row_ror:8 row_mask:0xf bank_mask:0x3
  v_add_f32_dpp v44, v45, v45 row_ror:8 row_mask:0xf bank_mask:0xc
  v_add_f32_dpp v46, v46, v46 row_ror:8 row_mask:0xf bank_mask:0x3
  v_add_f32_dpp v46, v47, v47 row_ror:8 row_mask:0xf bank_mask:0xc
  v_add_f32_dpp v32, v32, v32 row_shl:4 row_mask:0xf bank_mask:0x5
  v_add_f32_dpp v32, v34, v34 row_shr:4 row_mask:0xf bank_mask:0xa
  v_add_f32_dpp v36, v36, v36 row_shl:4 row_mask:0xf bank_mask:0x5
  v_add_f32_dpp v36, v38, v38 row_shr:4 row_mask:0xf bank_mask:0xa
  v_add_f32_dpp v40, v40, v40 row_shl:4 row_mask:0xf bank_mask:0x5
  v_add_f32_dpp v40, v42, v42 row_shr:4 row_mask:0xf bank_mask:0xa
  v_add_f32_dpp v44, v44, v44 row_shl:4 row_mask:0xf bank_mask:0x5
  v_add_f32_dpp v44, v46, v46 row_shr:4 row_mask:0xf bank_mask:0xa
  s_nop 0
  v_add_f32_dpp v32, v32, v32 quad_perm:[1,0,3,2] row_mask:0xf bank_mask:0xf
  v_add_f32_dpp v36, v36, v36 quad_perm:[1,0,3,2] row_mask:0xf bank_mask:0xf
  v_add_f32_dpp v40, v40, v40 quad_perm:[1,0,3,2] row_mask:0xf bank_mask:0xf
  v_add_f32_dpp v44, v44, v44 quad_perm:[1,0,3,2] row_mask:0xf bank_mask:0xf
  v_cndmask_b32 v32, v32, v36, s[80:81]
  v_cndmask_b32 v40, v40, v44, s[80:81]
  s_nop 0
  v_add_f32_dpp v32, v32, v32 quad_perm:[2,3,0,1] row_mask:0xf bank_mask:0xf
  v_add_f32_dpp v40, v40, v40 quad_perm:[2,3,0,1] row_mask:0xf bank_mask:0xf
  v_cndmask_b32 v14, v32, v40, s[82:83]
  v_cvt_pk_bf16_f32 v14, v14, v14
  v_lshlrev_b32 v14, 16, v14
  v_mul_f32 v14, 0x3db504f3, v14
  v_cvt_pk_bf16_f32 v14, v14, v14
  v_lshlrev_b32 v14, 16, v14
  v_max_f32 v63, v63, v14
  ds_write_b32 v23, v14 offset:0
  v_accvgpr_read_b32 v48, a64
  v_accvgpr_read_b32 v49, a65
  v_accvgpr_read_b32 v50, a66
  v_accvgpr_read_b32 v51, a67
  v_dot2_f32_bf16 v32, v48, v24, 0
  v_dot2_f32_bf16 v32, v49, v25, v32
  v_dot2_f32_bf16 v32, v50, v26, v32
  v_dot2_f32_bf16 v32, v51, v27, v32
  v_accvgpr_read_b32 v52, a68
  v_accvgpr_read_b32 v53, a69
  v_accvgpr_read_b32 v54, a70
  v_accvgpr_read_b32 v55, a71
  v_dot2_f32_bf16 v33, v52, v24, 0
  v_dot2_f32_bf16 v33, v53, v25, v33
  v_dot2_f32_bf16 v33, v54, v26, v33
  v_dot2_f32_bf16 v33, v55, v27, v33
  v_accvgpr_read_b32 v48, a72
  v_accvgpr_read_b32 v49, a73
  v_accvgpr_read_b32 v50, a74
  v_accvgpr_read_b32 v51, a75
  v_dot2_f32_bf16 v34, v48, v24, 0
  v_dot2_f32_bf16 v34, v49, v25, v34
  v_dot2_f32_bf16 v34, v50, v26, v34
  v_dot2_f32_bf16 v34, v51, v27, v34
  v_accvgpr_read_b32 v52, a76
  v_accvgpr_read_b32 v53, a77
  v_accvgpr_read_b32 v54, a78
  v_accvgpr_read_b32 v55, a79
  v_dot2_f32_bf16 v35, v52, v24, 0
  v_dot2_f32_bf16 v35, v53, v25, v35
  v_dot2_f32_bf16 v35, v54, v26, v35
  v_dot2_f32_bf16 v35, v55, v27, v35
  v_accvgpr_read_b32 v48, a80
  v_accvgpr_read_b32 v49, a81
  v_accvgpr_read_b32 v50, a82
  v_accvgpr_read_b32 v51, a83
  v_dot2_f32_bf16 v36, v48, v24, 0
  v_dot2_f32_bf16 v36, v49, v25, v36
  v_dot2_f32_bf16 v36, v50, v26, v36
  v_dot2_f32_bf16 v36, v51, v27, v36
  v_accvgpr_read_b32 v52, a84
  v_accvgpr_read_b32 v53, a85
  v_accvgpr_read_b32 v54, a86
  v_accvgpr_read_b32 v55, a87
  v_dot2_f32_bf16 v37, v52, v24, 0
  v_dot2_f32_bf16 v37, v53, v25, v37
  v_dot2_f32_bf16 v37, v54, v26, v37
  v_dot2_f32_bf16 v37, v55, v27, v37
  v_accvgpr_read_b32 v48, a88
  v_accvgpr_read_b32 v49, a89
  v_accvgpr_read_b32 v50, a90
  v_accvgpr_read_b32 v51, a91
  v_dot2_f32_bf16 v38, v48, v24, 0
  v_dot2_f32_bf16 v38, v49, v25, v38
  v_dot2_f32_bf16 v38, v50, v26, v38
  v_dot2_f32_bf16 v38, v51, v27, v38
  v_accvgpr_read_b32 v52, a92
  v_accvgpr_read_b32 v53, a93
  v_accvgpr_read_b32 v54, a94
  v_accvgpr_read_b32 v55, a95
  v_dot2_f32_bf16 v39, v52, v24, 0
  v_dot2_f32_bf16 v39, v53, v25, v39
  v_dot2_f32_bf16 v39, v54, v26, v39
  v_dot2_f32_bf16 v39, v55, v27, v39
  v_accvgpr_read_b32 v48, a96
  v_accvgpr_read_b32 v49, a97
  v_accvgpr_read_b32 v50, a98
  v_accvgpr_read_b32 v51, a99
  v_dot2_f32_bf16 v40, v48, v24, 0
  v_dot2_f32_bf16 v40, v49, v25, v40
  v_dot2_f32_bf16 v40, v50, v26, v40
  v_dot2_f32_bf16 v40, v51, v27, v40
  v_accvgpr_read_b32 v52, a100
  v_accvgpr_read_b32 v53, a101
  v_accvgpr_read_b32 v54, a102
  v_accvgpr_read_b32 v55, a103
  v_dot2_f32_bf16 v41, v52, v24, 0
  v_dot2_f32_bf16 v41, v53, v25, v41
  v_dot2_f32_bf16 v41, v54, v26, v41
  v_dot2_f32_bf16 v41, v55, v27, v41
  v_accvgpr_read_b32 v48, a104
  v_accvgpr_read_b32 v49, a105
  v_accvgpr_read_b32 v50, a106
  v_accvgpr_read_b32 v51, a107
  v_dot2_f32_bf16 v42, v48, v24, 0
  v_dot2_f32_bf16 v42, v49, v25, v42
  v_dot2_f32_bf16 v42, v50, v26, v42
  v_dot2_f32_bf16 v42, v51, v27, v42
  v_accvgpr_read_b32 v52, a108
  v_accvgpr_read_b32 v53, a109
  v_accvgpr_read_b32 v54, a110
  v_accvgpr_read_b32 v55, a111
  v_dot2_f32_bf16 v43, v52, v24, 0
  v_dot2_f32_bf16 v43, v53, v25, v43
  v_dot2_f32_bf16 v43, v54, v26, v43
  v_dot2_f32_bf16 v43, v55, v27, v43
  v_accvgpr_read_b32 v48, a112
  v_accvgpr_read_b32 v49, a113
  v_accvgpr_read_b32 v50, a114
  v_accvgpr_read_b32 v51, a115
  v_dot2_f32_bf16 v44, v48, v24, 0
  v_dot2_f32_bf16 v44, v49, v25, v44
  v_dot2_f32_bf16 v44, v50, v26, v44
  v_dot2_f32_bf16 v44, v51, v27, v44
  v_accvgpr_read_b32 v52, a116
  v_accvgpr_read_b32 v53, a117
  v_accvgpr_read_b32 v54, a118
  v_accvgpr_read_b32 v55, a119
  v_dot2_f32_bf16 v45, v52, v24, 0
  v_dot2_f32_bf16 v45, v53, v25, v45
  v_dot2_f32_bf16 v45, v54, v26, v45
  v_dot2_f32_bf16 v45, v55, v27, v45
  v_accvgpr_read_b32 v48, a120
  v_accvgpr_read_b32 v49, a121
  v_accvgpr_read_b32 v50, a122
  v_accvgpr_read_b32 v51, a123
  v_dot2_f32_bf16 v46, v48, v24, 0
  v_dot2_f32_bf16 v46, v49, v25, v46
  v_dot2_f32_bf16 v46, v50, v26, v46
  v_dot2_f32_bf16 v46, v51, v27, v46
  v_accvgpr_read_b32 v52, a124
  v_accvgpr_read_b32 v53, a125
  v_accvgpr_read_b32 v54, a126
  v_accvgpr_read_b32 v55, a127
  v_dot2_f32_bf16 v47, v52, v24, 0
  v_dot2_f32_bf16 v47, v53, v25, v47
  v_dot2_f32_bf16 v47, v54, v26, v47
  v_dot2_f32_bf16 v47, v55, v27, v47
  s_nop 2
  v_add_f32_dpp v32, v32, v32 row_ror:8 row_mask:0xf bank_mask:0x3
  v_add_f32_dpp v32, v33, v33 row_ror:8 row_mask:0xf bank_mask:0xc
  v_add_f32_dpp v34, v34, v34 row_ror:8 row_mask:0xf bank_mask:0x3
  v_add_f32_dpp v34, v35, v35 row_ror:8 row_mask:0xf bank_mask:0xc
  v_add_f32_dpp v36, v36, v36 row_ror:8 row_mask:0xf bank_mask:0x3
  v_add_f32_dpp v36, v37, v37 row_ror:8 row_mask:0xf bank_mask:0xc
  v_add_f32_dpp v38, v38, v38 row_ror:8 row_mask:0xf bank_mask:0x3
  v_add_f32_dpp v38, v39, v39 row_ror:8 row_mask:0xf bank_mask:0xc
  v_add_f32_dpp v40, v40, v40 row_ror:8 row_mask:0xf bank_mask:0x3
  v_add_f32_dpp v40, v41, v41 row_ror:8 row_mask:0xf bank_mask:0xc
  v_add_f32_dpp v42, v42, v42 row_ror:8 row_mask:0xf bank_mask:0x3
  v_add_f32_dpp v42, v43, v43 row_ror:8 row_mask:0xf bank_mask:0xc
  v_add_f32_dpp v44, v44, v44 row_ror:8 row_mask:0xf bank_mask:0x3
  v_add_f32_dpp v44, v45, v45 row_ror:8 row_mask:0xf bank_mask:0xc
  v_add_f32_dpp v46, v46, v46 row_ror:8 row_mask:0xf bank_mask:0x3
  v_add_f32_dpp v46, v47, v47 row_ror:8 row_mask:0xf bank_mask:0xc
  v_add_f32_dpp v32, v32, v32 row_shl:4 row_mask:0xf bank_mask:0x5
  v_add_f32_dpp v32, v34, v34 row_shr:4 row_mask:0xf bank_mask:0xa
  v_add_f32_dpp v36, v36, v36 row_shl:4 row_mask:0xf bank_mask:0x5
  v_add_f32_dpp v36, v38, v38 row_shr:4 row_mask:0xf bank_mask:0xa
  v_add_f32_dpp v40, v40, v40 row_shl:4 row_mask:0xf bank_mask:0x5
  v_add_f32_dpp v40, v42, v42 row_shr:4 row_mask:0xf bank_mask:0xa
  v_add_f32_dpp v44, v44, v44 row_shl:4 row_mask:0xf bank_mask:0x5
  v_add_f32_dpp v44, v46, v46 row_shr:4 row_mask:0xf bank_mask:0xa
  s_nop 0
  v_add_f32_dpp v32, v32, v32 quad_perm:[1,0,3,2] row_mask:0xf bank_mask:0xf
  v_add_f32_dpp v36, v36, v36 quad_perm:[1,0,3,2] row_mask:0xf bank_mask:0xf
  v_add_f32_dpp v40, v40, v40 quad_perm:[1,0,3,2] row_mask:0xf bank_mask:0xf
  v_add_f32_dpp v44, v44, v44 quad_perm:[1,0,3,2] row_mask:0xf bank_mask:0xf
  v_cndmask_b32 v32, v32, v36, s[80:81]
  v_cndmask_b32 v40, v40, v44, s[80:81]
  s_nop 0
  v_add_f32_dpp v32, v32, v32 quad_perm:[2,3,0,1] row_mask:0xf bank_mask:0xf
  v_add_f32_dpp v40, v40, v40 quad_perm:[2,3,0,1] row_mask:0xf bank_mask:0xf
  v_cndmask_b32 v14, v32, v40, s[82:83]
  v_cvt_pk_bf16_f32 v14, v14, v14
  v_lshlrev_b32 v14, 16, v14
  v_mul_f32 v14, 0x3db504f3, v14
  v_cvt_pk_bf16_f32 v14, v14, v14
  v_lshlrev_b32 v14, 16, v14
  v_max_f32 v63, v63, v14
  ds_write_b32 v23, v14 offset:256
  v_dot2_f32_bf16 v32, v64, v24, 0
  v_dot2_f32_bf16 v32, v65, v25, v32
  v_dot2_f32_bf16 v32, v66, v26, v32
  v_dot2_f32_bf16 v32, v67, v27, v32
  buffer_load_dwordx4 v[64:67], v21, s[32:35], s70 offen offset:0 nt
  v_dot2_f32_bf16 v33, v68, v24, 0
  v_dot2_f32_bf16 v33, v69, v25, v33
  v_dot2_f32_bf16 v33, v70, v26, v33
  v_dot2_f32_bf16 v33, v71, v27, v33
  buffer_load_dwordx4 v[68:71], v21, s[32:35], s70 offen offset:1024 nt
  v_dot2_f32_bf16 v34, v72, v24, 0
  v_dot2_f32_bf16 v34, v73, v25, v34
  v_dot2_f32_bf16 v34, v74, v26, v34
  v_dot2_f32_bf16 v34, v75, v27, v34
  buffer_load_dwordx4 v[72:75], v21, s[32:35], s70 offen offset:2048 nt
  v_dot2_f32_bf16 v35, v76, v24, 0
  v_dot2_f32_bf16 v35, v77, v25, v35
  v_dot2_f32_bf16 v35, v78, v26, v35
  v_dot2_f32_bf16 v35, v79, v27, v35
  buffer_load_dwordx4 v[76:79], v21, s[32:35], s70 offen offset:3072 nt
  s_add_u32 s70, s70, 16384
  v_dot2_f32_bf16 v36, v80, v24, 0
  v_dot2_f32_bf16 v36, v81, v25, v36
  v_dot2_f32_bf16 v36, v82, v26, v36
  v_dot2_f32_bf16 v36, v83, v27, v36
  buffer_load_dwordx4 v[80:83], v21, s[32:35], s70 offen offset:0 nt
  v_dot2_f32_bf16 v37, v84, v24, 0
  v_dot2_f32_bf16 v37, v85, v25, v37
  v_dot2_f32_bf16 v37, v86, v26, v37
  v_dot2_f32_bf16 v37, v87, v27, v37
  buffer_load_dwordx4 v[84:87], v21, s[32:35], s70 offen offset:1024 nt
  v_dot2_f32_bf16 v38, v88, v24, 0
  v_dot2_f32_bf16 v38, v89, v25, v38
  v_dot2_f32_bf16 v38, v90, v26, v38
  v_dot2_f32_bf16 v38, v91, v27, v38
  buffer_load_dwordx4 v[88:91], v21, s[32:35], s70 offen offset:2048 nt
  v_dot2_f32_bf16 v39, v92, v24, 0
  v_dot2_f32_bf16 v39, v93, v25, v39
  v_dot2_f32_bf16 v39, v94, v26, v39
  v_dot2_f32_bf16 v39, v95, v27, v39
  buffer_load_dwordx4 v[92:95], v21, s[32:35], s70 offen offset:3072 nt
  s_add_u32 s70, s70, 16384
  s_waitcnt vmcnt(15)
  v_dot2_f32_bf16 v40, v96, v24, 0
  v_dot2_f32_bf16 v40, v97, v25, v40
  v_dot2_f32_bf16 v40, v98, v26, v40
  v_dot2_f32_bf16 v40, v99, v27, v40
  buffer_load_dwordx4 v[96:99], v21, s[32:35], s70 offen offset:0 nt
  s_waitcnt vmcnt(15)
  v_dot2_f32_bf16 v41, v100, v24, 0
  v_dot2_f32_bf16 v41, v101, v25, v41
  v_dot2_f32_bf16 v41, v102, v26, v41
  v_dot2_f32_bf16 v41, v103, v27, v41
  buffer_load_dwordx4 v[100:103], v21, s[32:35], s70 offen offset:1024 nt
  s_waitcnt vmcnt(15)
  v_dot2_f32_bf16 v42, v104, v24, 0
  v_dot2_f32_bf16 v42, v105, v25, v42
  v_dot2_f32_bf16 v42, v106, v26, v42
  v_dot2_f32_bf16 v42, v107, v27, v42
  buffer_load_dwordx4 v[104:107], v21, s[32:35], s70 offen offset:2048 nt
  s_waitcnt vmcnt(15)
  v_dot2_f32_bf16 v43, v108, v24, 0
  v_dot2_f32_bf16 v43, v109, v25, v43
  v_dot2_f32_bf16 v43, v110, v26, v43
  v_dot2_f32_bf16 v43, v111, v27, v43
  buffer_load_dwordx4 v[108:111], v21, s[32:35], s70 offen offset:3072 nt
  s_add_u32 s70, s70, 16384
  s_waitcnt vmcnt(15)
  v_dot2_f32_bf16 v44, v112, v24, 0
  v_dot2_f32_bf16 v44, v113, v25, v44
  v_dot2_f32_bf16 v44, v114, v26, v44
  v_dot2_f32_bf16 v44, v115, v27, v44
  buffer_load_dwordx4 v[112:115], v21, s[32:35], s70 offen offset:0 nt
  s_waitcnt vmcnt(15)
  v_dot2_f32_bf16 v45, v116, v24, 0
  v_dot2_f32_bf16 v45, v117, v25, v45
  v_dot2_f32_bf16 v45, v118, v26, v45
  v_dot2_f32_bf16 v45, v119, v27, v45
  buffer_load_dwordx4 v[116:119], v21, s[32:35], s70 offen offset:1024 nt
  s_waitcnt vmcnt(15)
  v_dot2_f32_bf16 v46, v120, v24, 0
  v_dot2_f32_bf16 v46, v121, v25, v46
  v_dot2_f32_bf16 v46, v122, v26, v46
  v_dot2_f32_bf16 v46, v123, v27, v46
  buffer_load_dwordx4 v[120:123], v21, s[32:35], s70 offen offset:2048 nt
  s_waitcnt vmcnt(15)
  v_dot2_f32_bf16 v47, v124, v24, 0
  v_dot2_f32_bf16 v47, v125, v25, v47
  v_dot2_f32_bf16 v47, v126, v26, v47
  v_dot2_f32_bf16 v47, v127, v27, v47
  buffer_load_dwordx4 v[124:127], v21, s[32:35], s70 offen offset:3072 nt
  s_add_u32 s70, s70, 16384
  s_nop 2
  v_add_f32_dpp v32, v32, v32 row_ror:8 row_mask:0xf bank_mask:0x3
  v_add_f32_dpp v32, v33, v33 row_ror:8 row_mask:0xf bank_mask:0xc
  v_add_f32_dpp v34, v34, v34 row_ror:8 row_mask:0xf bank_mask:0x3
  v_add_f32_dpp v34, v35, v35 row_ror:8 row_mask:0xf bank_mask:0xc
  v_add_f32_dpp v36, v36, v36 row_ror:8 row_mask:0xf bank_mask:0x3
  v_add_f32_dpp v36, v37, v37 row_ror:8 row_mask:0xf bank_mask:0xc
  v_add_f32_dpp v38, v38, v38 row_ror:8 row_mask:0xf bank_mask:0x3
  v_add_f32_dpp v38, v39, v39 row_ror:8 row_mask:0xf bank_mask:0xc
  v_add_f32_dpp v40, v40, v40 row_ror:8 row_mask:0xf bank_mask:0x3
  v_add_f32_dpp v40, v41, v41 row_ror:8 row_mask:0xf bank_mask:0xc
  v_add_f32_dpp v42, v42, v42 row_ror:8 row_mask:0xf bank_mask:0x3
  v_add_f32_dpp v42, v43, v43 row_ror:8 row_mask:0xf bank_mask:0xc
  v_add_f32_dpp v44, v44, v44 row_ror:8 row_mask:0xf bank_mask:0x3
  v_add_f32_dpp v44, v45, v45 row_ror:8 row_mask:0xf bank_mask:0xc
  v_add_f32_dpp v46, v46, v46 row_ror:8 row_mask:0xf bank_mask:0x3
  v_add_f32_dpp v46, v47, v47 row_ror:8 row_mask:0xf bank_mask:0xc
  v_add_f32_dpp v32, v32, v32 row_shl:4 row_mask:0xf bank_mask:0x5
  v_add_f32_dpp v32, v34, v34 row_shr:4 row_mask:0xf bank_mask:0xa
  v_add_f32_dpp v36, v36, v36 row_shl:4 row_mask:0xf bank_mask:0x5
  v_add_f32_dpp v36, v38, v38 row_shr:4 row_mask:0xf bank_mask:0xa
  v_add_f32_dpp v40, v40, v40 row_shl:4 row_mask:0xf bank_mask:0x5
  v_add_f32_dpp v40, v42, v42 row_shr:4 row_mask:0xf bank_mask:0xa
  v_add_f32_dpp v44, v44, v44 row_shl:4 row_mask:0xf bank_mask:0x5
  v_add_f32_dpp v44, v46, v46 row_shr:4 row_mask:0xf bank_mask:0xa
  s_nop 0
  v_add_f32_dpp v32, v32, v32 quad_perm:[1,0,3,2] row_mask:0xf bank_mask:0xf
  v_add_f32_dpp v36, v36, v36 quad_perm:[1,0,3,2] row_mask:0xf bank_mask:0xf
  v_add_f32_dpp v40, v40, v40 quad_perm:[1,0,3,2] row_mask:0xf bank_mask:0xf
  v_add_f32_dpp v44, v44, v44 quad_perm:[1,0,3,2] row_mask:0xf bank_mask:0xf
  v_cndmask_b32 v32, v32, v36, s[80:81]
  v_cndmask_b32 v40, v40, v44, s[80:81]
  s_nop 0
  v_add_f32_dpp v32, v32, v32 quad_perm:[2,3,0,1] row_mask:0xf bank_mask:0xf
  v_add_f32_dpp v40, v40, v40 quad_perm:[2,3,0,1] row_mask:0xf bank_mask:0xf
  v_cndmask_b32 v14, v32, v40, s[82:83]
  v_cvt_pk_bf16_f32 v14, v14, v14
  v_lshlrev_b32 v14, 16, v14
  v_mul_f32 v14, 0x3db504f3, v14
  v_cvt_pk_bf16_f32 v14, v14, v14
  v_lshlrev_b32 v14, 16, v14
  v_max_f32 v63, v63, v14
  ds_write_b32 v23, v14 offset:512
  s_waitcnt vmcnt(15)
  v_dot2_f32_bf16 v32, v64, v24, 0
  v_dot2_f32_bf16 v32, v65, v25, v32
  v_dot2_f32_bf16 v32, v66, v26, v32
  v_dot2_f32_bf16 v32, v67, v27, v32
  buffer_load_dwordx4 v[64:67], v21, s[32:35], s70 offen offset:0 nt
  s_waitcnt vmcnt(15)
  v_dot2_f32_bf16 v33, v68, v24, 0
  v_dot2_f32_bf16 v33, v69, v25, v33
  v_dot2_f32_bf16 v33, v70, v26, v33
  v_dot2_f32_bf16 v33, v71, v27, v33
  buffer_load_dwordx4 v[68:71], v21, s[32:35], s70 offen offset:1024 nt
  s_waitcnt vmcnt(15)
  v_dot2_f32_bf16 v34, v72, v24, 0
  v_dot2_f32_bf16 v34, v73, v25, v34
  v_dot2_f32_bf16 v34, v74, v26, v34
  v_dot2_f32_bf16 v34, v75, v27, v34
  buffer_load_dwordx4 v[72:75], v21, s[32:35], s70 offen offset:2048 nt
  s_waitcnt vmcnt(15)
  v_dot2_f32_bf16 v35, v76, v24, 0
  v_dot2_f32_bf16 v35, v77, v25, v35
  v_dot2_f32_bf16 v35, v78, v26, v35
  v_dot2_f32_bf16 v35, v79, v27, v35
  buffer_load_dwordx4 v[76:79], v21, s[32:35], s70 offen offset:3072 nt
  s_add_u32 s70, s70, 16384
  s_waitcnt vmcnt(15)
  v_dot2_f32_bf16 v36, v80, v24, 0
  v_dot2_f32_bf16 v36, v81, v25, v36
  v_dot2_f32_bf16 v36, v82, v26, v36
  v_dot2_f32_bf16 v36, v83, v27, v36
  buffer_load_dwordx4 v[80:83], v21, s[32:35], s70 offen offset:0 nt
  s_waitcnt vmcnt(15)
  v_dot2_f32_bf16 v37, v84, v24, 0
  v_dot2_f32_bf16 v37, v85, v25, v37
  v_dot2_f32_bf16 v37, v86, v26, v37
  v_dot2_f32_bf16 v37, v87, v27, v37
  buffer_load_dwordx4 v[84:87], v21, s[32:35], s70 offen offset:1024 nt
  s_waitcnt vmcnt(15)
  v_dot2_f32_bf16 v38, v88, v24, 0
  v_dot2_f32_bf16 v38, v89, v25, v38
  v_dot2_f32_bf16 v38, v90, v26, v38
  v_dot2_f32_bf16 v38, v91, v27, v38
  buffer_load_dwordx4 v[88:91], v21, s[32:35], s70 offen offset:2048 nt
  s_waitcnt vmcnt(15)
  v_dot2_f32_bf16 v39, v92, v24, 0
  v_dot2_f32_bf16 v39, v93, v25, v39
  v_dot2_f32_bf16 v39, v94, v26, v39
  v_dot2_f32_bf16 v39, v95, v27, v39
  buffer_load_dwordx4 v[92:95], v21, s[32:35], s70 offen offset:3072 nt
  s_add_u32 s70, s70, 16384
  s_waitcnt vmcnt(15)
  v_dot2_f32_bf16 v40, v96, v24, 0
  v_dot2_f32_bf16 v40, v97, v25, v40
  v_dot2_f32_bf16 v40, v98, v26, v40
  v_dot2_f32_bf16 v40, v99, v27, v40
  buffer_load_dwordx4 v[96:99], v21, s[32:35], s70 offen offset:0 nt
  s_waitcnt vmcnt(15)
  v_dot2_f32_bf16 v41, v100, v24, 0
  v_dot2_f32_bf16 v41, v101, v25, v41
  v_dot2_f32_bf16 v41, v102, v26, v41
  v_dot2_f32_bf16 v41, v103, v27, v41
  buffer_load_dwordx4 v[100:103], v21, s[32:35], s70 offen offset:1024 nt
  s_waitcnt vmcnt(15)
  v_dot2_f32_bf16 v42, v104, v24, 0
  v_dot2_f32_bf16 v42, v105, v25, v42
  v_dot2_f32_bf16 v42, v106, v26, v42
  v_dot2_f32_bf16 v42, v107, v27, v42
  buffer_load_dwordx4 v[104:107], v21, s[32:35], s70 offen offset:2048 nt
  s_waitcnt vmcnt(15)
  v_dot2_f32_bf16 v43, v108, v24, 0
  v_dot2_f32_bf16 v43, v109, v25, v43
  v_dot2_f32_bf16 v43, v110, v26, v43
  v_dot2_f32_bf16 v43, v111, v27, v43
  buffer_load_dwordx4 v[108:111], v21, s[32:35], s70 offen offset:3072 nt
  s_add_u32 s70, s70, 16384
  s_waitcnt vmcnt(15)
  v_dot2_f32_bf16 v44, v112, v24, 0
  v_dot2_f32_bf16 v44, v113, v25, v44
  v_dot2_f32_bf16 v44, v114, v26, v44
  v_dot2_f32_bf16 v44, v115, v27, v44
  buffer_load_dwordx4 v[112:115], v21, s[32:35], s70 offen offset:0 nt
  s_waitcnt vmcnt(15)
  v_dot2_f32_bf16 v45, v116, v24, 0
  v_dot2_f32_bf16 v45, v117, v25, v45
  v_dot2_f32_bf16 v45, v118, v26, v45
  v_dot2_f32_bf16 v45, v119, v27, v45
  buffer_load_dwordx4 v[116:119], v21, s[32:35], s70 offen offset:1024 nt
  s_waitcnt vmcnt(15)
  v_dot2_f32_bf16 v46, v120, v24, 0
  v_dot2_f32_bf16 v46, v121, v25, v46
  v_dot2_f32_bf16 v46, v122, v26, v46
  v_dot2_f32_bf16 v46, v123, v27, v46
  buffer_load_dwordx4 v[120:123], v21, s[32:35], s70 offen offset:2048 nt
  s_waitcnt vmcnt(15)
  v_dot2_f32_bf16 v47, v124, v24, 0
  v_dot2_f32_bf16 v47, v125, v25, v47
  v_dot2_f32_bf16 v47, v126, v26, v47
  v_dot2_f32_bf16 v47, v127, v27, v47
  buffer_load_dwordx4 v[124:127], v21, s[32:35], s70 offen offset:3072 nt
  s_add_u32 s70, s70, 16384
  s_nop 2
  v_add_f32_dpp v32, v32, v32 row_ror:8 row_mask:0xf bank_mask:0x3
  v_add_f32_dpp v32, v33, v33 row_ror:8 row_mask:0xf bank_mask:0xc
  v_add_f32_dpp v34, v34, v34 row_ror:8 row_mask:0xf bank_mask:0x3
  v_add_f32_dpp v34, v35, v35 row_ror:8 row_mask:0xf bank_mask:0xc
  v_add_f32_dpp v36, v36, v36 row_ror:8 row_mask:0xf bank_mask:0x3
  v_add_f32_dpp v36, v37, v37 row_ror:8 row_mask:0xf bank_mask:0xc
  v_add_f32_dpp v38, v38, v38 row_ror:8 row_mask:0xf bank_mask:0x3
  v_add_f32_dpp v38, v39, v39 row_ror:8 row_mask:0xf bank_mask:0xc
  v_add_f32_dpp v40, v40, v40 row_ror:8 row_mask:0xf bank_mask:0x3
  v_add_f32_dpp v40, v41, v41 row_ror:8 row_mask:0xf bank_mask:0xc
  v_add_f32_dpp v42, v42, v42 row_ror:8 row_mask:0xf bank_mask:0x3
  v_add_f32_dpp v42, v43, v43 row_ror:8 row_mask:0xf bank_mask:0xc
  v_add_f32_dpp v44, v44, v44 row_ror:8 row_mask:0xf bank_mask:0x3
  v_add_f32_dpp v44, v45, v45 row_ror:8 row_mask:0xf bank_mask:0xc
  v_add_f32_dpp v46, v46, v46 row_ror:8 row_mask:0xf bank_mask:0x3
  v_add_f32_dpp v46, v47, v47 row_ror:8 row_mask:0xf bank_mask:0xc
  v_add_f32_dpp v32, v32, v32 row_shl:4 row_mask:0xf bank_mask:0x5
  v_add_f32_dpp v32, v34, v34 row_shr:4 row_mask:0xf bank_mask:0xa
  v_add_f32_dpp v36, v36, v36 row_shl:4 row_mask:0xf bank_mask:0x5
  v_add_f32_dpp v36, v38, v38 row_shr:4 row_mask:0xf bank_mask:0xa
  v_add_f32_dpp v40, v40, v40 row_shl:4 row_mask:0xf bank_mask:0x5
  v_add_f32_dpp v40, v42, v42 row_shr:4 row_mask:0xf bank_mask:0xa
  v_add_f32_dpp v44, v44, v44 row_shl:4 row_mask:0xf bank_mask:0x5
  v_add_f32_dpp v44, v46, v46 row_shr:4 row_mask:0xf bank_mask:0xa
  s_nop 0
  v_add_f32_dpp v32, v32, v32 quad_perm:[1,0,3,2] row_mask:0xf bank_mask:0xf
  v_add_f32_dpp v36, v36, v36 quad_perm:[1,0,3,2] row_mask:0xf bank_mask:0xf
  v_add_f32_dpp v40, v40, v40 quad_perm:[1,0,3,2] row_mask:0xf bank_mask:0xf
  v_add_f32_dpp v44, v44, v44 quad_perm:[1,0,3,2] row_mask:0xf bank_mask:0xf
  v_cndmask_b32 v32, v32, v36, s[80:81]
  v_cndmask_b32 v40, v40, v44, s[80:81]
  s_nop 0
  v_add_f32_dpp v32, v32, v32 quad_perm:[2,3,0,1] row_mask:0xf bank_mask:0xf
  v_add_f32_dpp v40, v40, v40 quad_perm:[2,3,0,1] row_mask:0xf bank_mask:0xf
  v_cndmask_b32 v14, v32, v40, s[82:83]
  v_cvt_pk_bf16_f32 v14, v14, v14
  v_lshlrev_b32 v14, 16, v14
  v_mul_f32 v14, 0x3db504f3, v14
  v_cvt_pk_bf16_f32 v14, v14, v14
  v_lshlrev_b32 v14, 16, v14
  v_max_f32 v63, v63, v14
  ds_write_b32 v23, v14 offset:768
  s_waitcnt vmcnt(15)
  v_dot2_f32_bf16 v32, v64, v24, 0
  v_dot2_f32_bf16 v32, v65, v25, v32
  v_dot2_f32_bf16 v32, v66, v26, v32
  v_dot2_f32_bf16 v32, v67, v27, v32
  buffer_load_dwordx4 v[64:67], v21, s[32:35], s70 offen offset:0 nt
  s_waitcnt vmcnt(15)
  v_dot2_f32_bf16 v33, v68, v24, 0
  v_dot2_f32_bf16 v33, v69, v25, v33
  v_dot2_f32_bf16 v33, v70, v26, v33
  v_dot2_f32_bf16 v33, v71, v27, v33
  buffer_load_dwordx4 v[68:71], v21, s[32:35], s70 offen offset:1024 nt
  s_waitcnt vmcnt(15)
  v_dot2_f32_bf16 v34, v72, v24, 0
  v_dot2_f32_bf16 v34, v73, v25, v34
  v_dot2_f32_bf16 v34, v74, v26, v34
  v_dot2_f32_bf16 v34, v75, v27, v34
  buffer_load_dwordx4 v[72:75], v21, s[32:35], s70 offen offset:2048 nt
  s_waitcnt vmcnt(15)
  v_dot2_f32_bf16 v35, v76, v24, 0
  v_dot2_f32_bf16 v35, v77, v25, v35
  v_dot2_f32_bf16 v35, v78, v26, v35
  v_dot2_f32_bf16 v35, v79, v27, v35
  buffer_load_dwordx4 v[76:79], v21, s[32:35], s70 offen offset:3072 nt
  s_add_u32 s70, s70, 16384
  s_waitcnt vmcnt(15)
  v_dot2_f32_bf16 v36, v80, v24, 0
  v_dot2_f32_bf16 v36, v81, v25, v36
  v_dot2_f32_bf16 v36, v82, v26, v36
  v_dot2_f32_bf16 v36, v83, v27, v36
  buffer_load_dwordx4 v[80:83], v21, s[32:35], s70 offen offset:0 nt
  s_waitcnt vmcnt(15)
  v_dot2_f32_bf16 v37, v84, v24, 0
  v_dot2_f32_bf16 v37, v85, v25, v37
  v_dot2_f32_bf16 v37, v86, v26, v37
  v_dot2_f32_bf16 v37, v87, v27, v37
  buffer_load_dwordx4 v[84:87], v21, s[32:35], s70 offen offset:1024 nt
  s_waitcnt vmcnt(15)
  v_dot2_f32_bf16 v38, v88, v24, 0
  v_dot2_f32_bf16 v38, v89, v25, v38
  v_dot2_f32_bf16 v38, v90, v26, v38
  v_dot2_f32_bf16 v38, v91, v27, v38
  buffer_load_dwordx4 v[88:91], v21, s[32:35], s70 offen offset:2048 nt
  s_waitcnt vmcnt(15)
  v_dot2_f32_bf16 v39, v92, v24, 0
  v_dot2_f32_bf16 v39, v93, v25, v39
  v_dot2_f32_bf16 v39, v94, v26, v39
  v_dot2_f32_bf16 v39, v95, v27, v39
  buffer_load_dwordx4 v[92:95], v21, s[32:35], s70 offen offset:3072 nt
  s_add_u32 s70, s70, 16384
  s_waitcnt vmcnt(15)
  v_dot2_f32_bf16 v40, v96, v24, 0
  v_dot2_f32_bf16 v40, v97, v25, v40
  v_dot2_f32_bf16 v40, v98, v26, v40
  v_dot2_f32_bf16 v40, v99, v27, v40
  buffer_load_dwordx4 v[96:99], v21, s[32:35], s70 offen offset:0 nt
  s_waitcnt vmcnt(15)
  v_dot2_f32_bf16 v41, v100, v24, 0
  v_dot2_f32_bf16 v41, v101, v25, v41
  v_dot2_f32_bf16 v41, v102, v26, v41
  v_dot2_f32_bf16 v41, v103, v27, v41
  buffer_load_dwordx4 v[100:103], v21, s[32:35], s70 offen offset:1024 nt
  s_waitcnt vmcnt(15)
  v_dot2_f32_bf16 v42, v104, v24, 0
  v_dot2_f32_bf16 v42, v105, v25, v42
  v_dot2_f32_bf16 v42, v106, v26, v42
  v_dot2_f32_bf16 v42, v107, v27, v42
  buffer_load_dwordx4 v[104:107], v21, s[32:35], s70 offen offset:2048 nt
  s_waitcnt vmcnt(15)
  v_dot2_f32_bf16 v43, v108, v24, 0
  v_dot2_f32_bf16 v43, v109, v25, v43
  v_dot2_f32_bf16 v43, v110, v26, v43
  v_dot2_f32_bf16 v43, v111, v27, v43
  buffer_load_dwordx4 v[108:111], v21, s[32:35], s70 offen offset:3072 nt
  s_add_u32 s70, s70, 16384
  s_waitcnt vmcnt(15)
  v_dot2_f32_bf16 v44, v112, v24, 0
  v_dot2_f32_bf16 v44, v113, v25, v44
  v_dot2_f32_bf16 v44, v114, v26, v44
  v_dot2_f32_bf16 v44, v115, v27, v44
  buffer_load_dwordx4 v[112:115], v21, s[32:35], s70 offen offset:0 nt
  s_waitcnt vmcnt(15)
  v_dot2_f32_bf16 v45, v116, v24, 0
  v_dot2_f32_bf16 v45, v117, v25, v45
  v_dot2_f32_bf16 v45, v118, v26, v45
  v_dot2_f32_bf16 v45, v119, v27, v45
  buffer_load_dwordx4 v[116:119], v21, s[32:35], s70 offen offset:1024 nt
  s_waitcnt vmcnt(15)
  v_dot2_f32_bf16 v46, v120, v24, 0
  v_dot2_f32_bf16 v46, v121, v25, v46
  v_dot2_f32_bf16 v46, v122, v26, v46
  v_dot2_f32_bf16 v46, v123, v27, v46
  buffer_load_dwordx4 v[120:123], v21, s[32:35], s70 offen offset:2048 nt
  s_waitcnt vmcnt(15)
  v_dot2_f32_bf16 v47, v124, v24, 0
  v_dot2_f32_bf16 v47, v125, v25, v47
  v_dot2_f32_bf16 v47, v126, v26, v47
  v_dot2_f32_bf16 v47, v127, v27, v47
  buffer_load_dwordx4 v[124:127], v21, s[32:35], s70 offen offset:3072 nt
  s_add_u32 s70, s70, 16384
  s_nop 2
  v_add_f32_dpp v32, v32, v32 row_ror:8 row_mask:0xf bank_mask:0x3
  v_add_f32_dpp v32, v33, v33 row_ror:8 row_mask:0xf bank_mask:0xc
  v_add_f32_dpp v34, v34, v34 row_ror:8 row_mask:0xf bank_mask:0x3
  v_add_f32_dpp v34, v35, v35 row_ror:8 row_mask:0xf bank_mask:0xc
  v_add_f32_dpp v36, v36, v36 row_ror:8 row_mask:0xf bank_mask:0x3
  v_add_f32_dpp v36, v37, v37 row_ror:8 row_mask:0xf bank_mask:0xc
  v_add_f32_dpp v38, v38, v38 row_ror:8 row_mask:0xf bank_mask:0x3
  v_add_f32_dpp v38, v39, v39 row_ror:8 row_mask:0xf bank_mask:0xc
  v_add_f32_dpp v40, v40, v40 row_ror:8 row_mask:0xf bank_mask:0x3
  v_add_f32_dpp v40, v41, v41 row_ror:8 row_mask:0xf bank_mask:0xc
  v_add_f32_dpp v42, v42, v42 row_ror:8 row_mask:0xf bank_mask:0x3
  v_add_f32_dpp v42, v43, v43 row_ror:8 row_mask:0xf bank_mask:0xc
  v_add_f32_dpp v44, v44, v44 row_ror:8 row_mask:0xf bank_mask:0x3
  v_add_f32_dpp v44, v45, v45 row_ror:8 row_mask:0xf bank_mask:0xc
  v_add_f32_dpp v46, v46, v46 row_ror:8 row_mask:0xf bank_mask:0x3
  v_add_f32_dpp v46, v47, v47 row_ror:8 row_mask:0xf bank_mask:0xc
  v_add_f32_dpp v32, v32, v32 row_shl:4 row_mask:0xf bank_mask:0x5
  v_add_f32_dpp v32, v34, v34 row_shr:4 row_mask:0xf bank_mask:0xa
  v_add_f32_dpp v36, v36, v36 row_shl:4 row_mask:0xf bank_mask:0x5
  v_add_f32_dpp v36, v38, v38 row_shr:4 row_mask:0xf bank_mask:0xa
  v_add_f32_dpp v40, v40, v40 row_shl:4 row_mask:0xf bank_mask:0x5
  v_add_f32_dpp v40, v42, v42 row_shr:4 row_mask:0xf bank_mask:0xa
  v_add_f32_dpp v44, v44, v44 row_shl:4 row_mask:0xf bank_mask:0x5
  v_add_f32_dpp v44, v46, v46 row_shr:4 row_mask:0xf bank_mask:0xa
  s_nop 0
  v_add_f32_dpp v32, v32, v32 quad_perm:[1,0,3,2] row_mask:0xf bank_mask:0xf
  v_add_f32_dpp v36, v36, v36 quad_perm:[1,0,3,2] row_mask:0xf bank_mask:0xf
  v_add_f32_dpp v40, v40, v40 quad_perm:[1,0,3,2] row_mask:0xf bank_mask:0xf
  v_add_f32_dpp v44, v44, v44 quad_perm:[1,0,3,2] row_mask:0xf bank_mask:0xf
  v_cndmask_b32 v32, v32, v36, s[80:81]
  v_cndmask_b32 v40, v40, v44, s[80:81]
  s_nop 0
  v_add_f32_dpp v32, v32, v32 quad_perm:[2,3,0,1] row_mask:0xf bank_mask:0xf
  v_add_f32_dpp v40, v40, v40 quad_perm:[2,3,0,1] row_mask:0xf bank_mask:0xf
  v_cndmask_b32 v14, v32, v40, s[82:83]
  v_cvt_pk_bf16_f32 v14, v14, v14
  v_lshlrev_b32 v14, 16, v14
  v_mul_f32 v14, 0x3db504f3, v14
  v_cvt_pk_bf16_f32 v14, v14, v14
  v_lshlrev_b32 v14, 16, v14
  v_max_f32 v63, v63, v14
  ds_write_b32 v23, v14 offset:1024
  s_waitcnt vmcnt(15)
  v_dot2_f32_bf16 v32, v64, v24, 0
  v_dot2_f32_bf16 v32, v65, v25, v32
  v_dot2_f32_bf16 v32, v66, v26, v32
  v_dot2_f32_bf16 v32, v67, v27, v32
  buffer_load_dwordx4 v[64:67], v21, s[32:35], s70 offen offset:0 nt
  s_waitcnt vmcnt(15)
  v_dot2_f32_bf16 v33, v68, v24, 0
  v_dot2_f32_bf16 v33, v69, v25, v33
  v_dot2_f32_bf16 v33, v70, v26, v33
  v_dot2_f32_bf16 v33, v71, v27, v33
  buffer_load_dwordx4 v[68:71], v21, s[32:35], s70 offen offset:1024 nt
  s_waitcnt vmcnt(15)
  v_dot2_f32_bf16 v34, v72, v24, 0
  v_dot2_f32_bf16 v34, v73, v25, v34
  v_dot2_f32_bf16 v34, v74, v26, v34
  v_dot2_f32_bf16 v34, v75, v27, v34
  buffer_load_dwordx4 v[72:75], v21, s[32:35], s70 offen offset:2048 nt
  s_waitcnt vmcnt(15)
  v_dot2_f32_bf16 v35, v76, v24, 0
  v_dot2_f32_bf16 v35, v77, v25, v35
  v_dot2_f32_bf16 v35, v78, v26, v35
  v_dot2_f32_bf16 v35, v79, v27, v35
  buffer_load_dwordx4 v[76:79], v21, s[32:35], s70 offen offset:3072 nt
  s_add_u32 s70, s70, 16384
  s_waitcnt vmcnt(15)
  v_dot2_f32_bf16 v36, v80, v24, 0
  v_dot2_f32_bf16 v36, v81, v25, v36
  v_dot2_f32_bf16 v36, v82, v26, v36
  v_dot2_f32_bf16 v36, v83, v27, v36
  buffer_load_dwordx4 v[80:83], v21, s[32:35], s70 offen offset:0 nt
  s_waitcnt vmcnt(15)
  v_dot2_f32_bf16 v37, v84, v24, 0
  v_dot2_f32_bf16 v37, v85, v25, v37
  v_dot2_f32_bf16 v37, v86, v26, v37
  v_dot2_f32_bf16 v37, v87, v27, v37
  buffer_load_dwordx4 v[84:87], v21, s[32:35], s70 offen offset:1024 nt
  s_waitcnt vmcnt(15)
  v_dot2_f32_bf16 v38, v88, v24, 0
  v_dot2_f32_bf16 v38, v89, v25, v38
  v_dot2_f32_bf16 v38, v90, v26, v38
  v_dot2_f32_bf16 v38, v91, v27, v38
  buffer_load_dwordx4 v[88:91], v21, s[32:35], s70 offen offset:2048 nt
  s_waitcnt vmcnt(15)
  v_dot2_f32_bf16 v39, v92, v24, 0
  v_dot2_f32_bf16 v39, v93, v25, v39
  v_dot2_f32_bf16 v39, v94, v26, v39
  v_dot2_f32_bf16 v39, v95, v27, v39
  buffer_load_dwordx4 v[92:95], v21, s[32:35], s70 offen offset:3072 nt
  s_add_u32 s70, s70, 16384
  s_waitcnt vmcnt(15)
  v_dot2_f32_bf16 v40, v96, v24, 0
  v_dot2_f32_bf16 v40, v97, v25, v40
  v_dot2_f32_bf16 v40, v98, v26, v40
  v_dot2_f32_bf16 v40, v99, v27, v40
  buffer_load_dwordx4 v[96:99], v21, s[32:35], s70 offen offset:0 nt
  s_waitcnt vmcnt(15)
  v_dot2_f32_bf16 v41, v100, v24, 0
  v_dot2_f32_bf16 v41, v101, v25, v41
  v_dot2_f32_bf16 v41, v102, v26, v41
  v_dot2_f32_bf16 v41, v103, v27, v41
  buffer_load_dwordx4 v[100:103], v21, s[32:35], s70 offen offset:1024 nt
  s_waitcnt vmcnt(15)
  v_dot2_f32_bf16 v42, v104, v24, 0
  v_dot2_f32_bf16 v42, v105, v25, v42
  v_dot2_f32_bf16 v42, v106, v26, v42
  v_dot2_f32_bf16 v42, v107, v27, v42
  buffer_load_dwordx4 v[104:107], v21, s[32:35], s70 offen offset:2048 nt
  s_waitcnt vmcnt(15)
  v_dot2_f32_bf16 v43, v108, v24, 0
  v_dot2_f32_bf16 v43, v109, v25, v43
  v_dot2_f32_bf16 v43, v110, v26, v43
  v_dot2_f32_bf16 v43, v111, v27, v43
  buffer_load_dwordx4 v[108:111], v21, s[32:35], s70 offen offset:3072 nt
  s_add_u32 s70, s70, 16384
  s_waitcnt vmcnt(15)
  v_dot2_f32_bf16 v44, v112, v24, 0
  v_dot2_f32_bf16 v44, v113, v25, v44
  v_dot2_f32_bf16 v44, v114, v26, v44
  v_dot2_f32_bf16 v44, v115, v27, v44
  buffer_load_dwordx4 v[112:115], v21, s[32:35], s70 offen offset:0 nt
  s_waitcnt vmcnt(15)
  v_dot2_f32_bf16 v45, v116, v24, 0
  v_dot2_f32_bf16 v45, v117, v25, v45
  v_dot2_f32_bf16 v45, v118, v26, v45
  v_dot2_f32_bf16 v45, v119, v27, v45
  buffer_load_dwordx4 v[116:119], v21, s[32:35], s70 offen offset:1024 nt
  s_waitcnt vmcnt(15)
  v_dot2_f32_bf16 v46, v120, v24, 0
  v_dot2_f32_bf16 v46, v121, v25, v46
  v_dot2_f32_bf16 v46, v122, v26, v46
  v_dot2_f32_bf16 v46, v123, v27, v46
  buffer_load_dwordx4 v[120:123], v21, s[32:35], s70 offen offset:2048 nt
  s_waitcnt vmcnt(15)
  v_dot2_f32_bf16 v47, v124, v24, 0
  v_dot2_f32_bf16 v47, v125, v25, v47
  v_dot2_f32_bf16 v47, v126, v26, v47
  v_dot2_f32_bf16 v47, v127, v27, v47
  buffer_load_dwordx4 v[124:127], v21, s[32:35], s70 offen offset:3072 nt
  s_add_u32 s70, s70, 16384
  s_nop 2
  v_add_f32_dpp v32, v32, v32 row_ror:8 row_mask:0xf bank_mask:0x3
  v_add_f32_dpp v32, v33, v33 row_ror:8 row_mask:0xf bank_mask:0xc
  v_add_f32_dpp v34, v34, v34 row_ror:8 row_mask:0xf bank_mask:0x3
  v_add_f32_dpp v34, v35, v35 row_ror:8 row_mask:0xf bank_mask:0xc
  v_add_f32_dpp v36, v36, v36 row_ror:8 row_mask:0xf bank_mask:0x3
  v_add_f32_dpp v36, v37, v37 row_ror:8 row_mask:0xf bank_mask:0xc
  v_add_f32_dpp v38, v38, v38 row_ror:8 row_mask:0xf bank_mask:0x3
  v_add_f32_dpp v38, v39, v39 row_ror:8 row_mask:0xf bank_mask:0xc
  v_add_f32_dpp v40, v40, v40 row_ror:8 row_mask:0xf bank_mask:0x3
  v_add_f32_dpp v40, v41, v41 row_ror:8 row_mask:0xf bank_mask:0xc
  v_add_f32_dpp v42, v42, v42 row_ror:8 row_mask:0xf bank_mask:0x3
  v_add_f32_dpp v42, v43, v43 row_ror:8 row_mask:0xf bank_mask:0xc
  v_add_f32_dpp v44, v44, v44 row_ror:8 row_mask:0xf bank_mask:0x3
  v_add_f32_dpp v44, v45, v45 row_ror:8 row_mask:0xf bank_mask:0xc
  v_add_f32_dpp v46, v46, v46 row_ror:8 row_mask:0xf bank_mask:0x3
  v_add_f32_dpp v46, v47, v47 row_ror:8 row_mask:0xf bank_mask:0xc
  v_add_f32_dpp v32, v32, v32 row_shl:4 row_mask:0xf bank_mask:0x5
  v_add_f32_dpp v32, v34, v34 row_shr:4 row_mask:0xf bank_mask:0xa
  v_add_f32_dpp v36, v36, v36 row_shl:4 row_mask:0xf bank_mask:0x5
  v_add_f32_dpp v36, v38, v38 row_shr:4 row_mask:0xf bank_mask:0xa
  v_add_f32_dpp v40, v40, v40 row_shl:4 row_mask:0xf bank_mask:0x5
  v_add_f32_dpp v40, v42, v42 row_shr:4 row_mask:0xf bank_mask:0xa
  v_add_f32_dpp v44, v44, v44 row_shl:4 row_mask:0xf bank_mask:0x5
  v_add_f32_dpp v44, v46, v46 row_shr:4 row_mask:0xf bank_mask:0xa
  s_nop 0
  v_add_f32_dpp v32, v32, v32 quad_perm:[1,0,3,2] row_mask:0xf bank_mask:0xf
  v_add_f32_dpp v36, v36, v36 quad_perm:[1,0,3,2] row_mask:0xf bank_mask:0xf
  v_add_f32_dpp v40, v40, v40 quad_perm:[1,0,3,2] row_mask:0xf bank_mask:0xf
  v_add_f32_dpp v44, v44, v44 quad_perm:[1,0,3,2] row_mask:0xf bank_mask:0xf
  v_cndmask_b32 v32, v32, v36, s[80:81]
  v_cndmask_b32 v40, v40, v44, s[80:81]
  s_nop 0
  v_add_f32_dpp v32, v32, v32 quad_perm:[2,3,0,1] row_mask:0xf bank_mask:0xf
  v_add_f32_dpp v40, v40, v40 quad_perm:[2,3,0,1] row_mask:0xf bank_mask:0xf
  v_cndmask_b32 v14, v32, v40, s[82:83]
  v_cvt_pk_bf16_f32 v14, v14, v14
  v_lshlrev_b32 v14, 16, v14
  v_mul_f32 v14, 0x3db504f3, v14
  v_cvt_pk_bf16_f32 v14, v14, v14
  v_lshlrev_b32 v14, 16, v14
  v_max_f32 v63, v63, v14
  ds_write_b32 v23, v14 offset:1280
  s_waitcnt vmcnt(15)
  v_dot2_f32_bf16 v32, v64, v24, 0
  v_dot2_f32_bf16 v32, v65, v25, v32
  v_dot2_f32_bf16 v32, v66, v26, v32
  v_dot2_f32_bf16 v32, v67, v27, v32
  buffer_load_dwordx4 v[64:67], v21, s[32:35], s70 offen offset:0 nt
  s_waitcnt vmcnt(15)
  v_dot2_f32_bf16 v33, v68, v24, 0
  v_dot2_f32_bf16 v33, v69, v25, v33
  v_dot2_f32_bf16 v33, v70, v26, v33
  v_dot2_f32_bf16 v33, v71, v27, v33
  buffer_load_dwordx4 v[68:71], v21, s[32:35], s70 offen offset:1024 nt
  s_waitcnt vmcnt(15)
  v_dot2_f32_bf16 v34, v72, v24, 0
  v_dot2_f32_bf16 v34, v73, v25, v34
  v_dot2_f32_bf16 v34, v74, v26, v34
  v_dot2_f32_bf16 v34, v75, v27, v34
  buffer_load_dwordx4 v[72:75], v21, s[32:35], s70 offen offset:2048 nt
  s_waitcnt vmcnt(15)
  v_dot2_f32_bf16 v35, v76, v24, 0
  v_dot2_f32_bf16 v35, v77, v25, v35
  v_dot2_f32_bf16 v35, v78, v26, v35
  v_dot2_f32_bf16 v35, v79, v27, v35
  buffer_load_dwordx4 v[76:79], v21, s[32:35], s70 offen offset:3072 nt
  s_add_u32 s70, s70, 16384
  s_waitcnt vmcnt(15)
  v_dot2_f32_bf16 v36, v80, v24, 0
  v_dot2_f32_bf16 v36, v81, v25, v36
  v_dot2_f32_bf16 v36, v82, v26, v36
  v_dot2_f32_bf16 v36, v83, v27, v36
  buffer_load_dwordx4 v[80:83], v21, s[32:35], s70 offen offset:0 nt
  s_waitcnt vmcnt(15)
  v_dot2_f32_bf16 v37, v84, v24, 0
  v_dot2_f32_bf16 v37, v85, v25, v37
  v_dot2_f32_bf16 v37, v86, v26, v37
  v_dot2_f32_bf16 v37, v87, v27, v37
  buffer_load_dwordx4 v[84:87], v21, s[32:35], s70 offen offset:1024 nt
  s_waitcnt vmcnt(15)
  v_dot2_f32_bf16 v38, v88, v24, 0
  v_dot2_f32_bf16 v38, v89, v25, v38
  v_dot2_f32_bf16 v38, v90, v26, v38
  v_dot2_f32_bf16 v38, v91, v27, v38
  buffer_load_dwordx4 v[88:91], v21, s[32:35], s70 offen offset:2048 nt
  s_waitcnt vmcnt(15)
  v_dot2_f32_bf16 v39, v92, v24, 0
  v_dot2_f32_bf16 v39, v93, v25, v39
  v_dot2_f32_bf16 v39, v94, v26, v39
  v_dot2_f32_bf16 v39, v95, v27, v39
  buffer_load_dwordx4 v[92:95], v21, s[32:35], s70 offen offset:3072 nt
  s_add_u32 s70, s70, 16384
  s_waitcnt vmcnt(15)
  v_dot2_f32_bf16 v40, v96, v24, 0
  v_dot2_f32_bf16 v40, v97, v25, v40
  v_dot2_f32_bf16 v40, v98, v26, v40
  v_dot2_f32_bf16 v40, v99, v27, v40
  buffer_load_dwordx4 v[96:99], v21, s[32:35], s70 offen offset:0 nt
  s_waitcnt vmcnt(15)
  v_dot2_f32_bf16 v41, v100, v24, 0
  v_dot2_f32_bf16 v41, v101, v25, v41
  v_dot2_f32_bf16 v41, v102, v26, v41
  v_dot2_f32_bf16 v41, v103, v27, v41
  buffer_load_dwordx4 v[100:103], v21, s[32:35], s70 offen offset:1024 nt
  s_waitcnt vmcnt(15)
  v_dot2_f32_bf16 v42, v104, v24, 0
  v_dot2_f32_bf16 v42, v105, v25, v42
  v_dot2_f32_bf16 v42, v106, v26, v42
  v_dot2_f32_bf16 v42, v107, v27, v42
  buffer_load_dwordx4 v[104:107], v21, s[32:35], s70 offen offset:2048 nt
  s_waitcnt vmcnt(15)
  v_dot2_f32_bf16 v43, v108, v24, 0
  v_dot2_f32_bf16 v43, v109, v25, v43
  v_dot2_f32_bf16 v43, v110, v26, v43
  v_dot2_f32_bf16 v43, v111, v27, v43
  buffer_load_dwordx4 v[108:111], v21, s[32:35], s70 offen offset:3072 nt
  s_add_u32 s70, s70, 16384
  s_waitcnt vmcnt(15)
  v_dot2_f32_bf16 v44, v112, v24, 0
  v_dot2_f32_bf16 v44, v113, v25, v44
  v_dot2_f32_bf16 v44, v114, v26, v44
  v_dot2_f32_bf16 v44, v115, v27, v44
  buffer_load_dwordx4 v[112:115], v21, s[32:35], s70 offen offset:0 nt
  s_waitcnt vmcnt(15)
  v_dot2_f32_bf16 v45, v116, v24, 0
  v_dot2_f32_bf16 v45, v117, v25, v45
  v_dot2_f32_bf16 v45, v118, v26, v45
  v_dot2_f32_bf16 v45, v119, v27, v45
  buffer_load_dwordx4 v[116:119], v21, s[32:35], s70 offen offset:1024 nt
  s_waitcnt vmcnt(15)
  v_dot2_f32_bf16 v46, v120, v24, 0
  v_dot2_f32_bf16 v46, v121, v25, v46
  v_dot2_f32_bf16 v46, v122, v26, v46
  v_dot2_f32_bf16 v46, v123, v27, v46
  buffer_load_dwordx4 v[120:123], v21, s[32:35], s70 offen offset:2048 nt
  s_waitcnt vmcnt(15)
  v_dot2_f32_bf16 v47, v124, v24, 0
  v_dot2_f32_bf16 v47, v125, v25, v47
  v_dot2_f32_bf16 v47, v126, v26, v47
  v_dot2_f32_bf16 v47, v127, v27, v47
  buffer_load_dwordx4 v[124:127], v21, s[32:35], s70 offen offset:3072 nt
  s_add_u32 s70, s70, 16384
  s_nop 2
  v_add_f32_dpp v32, v32, v32 row_ror:8 row_mask:0xf bank_mask:0x3
  v_add_f32_dpp v32, v33, v33 row_ror:8 row_mask:0xf bank_mask:0xc
  v_add_f32_dpp v34, v34, v34 row_ror:8 row_mask:0xf bank_mask:0x3
  v_add_f32_dpp v34, v35, v35 row_ror:8 row_mask:0xf bank_mask:0xc
  v_add_f32_dpp v36, v36, v36 row_ror:8 row_mask:0xf bank_mask:0x3
  v_add_f32_dpp v36, v37, v37 row_ror:8 row_mask:0xf bank_mask:0xc
  v_add_f32_dpp v38, v38, v38 row_ror:8 row_mask:0xf bank_mask:0x3
  v_add_f32_dpp v38, v39, v39 row_ror:8 row_mask:0xf bank_mask:0xc
  v_add_f32_dpp v40, v40, v40 row_ror:8 row_mask:0xf bank_mask:0x3
  v_add_f32_dpp v40, v41, v41 row_ror:8 row_mask:0xf bank_mask:0xc
  v_add_f32_dpp v42, v42, v42 row_ror:8 row_mask:0xf bank_mask:0x3
  v_add_f32_dpp v42, v43, v43 row_ror:8 row_mask:0xf bank_mask:0xc
  v_add_f32_dpp v44, v44, v44 row_ror:8 row_mask:0xf bank_mask:0x3
  v_add_f32_dpp v44, v45, v45 row_ror:8 row_mask:0xf bank_mask:0xc
  v_add_f32_dpp v46, v46, v46 row_ror:8 row_mask:0xf bank_mask:0x3
  v_add_f32_dpp v46, v47, v47 row_ror:8 row_mask:0xf bank_mask:0xc
  v_add_f32_dpp v32, v32, v32 row_shl:4 row_mask:0xf bank_mask:0x5
  v_add_f32_dpp v32, v34, v34 row_shr:4 row_mask:0xf bank_mask:0xa
  v_add_f32_dpp v36, v36, v36 row_shl:4 row_mask:0xf bank_mask:0x5
  v_add_f32_dpp v36, v38, v38 row_shr:4 row_mask:0xf bank_mask:0xa
  v_add_f32_dpp v40, v40, v40 row_shl:4 row_mask:0xf bank_mask:0x5
  v_add_f32_dpp v40, v42, v42 row_shr:4 row_mask:0xf bank_mask:0xa
  v_add_f32_dpp v44, v44, v44 row_shl:4 row_mask:0xf bank_mask:0x5
  v_add_f32_dpp v44, v46, v46 row_shr:4 row_mask:0xf bank_mask:0xa
  s_nop 0
  v_add_f32_dpp v32, v32, v32 quad_perm:[1,0,3,2] row_mask:0xf bank_mask:0xf
  v_add_f32_dpp v36, v36, v36 quad_perm:[1,0,3,2] row_mask:0xf bank_mask:0xf
  v_add_f32_dpp v40, v40, v40 quad_perm:[1,0,3,2] row_mask:0xf bank_mask:0xf
  v_add_f32_dpp v44, v44, v44 quad_perm:[1,0,3,2] row_mask:0xf bank_mask:0xf
  v_cndmask_b32 v32, v32, v36, s[80:81]
  v_cndmask_b32 v40, v40, v44, s[80:81]
  s_nop 0
  v_add_f32_dpp v32, v32, v32 quad_perm:[2,3,0,1] row_mask:0xf bank_mask:0xf
  v_add_f32_dpp v40, v40, v40 quad_perm:[2,3,0,1] row_mask:0xf bank_mask:0xf
  v_cndmask_b32 v14, v32, v40, s[82:83]
  v_cvt_pk_bf16_f32 v14, v14, v14
  v_lshlrev_b32 v14, 16, v14
  v_mul_f32 v14, 0x3db504f3, v14
  v_cvt_pk_bf16_f32 v14, v14, v14
  v_lshlrev_b32 v14, 16, v14
  v_max_f32 v63, v63, v14
  ds_write_b32 v23, v14 offset:1536
  s_waitcnt vmcnt(15)
  v_dot2_f32_bf16 v32, v64, v24, 0
  v_dot2_f32_bf16 v32, v65, v25, v32
  v_dot2_f32_bf16 v32, v66, v26, v32
  v_dot2_f32_bf16 v32, v67, v27, v32
  buffer_load_dwordx4 v[64:67], v21, s[32:35], s70 offen offset:0 nt
  s_waitcnt vmcnt(15)
  v_dot2_f32_bf16 v33, v68, v24, 0
  v_dot2_f32_bf16 v33, v69, v25, v33
  v_dot2_f32_bf16 v33, v70, v26, v33
  v_dot2_f32_bf16 v33, v71, v27, v33
  buffer_load_dwordx4 v[68:71], v21, s[32:35], s70 offen offset:1024 nt
  s_waitcnt vmcnt(15)
  v_dot2_f32_bf16 v34, v72, v24, 0
  v_dot2_f32_bf16 v34, v73, v25, v34
  v_dot2_f32_bf16 v34, v74, v26, v34
  v_dot2_f32_bf16 v34, v75, v27, v34
  buffer_load_dwordx4 v[72:75], v21, s[32:35], s70 offen offset:2048 nt
  s_waitcnt vmcnt(15)
  v_dot2_f32_bf16 v35, v76, v24, 0
  v_dot2_f32_bf16 v35, v77, v25, v35
  v_dot2_f32_bf16 v35, v78, v26, v35
  v_dot2_f32_bf16 v35, v79, v27, v35
  buffer_load_dwordx4 v[76:79], v21, s[32:35], s70 offen offset:3072 nt
  s_add_u32 s70, s70, 16384
  s_waitcnt vmcnt(15)
  v_dot2_f32_bf16 v36, v80, v24, 0
  v_dot2_f32_bf16 v36, v81, v25, v36
  v_dot2_f32_bf16 v36, v82, v26, v36
  v_dot2_f32_bf16 v36, v83, v27, v36
  buffer_load_dwordx4 v[80:83], v21, s[32:35], s70 offen offset:0 nt
  s_waitcnt vmcnt(15)
  v_dot2_f32_bf16 v37, v84, v24, 0
  v_dot2_f32_bf16 v37, v85, v25, v37
  v_dot2_f32_bf16 v37, v86, v26, v37
  v_dot2_f32_bf16 v37, v87, v27, v37
  buffer_load_dwordx4 v[84:87], v21, s[32:35], s70 offen offset:1024 nt
  s_waitcnt vmcnt(15)
  v_dot2_f32_bf16 v38, v88, v24, 0
  v_dot2_f32_bf16 v38, v89, v25, v38
  v_dot2_f32_bf16 v38, v90, v26, v38
  v_dot2_f32_bf16 v38, v91, v27, v38
  buffer_load_dwordx4 v[88:91], v21, s[32:35], s70 offen offset:2048 nt
  s_waitcnt vmcnt(15)
  v_dot2_f32_bf16 v39, v92, v24, 0
  v_dot2_f32_bf16 v39, v93, v25, v39
  v_dot2_f32_bf16 v39, v94, v26, v39
  v_dot2_f32_bf16 v39, v95, v27, v39
  buffer_load_dwordx4 v[92:95], v21, s[32:35], s70 offen offset:3072 nt
  s_add_u32 s70, s70, 16384
  s_waitcnt vmcnt(15)
  v_dot2_f32_bf16 v40, v96, v24, 0
  v_dot2_f32_bf16 v40, v97, v25, v40
  v_dot2_f32_bf16 v40, v98, v26, v40
  v_dot2_f32_bf16 v40, v99, v27, v40
  buffer_load_dwordx4 v[96:99], v21, s[32:35], s70 offen offset:0 nt
  s_waitcnt vmcnt(15)
  v_dot2_f32_bf16 v41, v100, v24, 0
  v_dot2_f32_bf16 v41, v101, v25, v41
  v_dot2_f32_bf16 v41, v102, v26, v41
  v_dot2_f32_bf16 v41, v103, v27, v41
  buffer_load_dwordx4 v[100:103], v21, s[32:35], s70 offen offset:1024 nt
  s_waitcnt vmcnt(15)
  v_dot2_f32_bf16 v42, v104, v24, 0
  v_dot2_f32_bf16 v42, v105, v25, v42
  v_dot2_f32_bf16 v42, v106, v26, v42
  v_dot2_f32_bf16 v42, v107, v27, v42
  buffer_load_dwordx4 v[104:107], v21, s[32:35], s70 offen offset:2048 nt
  s_waitcnt vmcnt(15)
  v_dot2_f32_bf16 v43, v108, v24, 0
  v_dot2_f32_bf16 v43, v109, v25, v43
  v_dot2_f32_bf16 v43, v110, v26, v43
  v_dot2_f32_bf16 v43, v111, v27, v43
  buffer_load_dwordx4 v[108:111], v21, s[32:35], s70 offen offset:3072 nt
  s_add_u32 s70, s70, 16384
  s_waitcnt vmcnt(15)
  v_dot2_f32_bf16 v44, v112, v24, 0
  v_dot2_f32_bf16 v44, v113, v25, v44
  v_dot2_f32_bf16 v44, v114, v26, v44
  v_dot2_f32_bf16 v44, v115, v27, v44
  buffer_load_dwordx4 v[112:115], v21, s[32:35], s70 offen offset:0 nt
  s_waitcnt vmcnt(15)
  v_dot2_f32_bf16 v45, v116, v24, 0
  v_dot2_f32_bf16 v45, v117, v25, v45
  v_dot2_f32_bf16 v45, v118, v26, v45
  v_dot2_f32_bf16 v45, v119, v27, v45
  buffer_load_dwordx4 v[116:119], v21, s[32:35], s70 offen offset:1024 nt
  s_waitcnt vmcnt(15)
  v_dot2_f32_bf16 v46, v120, v24, 0
  v_dot2_f32_bf16 v46, v121, v25, v46
  v_dot2_f32_bf16 v46, v122, v26, v46
  v_dot2_f32_bf16 v46, v123, v27, v46
  buffer_load_dwordx4 v[120:123], v21, s[32:35], s70 offen offset:2048 nt
  s_waitcnt vmcnt(15)
  v_dot2_f32_bf16 v47, v124, v24, 0
  v_dot2_f32_bf16 v47, v125, v25, v47
  v_dot2_f32_bf16 v47, v126, v26, v47
  v_dot2_f32_bf16 v47, v127, v27, v47
  buffer_load_dwordx4 v[124:127], v21, s[32:35], s70 offen offset:3072 nt
  s_add_u32 s70, s70, 16384
  s_nop 2
  v_add_f32_dpp v32, v32, v32 row_ror:8 row_mask:0xf bank_mask:0x3
  v_add_f32_dpp v32, v33, v33 row_ror:8 row_mask:0xf bank_mask:0xc
  v_add_f32_dpp v34, v34, v34 row_ror:8 row_mask:0xf bank_mask:0x3
  v_add_f32_dpp v34, v35, v35 row_ror:8 row_mask:0xf bank_mask:0xc
  v_add_f32_dpp v36, v36, v36 row_ror:8 row_mask:0xf bank_mask:0x3
  v_add_f32_dpp v36, v37, v37 row_ror:8 row_mask:0xf bank_mask:0xc
  v_add_f32_dpp v38, v38, v38 row_ror:8 row_mask:0xf bank_mask:0x3
  v_add_f32_dpp v38, v39, v39 row_ror:8 row_mask:0xf bank_mask:0xc
  v_add_f32_dpp v40, v40, v40 row_ror:8 row_mask:0xf bank_mask:0x3
  v_add_f32_dpp v40, v41, v41 row_ror:8 row_mask:0xf bank_mask:0xc
  v_add_f32_dpp v42, v42, v42 row_ror:8 row_mask:0xf bank_mask:0x3
  v_add_f32_dpp v42, v43, v43 row_ror:8 row_mask:0xf bank_mask:0xc
  v_add_f32_dpp v44, v44, v44 row_ror:8 row_mask:0xf bank_mask:0x3
  v_add_f32_dpp v44, v45, v45 row_ror:8 row_mask:0xf bank_mask:0xc
  v_add_f32_dpp v46, v46, v46 row_ror:8 row_mask:0xf bank_mask:0x3
  v_add_f32_dpp v46, v47, v47 row_ror:8 row_mask:0xf bank_mask:0xc
  v_add_f32_dpp v32, v32, v32 row_shl:4 row_mask:0xf bank_mask:0x5
  v_add_f32_dpp v32, v34, v34 row_shr:4 row_mask:0xf bank_mask:0xa
  v_add_f32_dpp v36, v36, v36 row_shl:4 row_mask:0xf bank_mask:0x5
  v_add_f32_dpp v36, v38, v38 row_shr:4 row_mask:0xf bank_mask:0xa
  v_add_f32_dpp v40, v40, v40 row_shl:4 row_mask:0xf bank_mask:0x5
  v_add_f32_dpp v40, v42, v42 row_shr:4 row_mask:0xf bank_mask:0xa
  v_add_f32_dpp v44, v44, v44 row_shl:4 row_mask:0xf bank_mask:0x5
  v_add_f32_dpp v44, v46, v46 row_shr:4 row_mask:0xf bank_mask:0xa
  s_nop 0
  v_add_f32_dpp v32, v32, v32 quad_perm:[1,0,3,2] row_mask:0xf bank_mask:0xf
  v_add_f32_dpp v36, v36, v36 quad_perm:[1,0,3,2] row_mask:0xf bank_mask:0xf
  v_add_f32_dpp v40, v40, v40 quad_perm:[1,0,3,2] row_mask:0xf bank_mask:0xf
  v_add_f32_dpp v44, v44, v44 quad_perm:[1,0,3,2] row_mask:0xf bank_mask:0xf
  v_cndmask_b32 v32, v32, v36, s[80:81]
  v_cndmask_b32 v40, v40, v44, s[80:81]
  s_nop 0
  v_add_f32_dpp v32, v32, v32 quad_perm:[2,3,0,1] row_mask:0xf bank_mask:0xf
  v_add_f32_dpp v40, v40, v40 quad_perm:[2,3,0,1] row_mask:0xf bank_mask:0xf
  v_cndmask_b32 v14, v32, v40, s[82:83]
  v_cvt_pk_bf16_f32 v14, v14, v14
  v_lshlrev_b32 v14, 16, v14
  v_mul_f32 v14, 0x3db504f3, v14
  v_cvt_pk_bf16_f32 v14, v14, v14
  v_lshlrev_b32 v14, 16, v14
  v_max_f32 v63, v63, v14
  ds_write_b32 v23, v14 offset:1792
  s_waitcnt vmcnt(15)
  v_dot2_f32_bf16 v32, v64, v24, 0
  v_dot2_f32_bf16 v32, v65, v25, v32
  v_dot2_f32_bf16 v32, v66, v26, v32
  v_dot2_f32_bf16 v32, v67, v27, v32
  buffer_load_dwordx4 v[64:67], v21, s[32:35], s70 offen offset:0 nt
  s_waitcnt vmcnt(15)
  v_dot2_f32_bf16 v33, v68, v24, 0
  v_dot2_f32_bf16 v33, v69, v25, v33
  v_dot2_f32_bf16 v33, v70, v26, v33
  v_dot2_f32_bf16 v33, v71, v27, v33
  buffer_load_dwordx4 v[68:71], v21, s[32:35], s70 offen offset:1024 nt
  s_waitcnt vmcnt(15)
  v_dot2_f32_bf16 v34, v72, v24, 0
  v_dot2_f32_bf16 v34, v73, v25, v34
  v_dot2_f32_bf16 v34, v74, v26, v34
  v_dot2_f32_bf16 v34, v75, v27, v34
  buffer_load_dwordx4 v[72:75], v21, s[32:35], s70 offen offset:2048 nt
  s_waitcnt vmcnt(15)
  v_dot2_f32_bf16 v35, v76, v24, 0
  v_dot2_f32_bf16 v35, v77, v25, v35
  v_dot2_f32_bf16 v35, v78, v26, v35
  v_dot2_f32_bf16 v35, v79, v27, v35
  buffer_load_dwordx4 v[76:79], v21, s[32:35], s70 offen offset:3072 nt
  s_add_u32 s70, s70, 16384
  s_waitcnt vmcnt(15)
  v_dot2_f32_bf16 v36, v80, v24, 0
  v_dot2_f32_bf16 v36, v81, v25, v36
  v_dot2_f32_bf16 v36, v82, v26, v36
  v_dot2_f32_bf16 v36, v83, v27, v36
  buffer_load_dwordx4 v[80:83], v21, s[32:35], s70 offen offset:0 nt
  s_waitcnt vmcnt(15)
  v_dot2_f32_bf16 v37, v84, v24, 0
  v_dot2_f32_bf16 v37, v85, v25, v37
  v_dot2_f32_bf16 v37, v86, v26, v37
  v_dot2_f32_bf16 v37, v87, v27, v37
  buffer_load_dwordx4 v[84:87], v21, s[32:35], s70 offen offset:1024 nt
  s_waitcnt vmcnt(15)
  v_dot2_f32_bf16 v38, v88, v24, 0
  v_dot2_f32_bf16 v38, v89, v25, v38
  v_dot2_f32_bf16 v38, v90, v26, v38
  v_dot2_f32_bf16 v38, v91, v27, v38
  buffer_load_dwordx4 v[88:91], v21, s[32:35], s70 offen offset:2048 nt
  s_waitcnt vmcnt(15)
  v_dot2_f32_bf16 v39, v92, v24, 0
  v_dot2_f32_bf16 v39, v93, v25, v39
  v_dot2_f32_bf16 v39, v94, v26, v39
  v_dot2_f32_bf16 v39, v95, v27, v39
  buffer_load_dwordx4 v[92:95], v21, s[32:35], s70 offen offset:3072 nt
  s_add_u32 s70, s70, 16384
  s_waitcnt vmcnt(15)
  v_dot2_f32_bf16 v40, v96, v24, 0
  v_dot2_f32_bf16 v40, v97, v25, v40
  v_dot2_f32_bf16 v40, v98, v26, v40
  v_dot2_f32_bf16 v40, v99, v27, v40
  buffer_load_dwordx4 v[96:99], v21, s[32:35], s70 offen offset:0 nt
  s_waitcnt vmcnt(15)
  v_dot2_f32_bf16 v41, v100, v24, 0
  v_dot2_f32_bf16 v41, v101, v25, v41
  v_dot2_f32_bf16 v41, v102, v26, v41
  v_dot2_f32_bf16 v41, v103, v27, v41
  buffer_load_dwordx4 v[100:103], v21, s[32:35], s70 offen offset:1024 nt
  s_waitcnt vmcnt(15)
  v_dot2_f32_bf16 v42, v104, v24, 0
  v_dot2_f32_bf16 v42, v105, v25, v42
  v_dot2_f32_bf16 v42, v106, v26, v42
  v_dot2_f32_bf16 v42, v107, v27, v42
  buffer_load_dwordx4 v[104:107], v21, s[32:35], s70 offen offset:2048 nt
  s_waitcnt vmcnt(15)
  v_dot2_f32_bf16 v43, v108, v24, 0
  v_dot2_f32_bf16 v43, v109, v25, v43
  v_dot2_f32_bf16 v43, v110, v26, v43
  v_dot2_f32_bf16 v43, v111, v27, v43
  buffer_load_dwordx4 v[108:111], v21, s[32:35], s70 offen offset:3072 nt
  s_add_u32 s70, s70, 16384
  s_waitcnt vmcnt(15)
  v_dot2_f32_bf16 v44, v112, v24, 0
  v_dot2_f32_bf16 v44, v113, v25, v44
  v_dot2_f32_bf16 v44, v114, v26, v44
  v_dot2_f32_bf16 v44, v115, v27, v44
  buffer_load_dwordx4 v[112:115], v21, s[32:35], s70 offen offset:0 nt
  s_waitcnt vmcnt(15)
  v_dot2_f32_bf16 v45, v116, v24, 0
  v_dot2_f32_bf16 v45, v117, v25, v45
  v_dot2_f32_bf16 v45, v118, v26, v45
  v_dot2_f32_bf16 v45, v119, v27, v45
  buffer_load_dwordx4 v[116:119], v21, s[32:35], s70 offen offset:1024 nt
  s_waitcnt vmcnt(15)
  v_dot2_f32_bf16 v46, v120, v24, 0
  v_dot2_f32_bf16 v46, v121, v25, v46
  v_dot2_f32_bf16 v46, v122, v26, v46
  v_dot2_f32_bf16 v46, v123, v27, v46
  buffer_load_dwordx4 v[120:123], v21, s[32:35], s70 offen offset:2048 nt
  s_waitcnt vmcnt(15)
  v_dot2_f32_bf16 v47, v124, v24, 0
  v_dot2_f32_bf16 v47, v125, v25, v47
  v_dot2_f32_bf16 v47, v126, v26, v47
  v_dot2_f32_bf16 v47, v127, v27, v47
  buffer_load_dwordx4 v[124:127], v21, s[32:35], s70 offen offset:3072 nt
  s_add_u32 s70, s70, 16384
  s_nop 2
  v_add_f32_dpp v32, v32, v32 row_ror:8 row_mask:0xf bank_mask:0x3
  v_add_f32_dpp v32, v33, v33 row_ror:8 row_mask:0xf bank_mask:0xc
  v_add_f32_dpp v34, v34, v34 row_ror:8 row_mask:0xf bank_mask:0x3
  v_add_f32_dpp v34, v35, v35 row_ror:8 row_mask:0xf bank_mask:0xc
  v_add_f32_dpp v36, v36, v36 row_ror:8 row_mask:0xf bank_mask:0x3
  v_add_f32_dpp v36, v37, v37 row_ror:8 row_mask:0xf bank_mask:0xc
  v_add_f32_dpp v38, v38, v38 row_ror:8 row_mask:0xf bank_mask:0x3
  v_add_f32_dpp v38, v39, v39 row_ror:8 row_mask:0xf bank_mask:0xc
  v_add_f32_dpp v40, v40, v40 row_ror:8 row_mask:0xf bank_mask:0x3
  v_add_f32_dpp v40, v41, v41 row_ror:8 row_mask:0xf bank_mask:0xc
  v_add_f32_dpp v42, v42, v42 row_ror:8 row_mask:0xf bank_mask:0x3
  v_add_f32_dpp v42, v43, v43 row_ror:8 row_mask:0xf bank_mask:0xc
  v_add_f32_dpp v44, v44, v44 row_ror:8 row_mask:0xf bank_mask:0x3
  v_add_f32_dpp v44, v45, v45 row_ror:8 row_mask:0xf bank_mask:0xc
  v_add_f32_dpp v46, v46, v46 row_ror:8 row_mask:0xf bank_mask:0x3
  v_add_f32_dpp v46, v47, v47 row_ror:8 row_mask:0xf bank_mask:0xc
  v_add_f32_dpp v32, v32, v32 row_shl:4 row_mask:0xf bank_mask:0x5
  v_add_f32_dpp v32, v34, v34 row_shr:4 row_mask:0xf bank_mask:0xa
  v_add_f32_dpp v36, v36, v36 row_shl:4 row_mask:0xf bank_mask:0x5
  v_add_f32_dpp v36, v38, v38 row_shr:4 row_mask:0xf bank_mask:0xa
  v_add_f32_dpp v40, v40, v40 row_shl:4 row_mask:0xf bank_mask:0x5
  v_add_f32_dpp v40, v42, v42 row_shr:4 row_mask:0xf bank_mask:0xa
  v_add_f32_dpp v44, v44, v44 row_shl:4 row_mask:0xf bank_mask:0x5
  v_add_f32_dpp v44, v46, v46 row_shr:4 row_mask:0xf bank_mask:0xa
  s_nop 0
  v_add_f32_dpp v32, v32, v32 quad_perm:[1,0,3,2] row_mask:0xf bank_mask:0xf
  v_add_f32_dpp v36, v36, v36 quad_perm:[1,0,3,2] row_mask:0xf bank_mask:0xf
  v_add_f32_dpp v40, v40, v40 quad_perm:[1,0,3,2] row_mask:0xf bank_mask:0xf
  v_add_f32_dpp v44, v44, v44 quad_perm:[1,0,3,2] row_mask:0xf bank_mask:0xf
  v_cndmask_b32 v32, v32, v36, s[80:81]
  v_cndmask_b32 v40, v40, v44, s[80:81]
  s_nop 0
  v_add_f32_dpp v32, v32, v32 quad_perm:[2,3,0,1] row_mask:0xf bank_mask:0xf
  v_add_f32_dpp v40, v40, v40 quad_perm:[2,3,0,1] row_mask:0xf bank_mask:0xf
  v_cndmask_b32 v14, v32, v40, s[82:83]
  v_cvt_pk_bf16_f32 v14, v14, v14
  v_lshlrev_b32 v14, 16, v14
  v_mul_f32 v14, 0x3db504f3, v14
  v_cvt_pk_bf16_f32 v14, v14, v14
  v_lshlrev_b32 v14, 16, v14
  v_max_f32 v63, v63, v14
  ds_write_b32 v23, v14 offset:2048
  s_waitcnt vmcnt(15)
  v_dot2_f32_bf16 v32, v64, v24, 0
  v_dot2_f32_bf16 v32, v65, v25, v32
  v_dot2_f32_bf16 v32, v66, v26, v32
  v_dot2_f32_bf16 v32, v67, v27, v32
  buffer_load_dwordx4 v[64:67], v21, s[32:35], s70 offen offset:0 nt
  s_waitcnt vmcnt(15)
  v_dot2_f32_bf16 v33, v68, v24, 0
  v_dot2_f32_bf16 v33, v69, v25, v33
  v_dot2_f32_bf16 v33, v70, v26, v33
  v_dot2_f32_bf16 v33, v71, v27, v33
  buffer_load_dwordx4 v[68:71], v21, s[32:35], s70 offen offset:1024 nt
  s_waitcnt vmcnt(15)
  v_dot2_f32_bf16 v34, v72, v24, 0
  v_dot2_f32_bf16 v34, v73, v25, v34
  v_dot2_f32_bf16 v34, v74, v26, v34
  v_dot2_f32_bf16 v34, v75, v27, v34
  buffer_load_dwordx4 v[72:75], v21, s[32:35], s70 offen offset:2048 nt
  s_waitcnt vmcnt(15)
  v_dot2_f32_bf16 v35, v76, v24, 0
  v_dot2_f32_bf16 v35, v77, v25, v35
  v_dot2_f32_bf16 v35, v78, v26, v35
  v_dot2_f32_bf16 v35, v79, v27, v35
  buffer_load_dwordx4 v[76:79], v21, s[32:35], s70 offen offset:3072 nt
  s_add_u32 s70, s70, 16384
  s_waitcnt vmcnt(15)
  v_dot2_f32_bf16 v36, v80, v24, 0
  v_dot2_f32_bf16 v36, v81, v25, v36
  v_dot2_f32_bf16 v36, v82, v26, v36
  v_dot2_f32_bf16 v36, v83, v27, v36
  buffer_load_dwordx4 v[80:83], v21, s[32:35], s70 offen offset:0 nt
  s_waitcnt vmcnt(15)
  v_dot2_f32_bf16 v37, v84, v24, 0
  v_dot2_f32_bf16 v37, v85, v25, v37
  v_dot2_f32_bf16 v37, v86, v26, v37
  v_dot2_f32_bf16 v37, v87, v27, v37
  buffer_load_dwordx4 v[84:87], v21, s[32:35], s70 offen offset:1024 nt
  s_waitcnt vmcnt(15)
  v_dot2_f32_bf16 v38, v88, v24, 0
  v_dot2_f32_bf16 v38, v89, v25, v38
  v_dot2_f32_bf16 v38, v90, v26, v38
  v_dot2_f32_bf16 v38, v91, v27, v38
  buffer_load_dwordx4 v[88:91], v21, s[32:35], s70 offen offset:2048 nt
  s_waitcnt vmcnt(15)
  v_dot2_f32_bf16 v39, v92, v24, 0
  v_dot2_f32_bf16 v39, v93, v25, v39
  v_dot2_f32_bf16 v39, v94, v26, v39
  v_dot2_f32_bf16 v39, v95, v27, v39
  buffer_load_dwordx4 v[92:95], v21, s[32:35], s70 offen offset:3072 nt
  s_add_u32 s70, s70, 16384
  s_waitcnt vmcnt(15)
  v_dot2_f32_bf16 v40, v96, v24, 0
  v_dot2_f32_bf16 v40, v97, v25, v40
  v_dot2_f32_bf16 v40, v98, v26, v40
  v_dot2_f32_bf16 v40, v99, v27, v40
  buffer_load_dwordx4 v[96:99], v21, s[32:35], s70 offen offset:0 nt
  s_waitcnt vmcnt(15)
  v_dot2_f32_bf16 v41, v100, v24, 0
  v_dot2_f32_bf16 v41, v101, v25, v41
  v_dot2_f32_bf16 v41, v102, v26, v41
  v_dot2_f32_bf16 v41, v103, v27, v41
  buffer_load_dwordx4 v[100:103], v21, s[32:35], s70 offen offset:1024 nt
  s_waitcnt vmcnt(15)
  v_dot2_f32_bf16 v42, v104, v24, 0
  v_dot2_f32_bf16 v42, v105, v25, v42
  v_dot2_f32_bf16 v42, v106, v26, v42
  v_dot2_f32_bf16 v42, v107, v27, v42
  buffer_load_dwordx4 v[104:107], v21, s[32:35], s70 offen offset:2048 nt
  s_waitcnt vmcnt(15)
  v_dot2_f32_bf16 v43, v108, v24, 0
  v_dot2_f32_bf16 v43, v109, v25, v43
  v_dot2_f32_bf16 v43, v110, v26, v43
  v_dot2_f32_bf16 v43, v111, v27, v43
  buffer_load_dwordx4 v[108:111], v21, s[32:35], s70 offen offset:3072 nt
  s_add_u32 s70, s70, 16384
  s_waitcnt vmcnt(15)
  v_dot2_f32_bf16 v44, v112, v24, 0
  v_dot2_f32_bf16 v44, v113, v25, v44
  v_dot2_f32_bf16 v44, v114, v26, v44
  v_dot2_f32_bf16 v44, v115, v27, v44
  buffer_load_dwordx4 v[112:115], v21, s[32:35], s70 offen offset:0 nt
  s_waitcnt vmcnt(15)
  v_dot2_f32_bf16 v45, v116, v24, 0
  v_dot2_f32_bf16 v45, v117, v25, v45
  v_dot2_f32_bf16 v45, v118, v26, v45
  v_dot2_f32_bf16 v45, v119, v27, v45
  buffer_load_dwordx4 v[116:119], v21, s[32:35], s70 offen offset:1024 nt
  s_waitcnt vmcnt(15)
  v_dot2_f32_bf16 v46, v120, v24, 0
  v_dot2_f32_bf16 v46, v121, v25, v46
  v_dot2_f32_bf16 v46, v122, v26, v46
  v_dot2_f32_bf16 v46, v123, v27, v46
  buffer_load_dwordx4 v[120:123], v21, s[32:35], s70 offen offset:2048 nt
  s_waitcnt vmcnt(15)
  v_dot2_f32_bf16 v47, v124, v24, 0
  v_dot2_f32_bf16 v47, v125, v25, v47
  v_dot2_f32_bf16 v47, v126, v26, v47
  v_dot2_f32_bf16 v47, v127, v27, v47
  buffer_load_dwordx4 v[124:127], v21, s[32:35], s70 offen offset:3072 nt
  s_add_u32 s70, s70, 16384
  s_nop 2
  v_add_f32_dpp v32, v32, v32 row_ror:8 row_mask:0xf bank_mask:0x3
  v_add_f32_dpp v32, v33, v33 row_ror:8 row_mask:0xf bank_mask:0xc
  v_add_f32_dpp v34, v34, v34 row_ror:8 row_mask:0xf bank_mask:0x3
  v_add_f32_dpp v34, v35, v35 row_ror:8 row_mask:0xf bank_mask:0xc
  v_add_f32_dpp v36, v36, v36 row_ror:8 row_mask:0xf bank_mask:0x3
  v_add_f32_dpp v36, v37, v37 row_ror:8 row_mask:0xf bank_mask:0xc
  v_add_f32_dpp v38, v38, v38 row_ror:8 row_mask:0xf bank_mask:0x3
  v_add_f32_dpp v38, v39, v39 row_ror:8 row_mask:0xf bank_mask:0xc
  v_add_f32_dpp v40, v40, v40 row_ror:8 row_mask:0xf bank_mask:0x3
  v_add_f32_dpp v40, v41, v41 row_ror:8 row_mask:0xf bank_mask:0xc
  v_add_f32_dpp v42, v42, v42 row_ror:8 row_mask:0xf bank_mask:0x3
  v_add_f32_dpp v42, v43, v43 row_ror:8 row_mask:0xf bank_mask:0xc
  v_add_f32_dpp v44, v44, v44 row_ror:8 row_mask:0xf bank_mask:0x3
  v_add_f32_dpp v44, v45, v45 row_ror:8 row_mask:0xf bank_mask:0xc
  v_add_f32_dpp v46, v46, v46 row_ror:8 row_mask:0xf bank_mask:0x3
  v_add_f32_dpp v46, v47, v47 row_ror:8 row_mask:0xf bank_mask:0xc
  v_add_f32_dpp v32, v32, v32 row_shl:4 row_mask:0xf bank_mask:0x5
  v_add_f32_dpp v32, v34, v34 row_shr:4 row_mask:0xf bank_mask:0xa
  v_add_f32_dpp v36, v36, v36 row_shl:4 row_mask:0xf bank_mask:0x5
  v_add_f32_dpp v36, v38, v38 row_shr:4 row_mask:0xf bank_mask:0xa
  v_add_f32_dpp v40, v40, v40 row_shl:4 row_mask:0xf bank_mask:0x5
  v_add_f32_dpp v40, v42, v42 row_shr:4 row_mask:0xf bank_mask:0xa
  v_add_f32_dpp v44, v44, v44 row_shl:4 row_mask:0xf bank_mask:0x5
  v_add_f32_dpp v44, v46, v46 row_shr:4 row_mask:0xf bank_mask:0xa
  s_nop 0
  v_add_f32_dpp v32, v32, v32 quad_perm:[1,0,3,2] row_mask:0xf bank_mask:0xf
  v_add_f32_dpp v36, v36, v36 quad_perm:[1,0,3,2] row_mask:0xf bank_mask:0xf
  v_add_f32_dpp v40, v40, v40 quad_perm:[1,0,3,2] row_mask:0xf bank_mask:0xf
  v_add_f32_dpp v44, v44, v44 quad_perm:[1,0,3,2] row_mask:0xf bank_mask:0xf
  v_cndmask_b32 v32, v32, v36, s[80:81]
  v_cndmask_b32 v40, v40, v44, s[80:81]
  s_nop 0
  v_add_f32_dpp v32, v32, v32 quad_perm:[2,3,0,1] row_mask:0xf bank_mask:0xf
  v_add_f32_dpp v40, v40, v40 quad_perm:[2,3,0,1] row_mask:0xf bank_mask:0xf
  v_cndmask_b32 v14, v32, v40, s[82:83]
  v_cvt_pk_bf16_f32 v14, v14, v14
  v_lshlrev_b32 v14, 16, v14
  v_mul_f32 v14, 0x3db504f3, v14
  v_cvt_pk_bf16_f32 v14, v14, v14
  v_lshlrev_b32 v14, 16, v14
  v_max_f32 v63, v63, v14
  ds_write_b32 v23, v14 offset:2304
  s_waitcnt vmcnt(15)
  v_dot2_f32_bf16 v32, v64, v24, 0
  v_dot2_f32_bf16 v32, v65, v25, v32
  v_dot2_f32_bf16 v32, v66, v26, v32
  v_dot2_f32_bf16 v32, v67, v27, v32
  buffer_load_dwordx4 v[64:67], v21, s[32:35], s70 offen offset:0 nt
  s_waitcnt vmcnt(15)
  v_dot2_f32_bf16 v33, v68, v24, 0
  v_dot2_f32_bf16 v33, v69, v25, v33
  v_dot2_f32_bf16 v33, v70, v26, v33
  v_dot2_f32_bf16 v33, v71, v27, v33
  buffer_load_dwordx4 v[68:71], v21, s[32:35], s70 offen offset:1024 nt
  s_waitcnt vmcnt(15)
  v_dot2_f32_bf16 v34, v72, v24, 0
  v_dot2_f32_bf16 v34, v73, v25, v34
  v_dot2_f32_bf16 v34, v74, v26, v34
  v_dot2_f32_bf16 v34, v75, v27, v34
  buffer_load_dwordx4 v[72:75], v21, s[32:35], s70 offen offset:2048 nt
  s_waitcnt vmcnt(15)
  v_dot2_f32_bf16 v35, v76, v24, 0
  v_dot2_f32_bf16 v35, v77, v25, v35
  v_dot2_f32_bf16 v35, v78, v26, v35
  v_dot2_f32_bf16 v35, v79, v27, v35
  buffer_load_dwordx4 v[76:79], v21, s[32:35], s70 offen offset:3072 nt
  s_add_u32 s70, s70, 16384
  s_waitcnt vmcnt(15)
  v_dot2_f32_bf16 v36, v80, v24, 0
  v_dot2_f32_bf16 v36, v81, v25, v36
  v_dot2_f32_bf16 v36, v82, v26, v36
  v_dot2_f32_bf16 v36, v83, v27, v36
  buffer_load_dwordx4 v[80:83], v21, s[32:35], s70 offen offset:0 nt
  s_waitcnt vmcnt(15)
  v_dot2_f32_bf16 v37, v84, v24, 0
  v_dot2_f32_bf16 v37, v85, v25, v37
  v_dot2_f32_bf16 v37, v86, v26, v37
  v_dot2_f32_bf16 v37, v87, v27, v37
  buffer_load_dwordx4 v[84:87], v21, s[32:35], s70 offen offset:1024 nt
  s_waitcnt vmcnt(15)
  v_dot2_f32_bf16 v38, v88, v24, 0
  v_dot2_f32_bf16 v38, v89, v25, v38
  v_dot2_f32_bf16 v38, v90, v26, v38
  v_dot2_f32_bf16 v38, v91, v27, v38
  buffer_load_dwordx4 v[88:91], v21, s[32:35], s70 offen offset:2048 nt
  s_waitcnt vmcnt(15)
  v_dot2_f32_bf16 v39, v92, v24, 0
  v_dot2_f32_bf16 v39, v93, v25, v39
  v_dot2_f32_bf16 v39, v94, v26, v39
  v_dot2_f32_bf16 v39, v95, v27, v39
  buffer_load_dwordx4 v[92:95], v21, s[32:35], s70 offen offset:3072 nt
  s_add_u32 s70, s70, 16384
  s_waitcnt vmcnt(15)
  v_dot2_f32_bf16 v40, v96, v24, 0
  v_dot2_f32_bf16 v40, v97, v25, v40
  v_dot2_f32_bf16 v40, v98, v26, v40
  v_dot2_f32_bf16 v40, v99, v27, v40
  buffer_load_dwordx4 v[96:99], v21, s[32:35], s70 offen offset:0 nt
  s_waitcnt vmcnt(15)
  v_dot2_f32_bf16 v41, v100, v24, 0
  v_dot2_f32_bf16 v41, v101, v25, v41
  v_dot2_f32_bf16 v41, v102, v26, v41
  v_dot2_f32_bf16 v41, v103, v27, v41
  buffer_load_dwordx4 v[100:103], v21, s[32:35], s70 offen offset:1024 nt
  s_waitcnt vmcnt(15)
  v_dot2_f32_bf16 v42, v104, v24, 0
  v_dot2_f32_bf16 v42, v105, v25, v42
  v_dot2_f32_bf16 v42, v106, v26, v42
  v_dot2_f32_bf16 v42, v107, v27, v42
  buffer_load_dwordx4 v[104:107], v21, s[32:35], s70 offen offset:2048 nt
  s_waitcnt vmcnt(15)
  v_dot2_f32_bf16 v43, v108, v24, 0
  v_dot2_f32_bf16 v43, v109, v25, v43
  v_dot2_f32_bf16 v43, v110, v26, v43
  v_dot2_f32_bf16 v43, v111, v27, v43
  buffer_load_dwordx4 v[108:111], v21, s[32:35], s70 offen offset:3072 nt
  s_add_u32 s70, s70, 16384
  s_waitcnt vmcnt(15)
  v_dot2_f32_bf16 v44, v112, v24, 0
  v_dot2_f32_bf16 v44, v113, v25, v44
  v_dot2_f32_bf16 v44, v114, v26, v44
  v_dot2_f32_bf16 v44, v115, v27, v44
  buffer_load_dwordx4 v[112:115], v21, s[32:35], s70 offen offset:0 nt
  s_waitcnt vmcnt(15)
  v_dot2_f32_bf16 v45, v116, v24, 0
  v_dot2_f32_bf16 v45, v117, v25, v45
  v_dot2_f32_bf16 v45, v118, v26, v45
  v_dot2_f32_bf16 v45, v119, v27, v45
  buffer_load_dwordx4 v[116:119], v21, s[32:35], s70 offen offset:1024 nt
  s_waitcnt vmcnt(15)
  v_dot2_f32_bf16 v46, v120, v24, 0
  v_dot2_f32_bf16 v46, v121, v25, v46
  v_dot2_f32_bf16 v46, v122, v26, v46
  v_dot2_f32_bf16 v46, v123, v27, v46
  buffer_load_dwordx4 v[120:123], v21, s[32:35], s70 offen offset:2048 nt
  s_waitcnt vmcnt(15)
  v_dot2_f32_bf16 v47, v124, v24, 0
  v_dot2_f32_bf16 v47, v125, v25, v47
  v_dot2_f32_bf16 v47, v126, v26, v47
  v_dot2_f32_bf16 v47, v127, v27, v47
  buffer_load_dwordx4 v[124:127], v21, s[32:35], s70 offen offset:3072 nt
  s_add_u32 s70, s70, 16384
  s_nop 2
  v_add_f32_dpp v32, v32, v32 row_ror:8 row_mask:0xf bank_mask:0x3
  v_add_f32_dpp v32, v33, v33 row_ror:8 row_mask:0xf bank_mask:0xc
  v_add_f32_dpp v34, v34, v34 row_ror:8 row_mask:0xf bank_mask:0x3
  v_add_f32_dpp v34, v35, v35 row_ror:8 row_mask:0xf bank_mask:0xc
  v_add_f32_dpp v36, v36, v36 row_ror:8 row_mask:0xf bank_mask:0x3
  v_add_f32_dpp v36, v37, v37 row_ror:8 row_mask:0xf bank_mask:0xc
  v_add_f32_dpp v38, v38, v38 row_ror:8 row_mask:0xf bank_mask:0x3
  v_add_f32_dpp v38, v39, v39 row_ror:8 row_mask:0xf bank_mask:0xc
  v_add_f32_dpp v40, v40, v40 row_ror:8 row_mask:0xf bank_mask:0x3
  v_add_f32_dpp v40, v41, v41 row_ror:8 row_mask:0xf bank_mask:0xc
  v_add_f32_dpp v42, v42, v42 row_ror:8 row_mask:0xf bank_mask:0x3
  v_add_f32_dpp v42, v43, v43 row_ror:8 row_mask:0xf bank_mask:0xc
  v_add_f32_dpp v44, v44, v44 row_ror:8 row_mask:0xf bank_mask:0x3
  v_add_f32_dpp v44, v45, v45 row_ror:8 row_mask:0xf bank_mask:0xc
  v_add_f32_dpp v46, v46, v46 row_ror:8 row_mask:0xf bank_mask:0x3
  v_add_f32_dpp v46, v47, v47 row_ror:8 row_mask:0xf bank_mask:0xc
  v_add_f32_dpp v32, v32, v32 row_shl:4 row_mask:0xf bank_mask:0x5
  v_add_f32_dpp v32, v34, v34 row_shr:4 row_mask:0xf bank_mask:0xa
  v_add_f32_dpp v36, v36, v36 row_shl:4 row_mask:0xf bank_mask:0x5
  v_add_f32_dpp v36, v38, v38 row_shr:4 row_mask:0xf bank_mask:0xa
  v_add_f32_dpp v40, v40, v40 row_shl:4 row_mask:0xf bank_mask:0x5
  v_add_f32_dpp v40, v42, v42 row_shr:4 row_mask:0xf bank_mask:0xa
  v_add_f32_dpp v44, v44, v44 row_shl:4 row_mask:0xf bank_mask:0x5
  v_add_f32_dpp v44, v46, v46 row_shr:4 row_mask:0xf bank_mask:0xa
  s_nop 0
  v_add_f32_dpp v32, v32, v32 quad_perm:[1,0,3,2] row_mask:0xf bank_mask:0xf
  v_add_f32_dpp v36, v36, v36 quad_perm:[1,0,3,2] row_mask:0xf bank_mask:0xf
  v_add_f32_dpp v40, v40, v40 quad_perm:[1,0,3,2] row_mask:0xf bank_mask:0xf
  v_add_f32_dpp v44, v44, v44 quad_perm:[1,0,3,2] row_mask:0xf bank_mask:0xf
  v_cndmask_b32 v32, v32, v36, s[80:81]
  v_cndmask_b32 v40, v40, v44, s[80:81]
  s_nop 0
  v_add_f32_dpp v32, v32, v32 quad_perm:[2,3,0,1] row_mask:0xf bank_mask:0xf
  v_add_f32_dpp v40, v40, v40 quad_perm:[2,3,0,1] row_mask:0xf bank_mask:0xf
  v_cndmask_b32 v14, v32, v40, s[82:83]
  v_cvt_pk_bf16_f32 v14, v14, v14
  v_lshlrev_b32 v14, 16, v14
  v_mul_f32 v14, 0x3db504f3, v14
  v_cvt_pk_bf16_f32 v14, v14, v14
  v_lshlrev_b32 v14, 16, v14
  v_max_f32 v63, v63, v14
  ds_write_b32 v23, v14 offset:2560
  s_waitcnt vmcnt(15)
  v_dot2_f32_bf16 v32, v64, v24, 0
  v_dot2_f32_bf16 v32, v65, v25, v32
  v_dot2_f32_bf16 v32, v66, v26, v32
  v_dot2_f32_bf16 v32, v67, v27, v32
  buffer_load_dwordx4 v[64:67], v21, s[32:35], s70 offen offset:0 nt
  s_waitcnt vmcnt(15)
  v_dot2_f32_bf16 v33, v68, v24, 0
  v_dot2_f32_bf16 v33, v69, v25, v33
  v_dot2_f32_bf16 v33, v70, v26, v33
  v_dot2_f32_bf16 v33, v71, v27, v33
  buffer_load_dwordx4 v[68:71], v21, s[32:35], s70 offen offset:1024 nt
  s_waitcnt vmcnt(15)
  v_dot2_f32_bf16 v34, v72, v24, 0
  v_dot2_f32_bf16 v34, v73, v25, v34
  v_dot2_f32_bf16 v34, v74, v26, v34
  v_dot2_f32_bf16 v34, v75, v27, v34
  buffer_load_dwordx4 v[72:75], v21, s[32:35], s70 offen offset:2048 nt
  s_waitcnt vmcnt(15)
  v_dot2_f32_bf16 v35, v76, v24, 0
  v_dot2_f32_bf16 v35, v77, v25, v35
  v_dot2_f32_bf16 v35, v78, v26, v35
  v_dot2_f32_bf16 v35, v79, v27, v35
  buffer_load_dwordx4 v[76:79], v21, s[32:35], s70 offen offset:3072 nt
  s_add_u32 s70, s70, 16384
  s_waitcnt vmcnt(15)
  v_dot2_f32_bf16 v36, v80, v24, 0
  v_dot2_f32_bf16 v36, v81, v25, v36
  v_dot2_f32_bf16 v36, v82, v26, v36
  v_dot2_f32_bf16 v36, v83, v27, v36
  buffer_load_dwordx4 v[80:83], v21, s[32:35], s70 offen offset:0 nt
  s_waitcnt vmcnt(15)
  v_dot2_f32_bf16 v37, v84, v24, 0
  v_dot2_f32_bf16 v37, v85, v25, v37
  v_dot2_f32_bf16 v37, v86, v26, v37
  v_dot2_f32_bf16 v37, v87, v27, v37
  buffer_load_dwordx4 v[84:87], v21, s[32:35], s70 offen offset:1024 nt
  s_waitcnt vmcnt(15)
  v_dot2_f32_bf16 v38, v88, v24, 0
  v_dot2_f32_bf16 v38, v89, v25, v38
  v_dot2_f32_bf16 v38, v90, v26, v38
  v_dot2_f32_bf16 v38, v91, v27, v38
  buffer_load_dwordx4 v[88:91], v21, s[32:35], s70 offen offset:2048 nt
  s_waitcnt vmcnt(15)
  v_dot2_f32_bf16 v39, v92, v24, 0
  v_dot2_f32_bf16 v39, v93, v25, v39
  v_dot2_f32_bf16 v39, v94, v26, v39
  v_dot2_f32_bf16 v39, v95, v27, v39
  buffer_load_dwordx4 v[92:95], v21, s[32:35], s70 offen offset:3072 nt
  s_add_u32 s70, s70, 16384
  s_waitcnt vmcnt(15)
  v_dot2_f32_bf16 v40, v96, v24, 0
  v_dot2_f32_bf16 v40, v97, v25, v40
  v_dot2_f32_bf16 v40, v98, v26, v40
  v_dot2_f32_bf16 v40, v99, v27, v40
  buffer_load_dwordx4 v[96:99], v21, s[32:35], s70 offen offset:0 nt
  s_waitcnt vmcnt(15)
  v_dot2_f32_bf16 v41, v100, v24, 0
  v_dot2_f32_bf16 v41, v101, v25, v41
  v_dot2_f32_bf16 v41, v102, v26, v41
  v_dot2_f32_bf16 v41, v103, v27, v41
  buffer_load_dwordx4 v[100:103], v21, s[32:35], s70 offen offset:1024 nt
  s_waitcnt vmcnt(15)
  v_dot2_f32_bf16 v42, v104, v24, 0
  v_dot2_f32_bf16 v42, v105, v25, v42
  v_dot2_f32_bf16 v42, v106, v26, v42
  v_dot2_f32_bf16 v42, v107, v27, v42
  buffer_load_dwordx4 v[104:107], v21, s[32:35], s70 offen offset:2048 nt
  s_waitcnt vmcnt(15)
  v_dot2_f32_bf16 v43, v108, v24, 0
  v_dot2_f32_bf16 v43, v109, v25, v43
  v_dot2_f32_bf16 v43, v110, v26, v43
  v_dot2_f32_bf16 v43, v111, v27, v43
  buffer_load_dwordx4 v[108:111], v21, s[32:35], s70 offen offset:3072 nt
  s_add_u32 s70, s70, 16384
  s_waitcnt vmcnt(15)
  v_dot2_f32_bf16 v44, v112, v24, 0
  v_dot2_f32_bf16 v44, v113, v25, v44
  v_dot2_f32_bf16 v44, v114, v26, v44
  v_dot2_f32_bf16 v44, v115, v27, v44
  buffer_load_dwordx4 v[112:115], v21, s[32:35], s70 offen offset:0 nt
  s_waitcnt vmcnt(15)
  v_dot2_f32_bf16 v45, v116, v24, 0
  v_dot2_f32_bf16 v45, v117, v25, v45
  v_dot2_f32_bf16 v45, v118, v26, v45
  v_dot2_f32_bf16 v45, v119, v27, v45
  buffer_load_dwordx4 v[116:119], v21, s[32:35], s70 offen offset:1024 nt
  s_waitcnt vmcnt(15)
  v_dot2_f32_bf16 v46, v120, v24, 0
  v_dot2_f32_bf16 v46, v121, v25, v46
  v_dot2_f32_bf16 v46, v122, v26, v46
  v_dot2_f32_bf16 v46, v123, v27, v46
  buffer_load_dwordx4 v[120:123], v21, s[32:35], s70 offen offset:2048 nt
  s_waitcnt vmcnt(15)
  v_dot2_f32_bf16 v47, v124, v24, 0
  v_dot2_f32_bf16 v47, v125, v25, v47
  v_dot2_f32_bf16 v47, v126, v26, v47
  v_dot2_f32_bf16 v47, v127, v27, v47
  buffer_load_dwordx4 v[124:127], v21, s[32:35], s70 offen offset:3072 nt
  s_add_u32 s70, s70, 16384
  s_nop 2
  v_add_f32_dpp v32, v32, v32 row_ror:8 row_mask:0xf bank_mask:0x3
  v_add_f32_dpp v32, v33, v33 row_ror:8 row_mask:0xf bank_mask:0xc
  v_add_f32_dpp v34, v34, v34 row_ror:8 row_mask:0xf bank_mask:0x3
  v_add_f32_dpp v34, v35, v35 row_ror:8 row_mask:0xf bank_mask:0xc
  v_add_f32_dpp v36, v36, v36 row_ror:8 row_mask:0xf bank_mask:0x3
  v_add_f32_dpp v36, v37, v37 row_ror:8 row_mask:0xf bank_mask:0xc
  v_add_f32_dpp v38, v38, v38 row_ror:8 row_mask:0xf bank_mask:0x3
  v_add_f32_dpp v38, v39, v39 row_ror:8 row_mask:0xf bank_mask:0xc
  v_add_f32_dpp v40, v40, v40 row_ror:8 row_mask:0xf bank_mask:0x3
  v_add_f32_dpp v40, v41, v41 row_ror:8 row_mask:0xf bank_mask:0xc
  v_add_f32_dpp v42, v42, v42 row_ror:8 row_mask:0xf bank_mask:0x3
  v_add_f32_dpp v42, v43, v43 row_ror:8 row_mask:0xf bank_mask:0xc
  v_add_f32_dpp v44, v44, v44 row_ror:8 row_mask:0xf bank_mask:0x3
  v_add_f32_dpp v44, v45, v45 row_ror:8 row_mask:0xf bank_mask:0xc
  v_add_f32_dpp v46, v46, v46 row_ror:8 row_mask:0xf bank_mask:0x3
  v_add_f32_dpp v46, v47, v47 row_ror:8 row_mask:0xf bank_mask:0xc
  v_add_f32_dpp v32, v32, v32 row_shl:4 row_mask:0xf bank_mask:0x5
  v_add_f32_dpp v32, v34, v34 row_shr:4 row_mask:0xf bank_mask:0xa
  v_add_f32_dpp v36, v36, v36 row_shl:4 row_mask:0xf bank_mask:0x5
  v_add_f32_dpp v36, v38, v38 row_shr:4 row_mask:0xf bank_mask:0xa
  v_add_f32_dpp v40, v40, v40 row_shl:4 row_mask:0xf bank_mask:0x5
  v_add_f32_dpp v40, v42, v42 row_shr:4 row_mask:0xf bank_mask:0xa
  v_add_f32_dpp v44, v44, v44 row_shl:4 row_mask:0xf bank_mask:0x5
  v_add_f32_dpp v44, v46, v46 row_shr:4 row_mask:0xf bank_mask:0xa
  s_nop 0
  v_add_f32_dpp v32, v32, v32 quad_perm:[1,0,3,2] row_mask:0xf bank_mask:0xf
  v_add_f32_dpp v36, v36, v36 quad_perm:[1,0,3,2] row_mask:0xf bank_mask:0xf
  v_add_f32_dpp v40, v40, v40 quad_perm:[1,0,3,2] row_mask:0xf bank_mask:0xf
  v_add_f32_dpp v44, v44, v44 quad_perm:[1,0,3,2] row_mask:0xf bank_mask:0xf
  v_cndmask_b32 v32, v32, v36, s[80:81]
  v_cndmask_b32 v40, v40, v44, s[80:81]
  s_nop 0
  v_add_f32_dpp v32, v32, v32 quad_perm:[2,3,0,1] row_mask:0xf bank_mask:0xf
  v_add_f32_dpp v40, v40, v40 quad_perm:[2,3,0,1] row_mask:0xf bank_mask:0xf
  v_cndmask_b32 v14, v32, v40, s[82:83]
  v_cvt_pk_bf16_f32 v14, v14, v14
  v_lshlrev_b32 v14, 16, v14
  v_mul_f32 v14, 0x3db504f3, v14
  v_cvt_pk_bf16_f32 v14, v14, v14
  v_lshlrev_b32 v14, 16, v14
  v_max_f32 v63, v63, v14
  ds_write_b32 v23, v14 offset:2816
  s_waitcnt vmcnt(15)
  v_dot2_f32_bf16 v32, v64, v24, 0
  v_dot2_f32_bf16 v32, v65, v25, v32
  v_dot2_f32_bf16 v32, v66, v26, v32
  v_dot2_f32_bf16 v32, v67, v27, v32
  buffer_load_dwordx4 v[64:67], v21, s[32:35], s70 offen offset:0 nt
  s_waitcnt vmcnt(15)
  v_dot2_f32_bf16 v33, v68, v24, 0
  v_dot2_f32_bf16 v33, v69, v25, v33
  v_dot2_f32_bf16 v33, v70, v26, v33
  v_dot2_f32_bf16 v33, v71, v27, v33
  buffer_load_dwordx4 v[68:71], v21, s[32:35], s70 offen offset:1024 nt
  s_waitcnt vmcnt(15)
  v_dot2_f32_bf16 v34, v72, v24, 0
  v_dot2_f32_bf16 v34, v73, v25, v34
  v_dot2_f32_bf16 v34, v74, v26, v34
  v_dot2_f32_bf16 v34, v75, v27, v34
  buffer_load_dwordx4 v[72:75], v21, s[32:35], s70 offen offset:2048 nt
  s_waitcnt vmcnt(15)
  v_dot2_f32_bf16 v35, v76, v24, 0
  v_dot2_f32_bf16 v35, v77, v25, v35
  v_dot2_f32_bf16 v35, v78, v26, v35
  v_dot2_f32_bf16 v35, v79, v27, v35
  buffer_load_dwordx4 v[76:79], v21, s[32:35], s70 offen offset:3072 nt
  s_add_u32 s70, s70, 16384
  s_waitcnt vmcnt(15)
  v_dot2_f32_bf16 v36, v80, v24, 0
  v_dot2_f32_bf16 v36, v81, v25, v36
  v_dot2_f32_bf16 v36, v82, v26, v36
  v_dot2_f32_bf16 v36, v83, v27, v36
  buffer_load_dwordx4 v[80:83], v21, s[32:35], s70 offen offset:0 nt
  s_waitcnt vmcnt(15)
  v_dot2_f32_bf16 v37, v84, v24, 0
  v_dot2_f32_bf16 v37, v85, v25, v37
  v_dot2_f32_bf16 v37, v86, v26, v37
  v_dot2_f32_bf16 v37, v87, v27, v37
  buffer_load_dwordx4 v[84:87], v21, s[32:35], s70 offen offset:1024 nt
  s_waitcnt vmcnt(15)
  v_dot2_f32_bf16 v38, v88, v24, 0
  v_dot2_f32_bf16 v38, v89, v25, v38
  v_dot2_f32_bf16 v38, v90, v26, v38
  v_dot2_f32_bf16 v38, v91, v27, v38
  buffer_load_dwordx4 v[88:91], v21, s[32:35], s70 offen offset:2048 nt
  s_waitcnt vmcnt(15)
  v_dot2_f32_bf16 v39, v92, v24, 0
  v_dot2_f32_bf16 v39, v93, v25, v39
  v_dot2_f32_bf16 v39, v94, v26, v39
  v_dot2_f32_bf16 v39, v95, v27, v39
  buffer_load_dwordx4 v[92:95], v21, s[32:35], s70 offen offset:3072 nt
  s_add_u32 s70, s70, 16384
  s_waitcnt vmcnt(15)
  v_dot2_f32_bf16 v40, v96, v24, 0
  v_dot2_f32_bf16 v40, v97, v25, v40
  v_dot2_f32_bf16 v40, v98, v26, v40
  v_dot2_f32_bf16 v40, v99, v27, v40
  buffer_load_dwordx4 v[96:99], v21, s[32:35], s70 offen offset:0 nt
  s_waitcnt vmcnt(15)
  v_dot2_f32_bf16 v41, v100, v24, 0
  v_dot2_f32_bf16 v41, v101, v25, v41
  v_dot2_f32_bf16 v41, v102, v26, v41
  v_dot2_f32_bf16 v41, v103, v27, v41
  buffer_load_dwordx4 v[100:103], v21, s[32:35], s70 offen offset:1024 nt
  s_waitcnt vmcnt(15)
  v_dot2_f32_bf16 v42, v104, v24, 0
  v_dot2_f32_bf16 v42, v105, v25, v42
  v_dot2_f32_bf16 v42, v106, v26, v42
  v_dot2_f32_bf16 v42, v107, v27, v42
  buffer_load_dwordx4 v[104:107], v21, s[32:35], s70 offen offset:2048 nt
  s_waitcnt vmcnt(15)
  v_dot2_f32_bf16 v43, v108, v24, 0
  v_dot2_f32_bf16 v43, v109, v25, v43
  v_dot2_f32_bf16 v43, v110, v26, v43
  v_dot2_f32_bf16 v43, v111, v27, v43
  buffer_load_dwordx4 v[108:111], v21, s[32:35], s70 offen offset:3072 nt
  s_add_u32 s70, s70, 16384
  s_waitcnt vmcnt(15)
  v_dot2_f32_bf16 v44, v112, v24, 0
  v_dot2_f32_bf16 v44, v113, v25, v44
  v_dot2_f32_bf16 v44, v114, v26, v44
  v_dot2_f32_bf16 v44, v115, v27, v44
  buffer_load_dwordx4 v[112:115], v21, s[32:35], s70 offen offset:0 nt
  s_waitcnt vmcnt(15)
  v_dot2_f32_bf16 v45, v116, v24, 0
  v_dot2_f32_bf16 v45, v117, v25, v45
  v_dot2_f32_bf16 v45, v118, v26, v45
  v_dot2_f32_bf16 v45, v119, v27, v45
  buffer_load_dwordx4 v[116:119], v21, s[32:35], s70 offen offset:1024 nt
  s_waitcnt vmcnt(15)
  v_dot2_f32_bf16 v46, v120, v24, 0
  v_dot2_f32_bf16 v46, v121, v25, v46
  v_dot2_f32_bf16 v46, v122, v26, v46
  v_dot2_f32_bf16 v46, v123, v27, v46
  buffer_load_dwordx4 v[120:123], v21, s[32:35], s70 offen offset:2048 nt
  s_waitcnt vmcnt(15)
  v_dot2_f32_bf16 v47, v124, v24, 0
  v_dot2_f32_bf16 v47, v125, v25, v47
  v_dot2_f32_bf16 v47, v126, v26, v47
  v_dot2_f32_bf16 v47, v127, v27, v47
  buffer_load_dwordx4 v[124:127], v21, s[32:35], s70 offen offset:3072 nt
  s_add_u32 s70, s70, 16384
  s_nop 2
  v_add_f32_dpp v32, v32, v32 row_ror:8 row_mask:0xf bank_mask:0x3
  v_add_f32_dpp v32, v33, v33 row_ror:8 row_mask:0xf bank_mask:0xc
  v_add_f32_dpp v34, v34, v34 row_ror:8 row_mask:0xf bank_mask:0x3
  v_add_f32_dpp v34, v35, v35 row_ror:8 row_mask:0xf bank_mask:0xc
  v_add_f32_dpp v36, v36, v36 row_ror:8 row_mask:0xf bank_mask:0x3
  v_add_f32_dpp v36, v37, v37 row_ror:8 row_mask:0xf bank_mask:0xc
  v_add_f32_dpp v38, v38, v38 row_ror:8 row_mask:0xf bank_mask:0x3
  v_add_f32_dpp v38, v39, v39 row_ror:8 row_mask:0xf bank_mask:0xc
  v_add_f32_dpp v40, v40, v40 row_ror:8 row_mask:0xf bank_mask:0x3
  v_add_f32_dpp v40, v41, v41 row_ror:8 row_mask:0xf bank_mask:0xc
  v_add_f32_dpp v42, v42, v42 row_ror:8 row_mask:0xf bank_mask:0x3
  v_add_f32_dpp v42, v43, v43 row_ror:8 row_mask:0xf bank_mask:0xc
  v_add_f32_dpp v44, v44, v44 row_ror:8 row_mask:0xf bank_mask:0x3
  v_add_f32_dpp v44, v45, v45 row_ror:8 row_mask:0xf bank_mask:0xc
  v_add_f32_dpp v46, v46, v46 row_ror:8 row_mask:0xf bank_mask:0x3
  v_add_f32_dpp v46, v47, v47 row_ror:8 row_mask:0xf bank_mask:0xc
  v_add_f32_dpp v32, v32, v32 row_shl:4 row_mask:0xf bank_mask:0x5
  v_add_f32_dpp v32, v34, v34 row_shr:4 row_mask:0xf bank_mask:0xa
  v_add_f32_dpp v36, v36, v36 row_shl:4 row_mask:0xf bank_mask:0x5
  v_add_f32_dpp v36, v38, v38 row_shr:4 row_mask:0xf bank_mask:0xa
  v_add_f32_dpp v40, v40, v40 row_shl:4 row_mask:0xf bank_mask:0x5
  v_add_f32_dpp v40, v42, v42 row_shr:4 row_mask:0xf bank_mask:0xa
  v_add_f32_dpp v44, v44, v44 row_shl:4 row_mask:0xf bank_mask:0x5
  v_add_f32_dpp v44, v46, v46 row_shr:4 row_mask:0xf bank_mask:0xa
  s_nop 0
  v_add_f32_dpp v32, v32, v32 quad_perm:[1,0,3,2] row_mask:0xf bank_mask:0xf
  v_add_f32_dpp v36, v36, v36 quad_perm:[1,0,3,2] row_mask:0xf bank_mask:0xf
  v_add_f32_dpp v40, v40, v40 quad_perm:[1,0,3,2] row_mask:0xf bank_mask:0xf
  v_add_f32_dpp v44, v44, v44 quad_perm:[1,0,3,2] row_mask:0xf bank_mask:0xf
  v_cndmask_b32 v32, v32, v36, s[80:81]
  v_cndmask_b32 v40, v40, v44, s[80:81]
  s_nop 0
  v_add_f32_dpp v32, v32, v32 quad_perm:[2,3,0,1] row_mask:0xf bank_mask:0xf
  v_add_f32_dpp v40, v40, v40 quad_perm:[2,3,0,1] row_mask:0xf bank_mask:0xf
  v_cndmask_b32 v14, v32, v40, s[82:83]
  v_cvt_pk_bf16_f32 v14, v14, v14
  v_lshlrev_b32 v14, 16, v14
  v_mul_f32 v14, 0x3db504f3, v14
  v_cvt_pk_bf16_f32 v14, v14, v14
  v_lshlrev_b32 v14, 16, v14
  v_max_f32 v63, v63, v14
  ds_write_b32 v23, v14 offset:3072
  s_waitcnt vmcnt(15)
  v_dot2_f32_bf16 v32, v64, v24, 0
  v_dot2_f32_bf16 v32, v65, v25, v32
  v_dot2_f32_bf16 v32, v66, v26, v32
  v_dot2_f32_bf16 v32, v67, v27, v32
  buffer_load_dwordx4 v[64:67], v21, s[32:35], s70 offen offset:0 nt
  s_waitcnt vmcnt(15)
  v_dot2_f32_bf16 v33, v68, v24, 0
  v_dot2_f32_bf16 v33, v69, v25, v33
  v_dot2_f32_bf16 v33, v70, v26, v33
  v_dot2_f32_bf16 v33, v71, v27, v33
  buffer_load_dwordx4 v[68:71], v21, s[32:35], s70 offen offset:1024 nt
  s_waitcnt vmcnt(15)
  v_dot2_f32_bf16 v34, v72, v24, 0
  v_dot2_f32_bf16 v34, v73, v25, v34
  v_dot2_f32_bf16 v34, v74, v26, v34
  v_dot2_f32_bf16 v34, v75, v27, v34
  buffer_load_dwordx4 v[72:75], v21, s[32:35], s70 offen offset:2048 nt
  s_waitcnt vmcnt(15)
  v_dot2_f32_bf16 v35, v76, v24, 0
  v_dot2_f32_bf16 v35, v77, v25, v35
  v_dot2_f32_bf16 v35, v78, v26, v35
  v_dot2_f32_bf16 v35, v79, v27, v35
  buffer_load_dwordx4 v[76:79], v21, s[32:35], s70 offen offset:3072 nt
  s_add_u32 s70, s70, 16384
  s_waitcnt vmcnt(15)
  v_dot2_f32_bf16 v36, v80, v24, 0
  v_dot2_f32_bf16 v36, v81, v25, v36
  v_dot2_f32_bf16 v36, v82, v26, v36
  v_dot2_f32_bf16 v36, v83, v27, v36
  buffer_load_dwordx4 v[80:83], v21, s[32:35], s70 offen offset:0 nt
  s_waitcnt vmcnt(15)
  v_dot2_f32_bf16 v37, v84, v24, 0
  v_dot2_f32_bf16 v37, v85, v25, v37
  v_dot2_f32_bf16 v37, v86, v26, v37
  v_dot2_f32_bf16 v37, v87, v27, v37
  buffer_load_dwordx4 v[84:87], v21, s[32:35], s70 offen offset:1024 nt
  s_waitcnt vmcnt(15)
  v_dot2_f32_bf16 v38, v88, v24, 0
  v_dot2_f32_bf16 v38, v89, v25, v38
  v_dot2_f32_bf16 v38, v90, v26, v38
  v_dot2_f32_bf16 v38, v91, v27, v38
  buffer_load_dwordx4 v[88:91], v21, s[32:35], s70 offen offset:2048 nt
  s_waitcnt vmcnt(15)
  v_dot2_f32_bf16 v39, v92, v24, 0
  v_dot2_f32_bf16 v39, v93, v25, v39
  v_dot2_f32_bf16 v39, v94, v26, v39
  v_dot2_f32_bf16 v39, v95, v27, v39
  buffer_load_dwordx4 v[92:95], v21, s[32:35], s70 offen offset:3072 nt
  s_add_u32 s70, s70, 16384
  s_waitcnt vmcnt(15)
  v_dot2_f32_bf16 v40, v96, v24, 0
  v_dot2_f32_bf16 v40, v97, v25, v40
  v_dot2_f32_bf16 v40, v98, v26, v40
  v_dot2_f32_bf16 v40, v99, v27, v40
  buffer_load_dwordx4 v[96:99], v21, s[32:35], s70 offen offset:0 nt
  s_waitcnt vmcnt(15)
  v_dot2_f32_bf16 v41, v100, v24, 0
  v_dot2_f32_bf16 v41, v101, v25, v41
  v_dot2_f32_bf16 v41, v102, v26, v41
  v_dot2_f32_bf16 v41, v103, v27, v41
  buffer_load_dwordx4 v[100:103], v21, s[32:35], s70 offen offset:1024 nt
  s_waitcnt vmcnt(15)
  v_dot2_f32_bf16 v42, v104, v24, 0
  v_dot2_f32_bf16 v42, v105, v25, v42
  v_dot2_f32_bf16 v42, v106, v26, v42
  v_dot2_f32_bf16 v42, v107, v27, v42
  buffer_load_dwordx4 v[104:107], v21, s[32:35], s70 offen offset:2048 nt
  s_waitcnt vmcnt(15)
  v_dot2_f32_bf16 v43, v108, v24, 0
  v_dot2_f32_bf16 v43, v109, v25, v43
  v_dot2_f32_bf16 v43, v110, v26, v43
  v_dot2_f32_bf16 v43, v111, v27, v43
  buffer_load_dwordx4 v[108:111], v21, s[32:35], s70 offen offset:3072 nt
  s_add_u32 s70, s70, 16384
  s_waitcnt vmcnt(15)
  v_dot2_f32_bf16 v44, v112, v24, 0
  v_dot2_f32_bf16 v44, v113, v25, v44
  v_dot2_f32_bf16 v44, v114, v26, v44
  v_dot2_f32_bf16 v44, v115, v27, v44
  buffer_load_dwordx4 v[112:115], v21, s[32:35], s70 offen offset:0 nt
  s_waitcnt vmcnt(15)
  v_dot2_f32_bf16 v45, v116, v24, 0
  v_dot2_f32_bf16 v45, v117, v25, v45
  v_dot2_f32_bf16 v45, v118, v26, v45
  v_dot2_f32_bf16 v45, v119, v27, v45
  buffer_load_dwordx4 v[116:119], v21, s[32:35], s70 offen offset:1024 nt
  s_waitcnt vmcnt(15)
  v_dot2_f32_bf16 v46, v120, v24, 0
  v_dot2_f32_bf16 v46, v121, v25, v46
  v_dot2_f32_bf16 v46, v122, v26, v46
  v_dot2_f32_bf16 v46, v123, v27, v46
  buffer_load_dwordx4 v[120:123], v21, s[32:35], s70 offen offset:2048 nt
  s_waitcnt vmcnt(15)
  v_dot2_f32_bf16 v47, v124, v24, 0
  v_dot2_f32_bf16 v47, v125, v25, v47
  v_dot2_f32_bf16 v47, v126, v26, v47
  v_dot2_f32_bf16 v47, v127, v27, v47
  buffer_load_dwordx4 v[124:127], v21, s[32:35], s70 offen offset:3072 nt
  s_add_u32 s70, s70, 16384
  s_nop 2
  v_add_f32_dpp v32, v32, v32 row_ror:8 row_mask:0xf bank_mask:0x3
  v_add_f32_dpp v32, v33, v33 row_ror:8 row_mask:0xf bank_mask:0xc
  v_add_f32_dpp v34, v34, v34 row_ror:8 row_mask:0xf bank_mask:0x3
  v_add_f32_dpp v34, v35, v35 row_ror:8 row_mask:0xf bank_mask:0xc
  v_add_f32_dpp v36, v36, v36 row_ror:8 row_mask:0xf bank_mask:0x3
  v_add_f32_dpp v36, v37, v37 row_ror:8 row_mask:0xf bank_mask:0xc
  v_add_f32_dpp v38, v38, v38 row_ror:8 row_mask:0xf bank_mask:0x3
  v_add_f32_dpp v38, v39, v39 row_ror:8 row_mask:0xf bank_mask:0xc
  v_add_f32_dpp v40, v40, v40 row_ror:8 row_mask:0xf bank_mask:0x3
  v_add_f32_dpp v40, v41, v41 row_ror:8 row_mask:0xf bank_mask:0xc
  v_add_f32_dpp v42, v42, v42 row_ror:8 row_mask:0xf bank_mask:0x3
  v_add_f32_dpp v42, v43, v43 row_ror:8 row_mask:0xf bank_mask:0xc
  v_add_f32_dpp v44, v44, v44 row_ror:8 row_mask:0xf bank_mask:0x3
  v_add_f32_dpp v44, v45, v45 row_ror:8 row_mask:0xf bank_mask:0xc
  v_add_f32_dpp v46, v46, v46 row_ror:8 row_mask:0xf bank_mask:0x3
  v_add_f32_dpp v46, v47, v47 row_ror:8 row_mask:0xf bank_mask:0xc
  v_add_f32_dpp v32, v32, v32 row_shl:4 row_mask:0xf bank_mask:0x5
  v_add_f32_dpp v32, v34, v34 row_shr:4 row_mask:0xf bank_mask:0xa
  v_add_f32_dpp v36, v36, v36 row_shl:4 row_mask:0xf bank_mask:0x5
  v_add_f32_dpp v36, v38, v38 row_shr:4 row_mask:0xf bank_mask:0xa
  v_add_f32_dpp v40, v40, v40 row_shl:4 row_mask:0xf bank_mask:0x5
  v_add_f32_dpp v40, v42, v42 row_shr:4 row_mask:0xf bank_mask:0xa
  v_add_f32_dpp v44, v44, v44 row_shl:4 row_mask:0xf bank_mask:0x5
  v_add_f32_dpp v44, v46, v46 row_shr:4 row_mask:0xf bank_mask:0xa
  s_nop 0
  v_add_f32_dpp v32, v32, v32 quad_perm:[1,0,3,2] row_mask:0xf bank_mask:0xf
  v_add_f32_dpp v36, v36, v36 quad_perm:[1,0,3,2] row_mask:0xf bank_mask:0xf
  v_add_f32_dpp v40, v40, v40 quad_perm:[1,0,3,2] row_mask:0xf bank_mask:0xf
  v_add_f32_dpp v44, v44, v44 quad_perm:[1,0,3,2] row_mask:0xf bank_mask:0xf
  v_cndmask_b32 v32, v32, v36, s[80:81]
  v_cndmask_b32 v40, v40, v44, s[80:81]
  s_nop 0
  v_add_f32_dpp v32, v32, v32 quad_perm:[2,3,0,1] row_mask:0xf bank_mask:0xf
  v_add_f32_dpp v40, v40, v40 quad_perm:[2,3,0,1] row_mask:0xf bank_mask:0xf
  v_cndmask_b32 v14, v32, v40, s[82:83]
  v_cvt_pk_bf16_f32 v14, v14, v14
  v_lshlrev_b32 v14, 16, v14
  v_mul_f32 v14, 0x3db504f3, v14
  v_cvt_pk_bf16_f32 v14, v14, v14
  v_lshlrev_b32 v14, 16, v14
  v_max_f32 v63, v63, v14
  ds_write_b32 v23, v14 offset:3328
  s_waitcnt vmcnt(15)
  v_dot2_f32_bf16 v32, v64, v24, 0
  v_dot2_f32_bf16 v32, v65, v25, v32
  v_dot2_f32_bf16 v32, v66, v26, v32
  v_dot2_f32_bf16 v32, v67, v27, v32
  buffer_load_dwordx4 v[64:67], v21, s[32:35], s70 offen offset:0 nt
  s_waitcnt vmcnt(15)
  v_dot2_f32_bf16 v33, v68, v24, 0
  v_dot2_f32_bf16 v33, v69, v25, v33
  v_dot2_f32_bf16 v33, v70, v26, v33
  v_dot2_f32_bf16 v33, v71, v27, v33
  buffer_load_dwordx4 v[68:71], v21, s[32:35], s70 offen offset:1024 nt
  s_waitcnt vmcnt(15)
  v_dot2_f32_bf16 v34, v72, v24, 0
  v_dot2_f32_bf16 v34, v73, v25, v34
  v_dot2_f32_bf16 v34, v74, v26, v34
  v_dot2_f32_bf16 v34, v75, v27, v34
  buffer_load_dwordx4 v[72:75], v21, s[32:35], s70 offen offset:2048 nt
  s_waitcnt vmcnt(15)
  v_dot2_f32_bf16 v35, v76, v24, 0
  v_dot2_f32_bf16 v35, v77, v25, v35
  v_dot2_f32_bf16 v35, v78, v26, v35
  v_dot2_f32_bf16 v35, v79, v27, v35
  buffer_load_dwordx4 v[76:79], v21, s[32:35], s70 offen offset:3072 nt
  s_add_u32 s70, s70, 16384
  s_waitcnt vmcnt(15)
  v_dot2_f32_bf16 v36, v80, v24, 0
  v_dot2_f32_bf16 v36, v81, v25, v36
  v_dot2_f32_bf16 v36, v82, v26, v36
  v_dot2_f32_bf16 v36, v83, v27, v36
  buffer_load_dwordx4 v[80:83], v21, s[32:35], s70 offen offset:0 nt
  s_waitcnt vmcnt(15)
  v_dot2_f32_bf16 v37, v84, v24, 0
  v_dot2_f32_bf16 v37, v85, v25, v37
  v_dot2_f32_bf16 v37, v86, v26, v37
  v_dot2_f32_bf16 v37, v87, v27, v37
  buffer_load_dwordx4 v[84:87], v21, s[32:35], s70 offen offset:1024 nt
  s_waitcnt vmcnt(15)
  v_dot2_f32_bf16 v38, v88, v24, 0
  v_dot2_f32_bf16 v38, v89, v25, v38
  v_dot2_f32_bf16 v38, v90, v26, v38
  v_dot2_f32_bf16 v38, v91, v27, v38
  buffer_load_dwordx4 v[88:91], v21, s[32:35], s70 offen offset:2048 nt
  s_waitcnt vmcnt(15)
  v_dot2_f32_bf16 v39, v92, v24, 0
  v_dot2_f32_bf16 v39, v93, v25, v39
  v_dot2_f32_bf16 v39, v94, v26, v39
  v_dot2_f32_bf16 v39, v95, v27, v39
  buffer_load_dwordx4 v[92:95], v21, s[32:35], s70 offen offset:3072 nt
  s_add_u32 s70, s70, 16384
  s_waitcnt vmcnt(15)
  v_dot2_f32_bf16 v40, v96, v24, 0
  v_dot2_f32_bf16 v40, v97, v25, v40
  v_dot2_f32_bf16 v40, v98, v26, v40
  v_dot2_f32_bf16 v40, v99, v27, v40
  buffer_load_dwordx4 v[96:99], v21, s[32:35], s70 offen offset:0 nt
  s_waitcnt vmcnt(15)
  v_dot2_f32_bf16 v41, v100, v24, 0
  v_dot2_f32_bf16 v41, v101, v25, v41
  v_dot2_f32_bf16 v41, v102, v26, v41
  v_dot2_f32_bf16 v41, v103, v27, v41
  buffer_load_dwordx4 v[100:103], v21, s[32:35], s70 offen offset:1024 nt
  s_waitcnt vmcnt(15)
  v_dot2_f32_bf16 v42, v104, v24, 0
  v_dot2_f32_bf16 v42, v105, v25, v42
  v_dot2_f32_bf16 v42, v106, v26, v42
  v_dot2_f32_bf16 v42, v107, v27, v42
  buffer_load_dwordx4 v[104:107], v21, s[32:35], s70 offen offset:2048 nt
  s_waitcnt vmcnt(15)
  v_dot2_f32_bf16 v43, v108, v24, 0
  v_dot2_f32_bf16 v43, v109, v25, v43
  v_dot2_f32_bf16 v43, v110, v26, v43
  v_dot2_f32_bf16 v43, v111, v27, v43
  buffer_load_dwordx4 v[108:111], v21, s[32:35], s70 offen offset:3072 nt
  s_add_u32 s70, s70, 16384
  s_waitcnt vmcnt(15)
  v_dot2_f32_bf16 v44, v112, v24, 0
  v_dot2_f32_bf16 v44, v113, v25, v44
  v_dot2_f32_bf16 v44, v114, v26, v44
  v_dot2_f32_bf16 v44, v115, v27, v44
  buffer_load_dwordx4 v[112:115], v21, s[32:35], s70 offen offset:0 nt
  s_waitcnt vmcnt(15)
  v_dot2_f32_bf16 v45, v116, v24, 0
  v_dot2_f32_bf16 v45, v117, v25, v45
  v_dot2_f32_bf16 v45, v118, v26, v45
  v_dot2_f32_bf16 v45, v119, v27, v45
  buffer_load_dwordx4 v[116:119], v21, s[32:35], s70 offen offset:1024 nt
  s_waitcnt vmcnt(15)
  v_dot2_f32_bf16 v46, v120, v24, 0
  v_dot2_f32_bf16 v46, v121, v25, v46
  v_dot2_f32_bf16 v46, v122, v26, v46
  v_dot2_f32_bf16 v46, v123, v27, v46
  buffer_load_dwordx4 v[120:123], v21, s[32:35], s70 offen offset:2048 nt
  s_waitcnt vmcnt(15)
  v_dot2_f32_bf16 v47, v124, v24, 0
  v_dot2_f32_bf16 v47, v125, v25, v47
  v_dot2_f32_bf16 v47, v126, v26, v47
  v_dot2_f32_bf16 v47, v127, v27, v47
  buffer_load_dwordx4 v[124:127], v21, s[32:35], s70 offen offset:3072 nt
  s_add_u32 s70, s70, 16384
  s_nop 2
  v_add_f32_dpp v32, v32, v32 row_ror:8 row_mask:0xf bank_mask:0x3
  v_add_f32_dpp v32, v33, v33 row_ror:8 row_mask:0xf bank_mask:0xc
  v_add_f32_dpp v34, v34, v34 row_ror:8 row_mask:0xf bank_mask:0x3
  v_add_f32_dpp v34, v35, v35 row_ror:8 row_mask:0xf bank_mask:0xc
  v_add_f32_dpp v36, v36, v36 row_ror:8 row_mask:0xf bank_mask:0x3
  v_add_f32_dpp v36, v37, v37 row_ror:8 row_mask:0xf bank_mask:0xc
  v_add_f32_dpp v38, v38, v38 row_ror:8 row_mask:0xf bank_mask:0x3
  v_add_f32_dpp v38, v39, v39 row_ror:8 row_mask:0xf bank_mask:0xc
  v_add_f32_dpp v40, v40, v40 row_ror:8 row_mask:0xf bank_mask:0x3
  v_add_f32_dpp v40, v41, v41 row_ror:8 row_mask:0xf bank_mask:0xc
  v_add_f32_dpp v42, v42, v42 row_ror:8 row_mask:0xf bank_mask:0x3
  v_add_f32_dpp v42, v43, v43 row_ror:8 row_mask:0xf bank_mask:0xc
  v_add_f32_dpp v44, v44, v44 row_ror:8 row_mask:0xf bank_mask:0x3
  v_add_f32_dpp v44, v45, v45 row_ror:8 row_mask:0xf bank_mask:0xc
  v_add_f32_dpp v46, v46, v46 row_ror:8 row_mask:0xf bank_mask:0x3
  v_add_f32_dpp v46, v47, v47 row_ror:8 row_mask:0xf bank_mask:0xc
  v_add_f32_dpp v32, v32, v32 row_shl:4 row_mask:0xf bank_mask:0x5
  v_add_f32_dpp v32, v34, v34 row_shr:4 row_mask:0xf bank_mask:0xa
  v_add_f32_dpp v36, v36, v36 row_shl:4 row_mask:0xf bank_mask:0x5
  v_add_f32_dpp v36, v38, v38 row_shr:4 row_mask:0xf bank_mask:0xa
  v_add_f32_dpp v40, v40, v40 row_shl:4 row_mask:0xf bank_mask:0x5
  v_add_f32_dpp v40, v42, v42 row_shr:4 row_mask:0xf bank_mask:0xa
  v_add_f32_dpp v44, v44, v44 row_shl:4 row_mask:0xf bank_mask:0x5
  v_add_f32_dpp v44, v46, v46 row_shr:4 row_mask:0xf bank_mask:0xa
  s_nop 0
  v_add_f32_dpp v32, v32, v32 quad_perm:[1,0,3,2] row_mask:0xf bank_mask:0xf
  v_add_f32_dpp v36, v36, v36 quad_perm:[1,0,3,2] row_mask:0xf bank_mask:0xf
  v_add_f32_dpp v40, v40, v40 quad_perm:[1,0,3,2] row_mask:0xf bank_mask:0xf
  v_add_f32_dpp v44, v44, v44 quad_perm:[1,0,3,2] row_mask:0xf bank_mask:0xf
  v_cndmask_b32 v32, v32, v36, s[80:81]
  v_cndmask_b32 v40, v40, v44, s[80:81]
  s_nop 0
  v_add_f32_dpp v32, v32, v32 quad_perm:[2,3,0,1] row_mask:0xf bank_mask:0xf
  v_add_f32_dpp v40, v40, v40 quad_perm:[2,3,0,1] row_mask:0xf bank_mask:0xf
  v_cndmask_b32 v14, v32, v40, s[82:83]
  v_cvt_pk_bf16_f32 v14, v14, v14
  v_lshlrev_b32 v14, 16, v14
  v_mul_f32 v14, 0x3db504f3, v14
  v_cvt_pk_bf16_f32 v14, v14, v14
  v_lshlrev_b32 v14, 16, v14
  v_max_f32 v63, v63, v14
  ds_write_b32 v23, v14 offset:3584
  s_waitcnt vmcnt(15)
  v_dot2_f32_bf16 v32, v64, v24, 0
  v_dot2_f32_bf16 v32, v65, v25, v32
  v_dot2_f32_bf16 v32, v66, v26, v32
  v_dot2_f32_bf16 v32, v67, v27, v32
  s_mov_b32 s70, 0
  buffer_load_dwordx4 v[64:67], v21, s[36:39], s70 offen offset:0 nt
  s_waitcnt vmcnt(15)
  v_dot2_f32_bf16 v33, v68, v24, 0
  v_dot2_f32_bf16 v33, v69, v25, v33
  v_dot2_f32_bf16 v33, v70, v26, v33
  v_dot2_f32_bf16 v33, v71, v27, v33
  buffer_load_dwordx4 v[68:71], v21, s[36:39], s70 offen offset:1024 nt
  s_waitcnt vmcnt(15)
  v_dot2_f32_bf16 v34, v72, v24, 0
  v_dot2_f32_bf16 v34, v73, v25, v34
  v_dot2_f32_bf16 v34, v74, v26, v34
  v_dot2_f32_bf16 v34, v75, v27, v34
  buffer_load_dwordx4 v[72:75], v21, s[36:39], s70 offen offset:2048 nt
  s_waitcnt vmcnt(15)
  v_dot2_f32_bf16 v35, v76, v24, 0
  v_dot2_f32_bf16 v35, v77, v25, v35
  v_dot2_f32_bf16 v35, v78, v26, v35
  v_dot2_f32_bf16 v35, v79, v27, v35
  buffer_load_dwordx4 v[76:79], v21, s[36:39], s70 offen offset:3072 nt
  s_add_u32 s70, s70, 16384
  s_waitcnt vmcnt(15)
  v_dot2_f32_bf16 v36, v80, v24, 0
  v_dot2_f32_bf16 v36, v81, v25, v36
  v_dot2_f32_bf16 v36, v82, v26, v36
  v_dot2_f32_bf16 v36, v83, v27, v36
  buffer_load_dwordx4 v[80:83], v21, s[36:39], s70 offen offset:0 nt
  s_waitcnt vmcnt(15)
  v_dot2_f32_bf16 v37, v84, v24, 0
  v_dot2_f32_bf16 v37, v85, v25, v37
  v_dot2_f32_bf16 v37, v86, v26, v37
  v_dot2_f32_bf16 v37, v87, v27, v37
  buffer_load_dwordx4 v[84:87], v21, s[36:39], s70 offen offset:1024 nt
  s_waitcnt vmcnt(15)
  v_dot2_f32_bf16 v38, v88, v24, 0
  v_dot2_f32_bf16 v38, v89, v25, v38
  v_dot2_f32_bf16 v38, v90, v26, v38
  v_dot2_f32_bf16 v38, v91, v27, v38
  buffer_load_dwordx4 v[88:91], v21, s[36:39], s70 offen offset:2048 nt
  s_waitcnt vmcnt(15)
  v_dot2_f32_bf16 v39, v92, v24, 0
  v_dot2_f32_bf16 v39, v93, v25, v39
  v_dot2_f32_bf16 v39, v94, v26, v39
  v_dot2_f32_bf16 v39, v95, v27, v39
  buffer_load_dwordx4 v[92:95], v21, s[36:39], s70 offen offset:3072 nt
  s_add_u32 s70, s70, 16384
  s_waitcnt vmcnt(15)
  v_dot2_f32_bf16 v40, v96, v24, 0
  v_dot2_f32_bf16 v40, v97, v25, v40
  v_dot2_f32_bf16 v40, v98, v26, v40
  v_dot2_f32_bf16 v40, v99, v27, v40
  buffer_load_dwordx4 v[96:99], v21, s[36:39], s70 offen offset:0 nt
  s_waitcnt vmcnt(15)
  v_dot2_f32_bf16 v41, v100, v24, 0
  v_dot2_f32_bf16 v41, v101, v25, v41
  v_dot2_f32_bf16 v41, v102, v26, v41
  v_dot2_f32_bf16 v41, v103, v27, v41
  buffer_load_dwordx4 v[100:103], v21, s[36:39], s70 offen offset:1024 nt
  s_waitcnt vmcnt(15)
  v_dot2_f32_bf16 v42, v104, v24, 0
  v_dot2_f32_bf16 v42, v105, v25, v42
  v_dot2_f32_bf16 v42, v106, v26, v42
  v_dot2_f32_bf16 v42, v107, v27, v42
  buffer_load_dwordx4 v[104:107], v21, s[36:39], s70 offen offset:2048 nt
  s_waitcnt vmcnt(15)
  v_dot2_f32_bf16 v43, v108, v24, 0
  v_dot2_f32_bf16 v43, v109, v25, v43
  v_dot2_f32_bf16 v43, v110, v26, v43
  v_dot2_f32_bf16 v43, v111, v27, v43
  buffer_load_dwordx4 v[108:111], v21, s[36:39], s70 offen offset:3072 nt
  s_add_u32 s70, s70, 16384
  s_waitcnt vmcnt(15)
  v_dot2_f32_bf16 v44, v112, v24, 0
  v_dot2_f32_bf16 v44, v113, v25, v44
  v_dot2_f32_bf16 v44, v114, v26, v44
  v_dot2_f32_bf16 v44, v115, v27, v44
  buffer_load_dwordx4 v[112:115], v21, s[36:39], s70 offen offset:0 nt
  s_waitcnt vmcnt(15)
  v_dot2_f32_bf16 v45, v116, v24, 0
  v_dot2_f32_bf16 v45, v117, v25, v45
  v_dot2_f32_bf16 v45, v118, v26, v45
  v_dot2_f32_bf16 v45, v119, v27, v45
  buffer_load_dwordx4 v[116:119], v21, s[36:39], s70 offen offset:1024 nt
  s_waitcnt vmcnt(15)
  v_dot2_f32_bf16 v46, v120, v24, 0
  v_dot2_f32_bf16 v46, v121, v25, v46
  v_dot2_f32_bf16 v46, v122, v26, v46
  v_dot2_f32_bf16 v46, v123, v27, v46
  buffer_load_dwordx4 v[120:123], v21, s[36:39], s70 offen offset:2048 nt
  s_waitcnt vmcnt(15)
  v_dot2_f32_bf16 v47, v124, v24, 0
  v_dot2_f32_bf16 v47, v125, v25, v47
  v_dot2_f32_bf16 v47, v126, v26, v47
  v_dot2_f32_bf16 v47, v127, v27, v47
  buffer_load_dwordx4 v[124:127], v21, s[36:39], s70 offen offset:3072 nt
  s_add_u32 s70, s70, 16384
  s_nop 2
  v_add_f32_dpp v32, v32, v32 row_ror:8 row_mask:0xf bank_mask:0x3
  v_add_f32_dpp v32, v33, v33 row_ror:8 row_mask:0xf bank_mask:0xc
  v_add_f32_dpp v34, v34, v34 row_ror:8 row_mask:0xf bank_mask:0x3
  v_add_f32_dpp v34, v35, v35 row_ror:8 row_mask:0xf bank_mask:0xc
  v_add_f32_dpp v36, v36, v36 row_ror:8 row_mask:0xf bank_mask:0x3
  v_add_f32_dpp v36, v37, v37 row_ror:8 row_mask:0xf bank_mask:0xc
  v_add_f32_dpp v38, v38, v38 row_ror:8 row_mask:0xf bank_mask:0x3
  v_add_f32_dpp v38, v39, v39 row_ror:8 row_mask:0xf bank_mask:0xc
  v_add_f32_dpp v40, v40, v40 row_ror:8 row_mask:0xf bank_mask:0x3
  v_add_f32_dpp v40, v41, v41 row_ror:8 row_mask:0xf bank_mask:0xc
  v_add_f32_dpp v42, v42, v42 row_ror:8 row_mask:0xf bank_mask:0x3
  v_add_f32_dpp v42, v43, v43 row_ror:8 row_mask:0xf bank_mask:0xc
  v_add_f32_dpp v44, v44, v44 row_ror:8 row_mask:0xf bank_mask:0x3
  v_add_f32_dpp v44, v45, v45 row_ror:8 row_mask:0xf bank_mask:0xc
  v_add_f32_dpp v46, v46, v46 row_ror:8 row_mask:0xf bank_mask:0x3
  v_add_f32_dpp v46, v47, v47 row_ror:8 row_mask:0xf bank_mask:0xc
  v_add_f32_dpp v32, v32, v32 row_shl:4 row_mask:0xf bank_mask:0x5
  v_add_f32_dpp v32, v34, v34 row_shr:4 row_mask:0xf bank_mask:0xa
  v_add_f32_dpp v36, v36, v36 row_shl:4 row_mask:0xf bank_mask:0x5
  v_add_f32_dpp v36, v38, v38 row_shr:4 row_mask:0xf bank_mask:0xa
  v_add_f32_dpp v40, v40, v40 row_shl:4 row_mask:0xf bank_mask:0x5
  v_add_f32_dpp v40, v42, v42 row_shr:4 row_mask:0xf bank_mask:0xa
  v_add_f32_dpp v44, v44, v44 row_shl:4 row_mask:0xf bank_mask:0x5
  v_add_f32_dpp v44, v46, v46 row_shr:4 row_mask:0xf bank_mask:0xa
  s_nop 0
  v_add_f32_dpp v32, v32, v32 quad_perm:[1,0,3,2] row_mask:0xf bank_mask:0xf
  v_add_f32_dpp v36, v36, v36 quad_perm:[1,0,3,2] row_mask:0xf bank_mask:0xf
  v_add_f32_dpp v40, v40, v40 quad_perm:[1,0,3,2] row_mask:0xf bank_mask:0xf
  v_add_f32_dpp v44, v44, v44 quad_perm:[1,0,3,2] row_mask:0xf bank_mask:0xf
  v_cndmask_b32 v32, v32, v36, s[80:81]
  v_cndmask_b32 v40, v40, v44, s[80:81]
  s_nop 0
  v_add_f32_dpp v32, v32, v32 quad_perm:[2,3,0,1] row_mask:0xf bank_mask:0xf
  v_add_f32_dpp v40, v40, v40 quad_perm:[2,3,0,1] row_mask:0xf bank_mask:0xf
  v_cndmask_b32 v14, v32, v40, s[82:83]
  v_cvt_pk_bf16_f32 v14, v14, v14
  v_lshlrev_b32 v14, 16, v14
  v_mul_f32 v14, 0x3db504f3, v14
  v_cvt_pk_bf16_f32 v14, v14, v14
  v_lshlrev_b32 v14, 16, v14
  v_max_f32 v63, v63, v14
  ds_write_b32 v23, v14 offset:3840
  ds_read_b32 v32, v23 offset:0
  ds_read_b32 v33, v23 offset:256
  ds_read_b32 v34, v23 offset:512
  ds_read_b32 v35, v23 offset:768
  ds_read_b32 v36, v23 offset:1024
  ds_read_b32 v37, v23 offset:1280
  ds_read_b32 v38, v23 offset:1536
  ds_read_b32 v39, v23 offset:1792
  ds_read_b32 v40, v23 offset:2048
  ds_read_b32 v41, v23 offset:2304
  ds_read_b32 v42, v23 offset:2560
  ds_read_b32 v43, v23 offset:2816
  ds_read_b32 v44, v23 offset:3072
  ds_read_b32 v45, v23 offset:3328
  ds_read_b32 v46, v23 offset:3584
  ds_read_b32 v47, v23 offset:3840
  s_nop 1
  v_max_f32_dpp v63, v63, v63 row_ror:8 row_mask:0xf bank_mask:0xf
  s_nop 1
  v_max_f32_dpp v63, v63, v63 row_ror:4 row_mask:0xf bank_mask:0xf
  s_nop 1
  v_max_f32_dpp v63, v63, v63 row_ror:2 row_mask:0xf bank_mask:0xf
  s_nop 1
  v_max_f32_dpp v63, v63, v63 row_ror:1 row_mask:0xf bank_mask:0xf
  s_nop 0
  v_readlane_b32 s86, v63, 0
  v_readlane_b32 s87, v63, 16
  v_readlane_b32 s88, v63, 32
  v_readlane_b32 s89, v63, 48
  s_nop 1
  v_mov_b32 v63, s86
  v_max_f32 v63, s87, v63
  v_max_f32 v63, s88, v63
  v_max_f32 v63, s89, v63
  v_mov_b32 v18, 0
  s_waitcnt lgkmcnt(0)
  v_sub_f32 v14, v32, v63
  v_mul_f32 v14, 0x3fb8aa3b, v14
  v_exp_f32 v14, v14
  s_nop 0
  v_add_f32 v18, v18, v14
  v_sub_f32 v15, v33, v63
  v_mul_f32 v15, 0x3fb8aa3b, v15
  v_exp_f32 v15, v15
  s_nop 0
  v_add_f32 v18, v18, v15
  v_sub_f32 v14, v34, v63
  v_mul_f32 v14, 0x3fb8aa3b, v14
  v_exp_f32 v14, v14
  s_nop 0
  v_add_f32 v18, v18, v14
  v_sub_f32 v15, v35, v63
  v_mul_f32 v15, 0x3fb8aa3b, v15
  v_exp_f32 v15, v15
  s_nop 0
  v_add_f32 v18, v18, v15
  v_sub_f32 v14, v36, v63
  v_mul_f32 v14, 0x3fb8aa3b, v14
  v_exp_f32 v14, v14
  s_nop 0
  v_add_f32 v18, v18, v14
  v_sub_f32 v15, v37, v63
  v_mul_f32 v15, 0x3fb8aa3b, v15
  v_exp_f32 v15, v15
  s_nop 0
  v_add_f32 v18, v18, v15
  v_sub_f32 v14, v38, v63
  v_mul_f32 v14, 0x3fb8aa3b, v14
  v_exp_f32 v14, v14
  s_nop 0
  v_add_f32 v18, v18, v14
  v_sub_f32 v15, v39, v63
  v_mul_f32 v15, 0x3fb8aa3b, v15
  v_exp_f32 v15, v15
  s_nop 0
  v_add_f32 v18, v18, v15
  v_sub_f32 v14, v40, v63
  v_mul_f32 v14, 0x3fb8aa3b, v14
  v_exp_f32 v14, v14
  s_nop 0
  v_add_f32 v18, v18, v14
  v_sub_f32 v15, v41, v63
  v_mul_f32 v15, 0x3fb8aa3b, v15
  v_exp_f32 v15, v15
  s_nop 0
  v_add_f32 v18, v18, v15
  v_sub_f32 v14, v42, v63
  v_mul_f32 v14, 0x3fb8aa3b, v14
  v_exp_f32 v14, v14
  s_nop 0
  v_add_f32 v18, v18, v14
  v_sub_f32 v15, v43, v63
  v_mul_f32 v15, 0x3fb8aa3b, v15
  v_exp_f32 v15, v15
  s_nop 0
  v_add_f32 v18, v18, v15
  v_sub_f32 v14, v44, v63
  v_mul_f32 v14, 0x3fb8aa3b, v14
  v_exp_f32 v14, v14
  s_nop 0
  v_add_f32 v18, v18, v14
  v_sub_f32 v15, v45, v63
  v_mul_f32 v15, 0x3fb8aa3b, v15
  v_exp_f32 v15, v15
  s_nop 0
  v_add_f32 v18, v18, v15
  v_sub_f32 v14, v46, v63
  v_mul_f32 v14, 0x3fb8aa3b, v14
  v_exp_f32 v14, v14
  s_nop 0
  v_add_f32 v18, v18, v14
  v_sub_f32 v15, v47, v63
  v_mul_f32 v15, 0x3fb8aa3b, v15
  v_exp_f32 v15, v15
  s_nop 0
  v_add_f32 v18, v18, v15
  s_nop 1
  v_add_f32_dpp v18, v18, v18 row_ror:8 row_mask:0xf bank_mask:0xf
  s_nop 1
  v_add_f32_dpp v18, v18, v18 row_ror:4 row_mask:0xf bank_mask:0xf
  s_nop 1
  v_add_f32_dpp v18, v18, v18 row_ror:2 row_mask:0xf bank_mask:0xf
  s_nop 1
  v_add_f32_dpp v18, v18, v18 row_ror:1 row_mask:0xf bank_mask:0xf
  s_nop 0
  v_readlane_b32 s86, v18, 0
  v_readlane_b32 s87, v18, 16
  v_readlane_b32 s88, v18, 32
  v_readlane_b32 s89, v18, 48
  s_nop 1
  v_mov_b32 v18, s86
  v_add_f32 v18, s87, v18
  v_add_f32 v18, s88, v18
  v_add_f32 v18, s89, v18
  v_mov_b32 v14, v63
  v_mov_b32 v15, v18
  s_lshl_b32 s72, s64, 3
  v_mov_b32 v16, s72
  ds_write_b64 v16, v[14:15] offset:30976
  s_waitcnt lgkmcnt(0)
  s_mov_b64 exec, 1
  v_mov_b32 v19, 1
  ds_add_u32 v7, v19 offset:31044
  s_mov_b64 exec, -1
L_lspin_3:
  ds_read_b32 v19, v7 offset:31044
  s_waitcnt lgkmcnt(0)
  v_readfirstlane_b32 s72, v19
  s_nop 0
  s_cmp_ge_u32 s72, 4
  s_cbranch_scc1 L_lspin_3_ok
  s_branch L_lspin_3
L_lspin_3_ok:
  ds_read_b128 v[48:51], v7 offset:30976
  ds_read_b128 v[52:55], v7 offset:30992
  s_waitcnt lgkmcnt(0)
  v_max3_f32 v16, v48, v50, v52
  v_max_f32 v16, v16, v54
  v_mov_b32 v18, 0
  v_sub_f32 v14, v48, v16
  v_mul_f32 v14, 0x3fb8aa3b, v14
  v_exp_f32 v14, v14
  s_nop 0
  v_fmac_f32 v18, v14, v49
  v_sub_f32 v14, v50, v16
  v_mul_f32 v14, 0x3fb8aa3b, v14
  v_exp_f32 v14, v14
  s_nop 0
  v_fmac_f32 v18, v14, v51
  v_sub_f32 v14, v52, v16
  v_mul_f32 v14, 0x3fb8aa3b, v14
  v_exp_f32 v14, v14
  s_nop 0
  v_fmac_f32 v18, v14, v53
  v_sub_f32 v14, v54, v16
  v_mul_f32 v14, 0x3fb8aa3b, v14
  v_exp_f32 v14, v14
  s_nop 0
  v_fmac_f32 v18, v14, v55
  v_rcp_f32 v17, v18
  s_nop 0
  v_fma_f32 v14, -v18, v17, 1.0
  v_fmac_f32 v17, v14, v17
  v_sub_f32 v32, v32, v16
  v_mul_f32 v32, 0x3fb8aa3b, v32
  v_exp_f32 v32, v32
  s_nop 0
  v_mul_f32 v32, v32, v17
  v_cvt_pk_bf16_f32 v32, v32, v32
  ds_write_b32 v23, v32 offset:0
  v_sub_f32 v33, v33, v16
  v_mul_f32 v33, 0x3fb8aa3b, v33
  v_exp_f32 v33, v33
  s_nop 0
  v_mul_f32 v33, v33, v17
  v_cvt_pk_bf16_f32 v33, v33, v33
  ds_write_b32 v23, v33 offset:256
  v_sub_f32 v34, v34, v16
  v_mul_f32 v34, 0x3fb8aa3b, v34
  v_exp_f32 v34, v34
  s_nop 0
  v_mul_f32 v34, v34, v17
  v_cvt_pk_bf16_f32 v34, v34, v34
  ds_write_b32 v23, v34 offset:512
  v_sub_f32 v35, v35, v16
  v_mul_f32 v35, 0x3fb8aa3b, v35
  v_exp_f32 v35, v35
  s_nop 0
  v_mul_f32 v35, v35, v17
  v_cvt_pk_bf16_f32 v35, v35, v35
  ds_write_b32 v23, v35 offset:768
  v_sub_f32 v36, v36, v16
  v_mul_f32 v36, 0x3fb8aa3b, v36
  v_exp_f32 v36, v36
  s_nop 0
  v_mul_f32 v36, v36, v17
  v_cvt_pk_bf16_f32 v36, v36, v36
  ds_write_b32 v23, v36 offset:1024
  v_sub_f32 v37, v37, v16
  v_mul_f32 v37, 0x3fb8aa3b, v37
  v_exp_f32 v37, v37
  s_nop 0
  v_mul_f32 v37, v37, v17
  v_cvt_pk_bf16_f32 v37, v37, v37
  ds_write_b32 v23, v37 offset:1280
  v_sub_f32 v38, v38, v16
  v_mul_f32 v38, 0x3fb8aa3b, v38
  v_exp_f32 v38, v38
  s_nop 0
  v_mul_f32 v38, v38, v17
  v_cvt_pk_bf16_f32 v38, v38, v38
  ds_write_b32 v23, v38 offset:1536
  v_sub_f32 v39, v39, v16
  v_mul_f32 v39, 0x3fb8aa3b, v39
  v_exp_f32 v39, v39
  s_nop 0
  v_mul_f32 v39, v39, v17
  v_cvt_pk_bf16_f32 v39, v39, v39
  ds_write_b32 v23, v39 offset:1792
  v_sub_f32 v40, v40, v16
  v_mul_f32 v40, 0x3fb8aa3b, v40
  v_exp_f32 v40, v40
  s_nop 0
  v_mul_f32 v40, v40, v17
  v_cvt_pk_bf16_f32 v40, v40, v40
  ds_write_b32 v23, v40 offset:2048
  v_sub_f32 v41, v41, v16
  v_mul_f32 v41, 0x3fb8aa3b, v41
  v_exp_f32 v41, v41
  s_nop 0
  v_mul_f32 v41, v41, v17
  v_cvt_pk_bf16_f32 v41, v41, v41
  ds_write_b32 v23, v41 offset:2304
  v_sub_f32 v42, v42, v16
  v_mul_f32 v42, 0x3fb8aa3b, v42
  v_exp_f32 v42, v42
  s_nop 0
  v_mul_f32 v42, v42, v17
  v_cvt_pk_bf16_f32 v42, v42, v42
  ds_write_b32 v23, v42 offset:2560
  v_sub_f32 v43, v43, v16
  v_mul_f32 v43, 0x3fb8aa3b, v43
  v_exp_f32 v43, v43
  s_nop 0
  v_mul_f32 v43, v43, v17
  v_cvt_pk_bf16_f32 v43, v43, v43
  ds_write_b32 v23, v43 offset:2816
  v_sub_f32 v44, v44, v16
  v_mul_f32 v44, 0x3fb8aa3b, v44
  v_exp_f32 v44, v44
  s_nop 0
  v_mul_f32 v44, v44, v17
  v_cvt_pk_bf16_f32 v44, v44, v44
  ds_write_b32 v23, v44 offset:3072
  v_sub_f32 v45, v45, v16
  v_mul_f32 v45, 0x3fb8aa3b, v45
  v_exp_f32 v45, v45
  s_nop 0
  v_mul_f32 v45, v45, v17
  v_cvt_pk_bf16_f32 v45, v45, v45
  ds_write_b32 v23, v45 offset:3328
  v_sub_f32 v46, v46, v16
  v_mul_f32 v46, 0x3fb8aa3b, v46
  v_exp_f32 v46, v46
  s_nop 0
  v_mul_f32 v46, v46, v17
  v_cvt_pk_bf16_f32 v46, v46, v46
  ds_write_b32 v23, v46 offset:3584
  v_sub_f32 v47, v47, v16
  v_mul_f32 v47, 0x3fb8aa3b, v47
  v_exp_f32 v47, v47
  s_nop 0
  v_mul_f32 v47, v47, v17
  v_cvt_pk_bf16_f32 v47, v47, v47
  ds_write_b32 v23, v47 offset:3840
  v_mov_b32 v28, 0
  v_mov_b32 v29, 0
  v_mov_b32 v30, 0
  v_mov_b32 v31, 0
  s_lshl_b32 s72, s66, 18
  s_lshl_b32 s73, s64, 8
  s_add_u32 s72, s72, s73
  s_add_u32 s40, s12, s72
  s_addc_u32 s41, s13, 0
  s_sub_u32 s42, 0x800000, s72
  s_waitcnt lgkmcnt(0)
  ds_read_b128 v[32:35], v22 offset:0
  s_waitcnt lgkmcnt(0)
  ds_read_b128 v[36:39], v22 offset:64
  v_and_b32 v40, v32, v8
  v_and_b32 v41, v32, v9
  v_and_b32 v42, v32, v10
  v_and_b32 v43, v32, v11
  s_waitcnt vmcnt(15)
  s_nop 1
  v_mfma_f32_16x16x32_bf16 v[28:31], v[40:43], v[64:67], v[28:31]
  buffer_load_dwordx4 v[64:67], v21, s[36:39], s70 offen offset:0 nt
  v_and_b32 v44, v33, v8
  v_and_b32 v45, v33, v9
  v_and_b32 v46, v33, v10
  v_and_b32 v47, v33, v11
  s_waitcnt vmcnt(15)
  s_nop 1
  v_mfma_f32_16x16x32_bf16 v[28:31], v[44:47], v[68:71], v[28:31]
  buffer_load_dwordx4 v[68:71], v21, s[36:39], s70 offen offset:1024 nt
  v_and_b32 v40, v34, v8
  v_and_b32 v41, v34, v9
  v_and_b32 v42, v34, v10
  v_and_b32 v43, v34, v11
  s_waitcnt vmcnt(15)
  s_nop 1
  v_mfma_f32_16x16x32_bf16 v[28:31], v[40:43], v[72:75], v[28:31]
  buffer_load_dwordx4 v[72:75], v21, s[36:39], s70 offen offset:2048 nt
  v_and_b32 v44, v35, v8
  v_and_b32 v45, v35, v9
  v_and_b32 v46, v35, v10
  v_and_b32 v47, v35, v11
  s_waitcnt vmcnt(15)
  s_nop 1
  v_mfma_f32_16x16x32_bf16 v[28:31], v[44:47], v[76:79], v[28:31]
  buffer_load_dwordx4 v[76:79], v21, s[36:39], s70 offen offset:3072 nt
  s_add_u32 s70, s70, 16384
  s_waitcnt lgkmcnt(0)
  ds_read_b128 v[32:35], v22 offset:128
  v_and_b32 v40, v36, v8
  v_and_b32 v41, v36, v9
  v_and_b32 v42, v36, v10
  v_and_b32 v43, v36, v11
  s_waitcnt vmcnt(15)
  s_nop 1
  v_mfma_f32_16x16x32_bf16 v[28:31], v[40:43], v[80:83], v[28:31]
  buffer_load_dwordx4 v[80:83], v21, s[36:39], s70 offen offset:0 nt
  v_and_b32 v44, v37, v8
  v_and_b32 v45, v37, v9
  v_and_b32 v46, v37, v10
  v_and_b32 v47, v37, v11
  s_waitcnt vmcnt(15)
  s_nop 1
  v_mfma_f32_16x16x32_bf16 v[28:31], v[44:47], v[84:87], v[28:31]
  buffer_load_dwordx4 v[84:87], v21, s[36:39], s70 offen offset:1024 nt
  v_and_b32 v40, v38, v8
  v_and_b32 v41, v38, v9
  v_and_b32 v42, v38, v10
  v_and_b32 v43, v38, v11
  s_waitcnt vmcnt(15)
  s_nop 1
  v_mfma_f32_16x16x32_bf16 v[28:31], v[40:43], v[88:91], v[28:31]
  buffer_load_dwordx4 v[88:91], v21, s[36:39], s70 offen offset:2048 nt
  v_and_b32 v44, v39, v8
  v_and_b32 v45, v39, v9
  v_and_b32 v46, v39, v10
  v_and_b32 v47, v39, v11
  s_waitcnt vmcnt(15)
  s_nop 1
  v_mfma_f32_16x16x32_bf16 v[28:31], v[44:47], v[92:95], v[28:31]
  buffer_load_dwordx4 v[92:95], v21, s[36:39], s70 offen offset:3072 nt
  s_add_u32 s70, s70, 16384
  s_waitcnt lgkmcnt(0)
  ds_read_b128 v[36:39], v22 offset:192
  v_and_b32 v40, v32, v8
  v_and_b32 v41, v32, v9
  v_and_b32 v42, v32, v10
  v_and_b32 v43, v32, v11
  s_waitcnt vmcnt(15)
  s_nop 1
  v_mfma_f32_16x16x32_bf16 v[28:31], v[40:43], v[96:99], v[28:31]
  buffer_load_dwordx4 v[96:99], v21, s[36:39], s70 offen offset:0 nt
  v_and_b32 v44, v33, v8
  v_and_b32 v45, v33, v9
  v_and_b32 v46, v33, v10
  v_and_b32 v47, v33, v11
  s_waitcnt vmcnt(15)
  s_nop 1
  v_mfma_f32_16x16x32_bf16 v[28:31], v[44:47], v[100:103], v[28:31]
  buffer_load_dwordx4 v[100:103], v21, s[36:39], s70 offen offset:1024 nt
  v_and_b32 v40, v34, v8
  v_and_b32 v41, v34, v9
  v_and_b32 v42, v34, v10
  v_and_b32 v43, v34, v11
  s_waitcnt vmcnt(15)
  s_nop 1
  v_mfma_f32_16x16x32_bf16 v[28:31], v[40:43], v[104:107], v[28:31]
  buffer_load_dwordx4 v[104:107], v21, s[36:39], s70 offen offset:2048 nt
  v_and_b32 v44, v35, v8
  v_and_b32 v45, v35, v9
  v_and_b32 v46, v35, v10
  v_and_b32 v47, v35, v11
  s_waitcnt vmcnt(15)
  s_nop 1
  v_mfma_f32_16x16x32_bf16 v[28:31], v[44:47], v[108:111], v[28:31]
  buffer_load_dwordx4 v[108:111], v21, s[36:39], s70 offen offset:3072 nt
  s_add_u32 s70, s70, 16384
  s_waitcnt lgkmcnt(0)
  ds_read_b128 v[32:35], v22 offset:256
  v_and_b32 v40, v36, v8
  v_and_b32 v41, v36, v9
  v_and_b32 v42, v36, v10
  v_and_b32 v43, v36, v11
  s_waitcnt vmcnt(15)
  s_nop 1
  v_mfma_f32_16x16x32_bf16 v[28:31], v[40:43], v[112:115], v[28:31]
  buffer_load_dwordx4 v[112:115], v21, s[36:39], s70 offen offset:0 nt
  v_and_b32 v44, v37, v8
  v_and_b32 v45, v37, v9
  v_and_b32 v46, v37, v10
  v_and_b32 v47, v37, v11
  s_waitcnt vmcnt(15)
  s_nop 1
  v_mfma_f32_16x16x32_bf16 v[28:31], v[44:47], v[116:119], v[28:31]
  buffer_load_dwordx4 v[116:119], v21, s[36:39], s70 offen offset:1024 nt
  v_and_b32 v40, v38, v8
  v_and_b32 v41, v38, v9
  v_and_b32 v42, v38, v10
  v_and_b32 v43, v38, v11
  s_waitcnt vmcnt(15)
  s_nop 1
  v_mfma_f32_16x16x32_bf16 v[28:31], v[40:43], v[120:123], v[28:31]
  buffer_load_dwordx4 v[120:123], v21, s[36:39], s70 offen offset:2048 nt
  v_and_b32 v44, v39, v8
  v_and_b32 v45, v39, v9
  v_and_b32 v46, v39, v10
  v_and_b32 v47, v39, v11
  s_waitcnt vmcnt(15)
  s_nop 1
  v_mfma_f32_16x16x32_bf16 v[28:31], v[44:47], v[124:127], v[28:31]
  buffer_load_dwordx4 v[124:127], v21, s[36:39], s70 offen offset:3072 nt
  s_add_u32 s70, s70, 16384
  s_waitcnt lgkmcnt(0)
  s_mov_b64 exec, 1
  v_mov_b32 v19, 1
  ds_add_u32 v7, v19 offset:31060
  s_mov_b64 exec, -1
  s_waitcnt lgkmcnt(0)
  ds_read_b128 v[36:39], v22 offset:320
  v_and_b32 v40, v32, v8
  v_and_b32 v41, v32, v9
  v_and_b32 v42, v32, v10
  v_and_b32 v43, v32, v11
  s_waitcnt vmcnt(15)
  s_nop 1
  v_mfma_f32_16x16x32_bf16 v[28:31], v[40:43], v[64:67], v[28:31]
  buffer_load_dwordx4 v[64:67], v21, s[36:39], s70 offen offset:0 nt
  v_and_b32 v44, v33, v8
  v_and_b32 v45, v33, v9
  v_and_b32 v46, v33, v10
  v_and_b32 v47, v33, v11
  s_waitcnt vmcnt(15)
  s_nop 1
  v_mfma_f32_16x16x32_bf16 v[28:31], v[44:47], v[68:71], v[28:31]
  buffer_load_dwordx4 v[68:71], v21, s[36:39], s70 offen offset:1024 nt
  v_and_b32 v40, v34, v8
  v_and_b32 v41, v34, v9
  v_and_b32 v42, v34, v10
  v_and_b32 v43, v34, v11
  s_waitcnt vmcnt(15)
  s_nop 1
  v_mfma_f32_16x16x32_bf16 v[28:31], v[40:43], v[72:75], v[28:31]
  buffer_load_dwordx4 v[72:75], v21, s[36:39], s70 offen offset:2048 nt
  v_and_b32 v44, v35, v8
  v_and_b32 v45, v35, v9
  v_and_b32 v46, v35, v10
  v_and_b32 v47, v35, v11
  s_waitcnt vmcnt(15)
  s_nop 1
  v_mfma_f32_16x16x32_bf16 v[28:31], v[44:47], v[76:79], v[28:31]
  buffer_load_dwordx4 v[76:79], v21, s[36:39], s70 offen offset:3072 nt
  s_add_u32 s70, s70, 16384
  s_mov_b32 s71, 0
  buffer_load_dwordx4 a[0:3], v13, s[40:43], s71 offen
  s_waitcnt lgkmcnt(0)
  ds_read_b128 v[32:35], v22 offset:384
  v_and_b32 v40, v36, v8
  v_and_b32 v41, v36, v9
  v_and_b32 v42, v36, v10
  v_and_b32 v43, v36, v11
  s_waitcnt vmcnt(16)
  s_nop 1
  v_mfma_f32_16x16x32_bf16 v[28:31], v[40:43], v[80:83], v[28:31]
  buffer_load_dwordx4 v[80:83], v21, s[36:39], s70 offen offset:0 nt
  v_and_b32 v44, v37, v8
  v_and_b32 v45, v37, v9
  v_and_b32 v46, v37, v10
  v_and_b32 v47, v37, v11
  s_waitcnt vmcnt(16)
  s_nop 1
  v_mfma_f32_16x16x32_bf16 v[28:31], v[44:47], v[84:87], v[28:31]
  buffer_load_dwordx4 v[84:87], v21, s[36:39], s70 offen offset:1024 nt
  v_and_b32 v40, v38, v8
  v_and_b32 v41, v38, v9
  v_and_b32 v42, v38, v10
  v_and_b32 v43, v38, v11
  s_waitcnt vmcnt(16)
  s_nop 1
  v_mfma_f32_16x16x32_bf16 v[28:31], v[40:43], v[88:91], v[28:31]
  buffer_load_dwordx4 v[88:91], v21, s[36:39], s70 offen offset:2048 nt
  v_and_b32 v44, v39, v8
  v_and_b32 v45, v39, v9
  v_and_b32 v46, v39, v10
  v_and_b32 v47, v39, v11
  s_waitcnt vmcnt(16)
  s_nop 1
  v_mfma_f32_16x16x32_bf16 v[28:31], v[44:47], v[92:95], v[28:31]
  buffer_load_dwordx4 v[92:95], v21, s[36:39], s70 offen offset:3072 nt
  s_add_u32 s70, s70, 16384
  s_mov_b32 s71, 2048
  buffer_load_dwordx4 a[4:7], v13, s[40:43], s71 offen
  s_waitcnt lgkmcnt(0)
  ds_read_b128 v[36:39], v22 offset:448
  v_and_b32 v40, v32, v8
  v_and_b32 v41, v32, v9
  v_and_b32 v42, v32, v10
  v_and_b32 v43, v32, v11
  s_waitcnt vmcnt(17)
  s_nop 1
  v_mfma_f32_16x16x32_bf16 v[28:31], v[40:43], v[96:99], v[28:31]
  buffer_load_dwordx4 v[96:99], v21, s[36:39], s70 offen offset:0 nt
  v_and_b32 v44, v33, v8
  v_and_b32 v45, v33, v9
  v_and_b32 v46, v33, v10
  v_and_b32 v47, v33, v11
  s_waitcnt vmcnt(17)
  s_nop 1
  v_mfma_f32_16x16x32_bf16 v[28:31], v[44:47], v[100:103], v[28:31]
  buffer_load_dwordx4 v[100:103], v21, s[36:39], s70 offen offset:1024 nt
  v_and_b32 v40, v34, v8
  v_and_b32 v41, v34, v9
  v_and_b32 v42, v34, v10
  v_and_b32 v43, v34, v11
  s_waitcnt vmcnt(17)
  s_nop 1
  v_mfma_f32_16x16x32_bf16 v[28:31], v[40:43], v[104:107], v[28:31]
  buffer_load_dwordx4 v[104:107], v21, s[36:39], s70 offen offset:2048 nt
  v_and_b32 v44, v35, v8
  v_and_b32 v45, v35, v9
  v_and_b32 v46, v35, v10
  v_and_b32 v47, v35, v11
  s_waitcnt vmcnt(17)
  s_nop 1
  v_mfma_f32_16x16x32_bf16 v[28:31], v[44:47], v[108:111], v[28:31]
  buffer_load_dwordx4 v[108:111], v21, s[36:39], s70 offen offset:3072 nt
  s_add_u32 s70, s70, 16384
  s_mov_b32 s71, 4096
  buffer_load_dwordx4 a[8:11], v13, s[40:43], s71 offen
  s_waitcnt lgkmcnt(0)
  ds_read_b128 v[32:35], v22 offset:512
  v_and_b32 v40, v36, v8
  v_and_b32 v41, v36, v9
  v_and_b32 v42, v36, v10
  v_and_b32 v43, v36, v11
  s_waitcnt vmcnt(18)
  s_nop 1
  v_mfma_f32_16x16x32_bf16 v[28:31], v[40:43], v[112:115], v[28:31]
  buffer_load_dwordx4 v[112:115], v21, s[36:39], s70 offen offset:0 nt
  v_and_b32 v44, v37, v8
  v_and_b32 v45, v37, v9
  v_and_b32 v46, v37, v10
  v_and_b32 v47, v37, v11
  s_waitcnt vmcnt(18)
  s_nop 1
  v_mfma_f32_16x16x32_bf16 v[28:31], v[44:47], v[116:119], v[28:31]
  buffer_load_dwordx4 v[116:119], v21, s[36:39], s70 offen offset:1024 nt
  v_and_b32 v40, v38, v8
  v_and_b32 v41, v38, v9
  v_and_b32 v42, v38, v10
  v_and_b32 v43, v38, v11
  s_waitcnt vmcnt(18)
  s_nop 1
  v_mfma_f32_16x16x32_bf16 v[28:31], v[40:43], v[120:123], v[28:31]
  buffer_load_dwordx4 v[120:123], v21, s[36:39], s70 offen offset:2048 nt
  v_and_b32 v44, v39, v8
  v_and_b32 v45, v39, v9
  v_and_b32 v46, v39, v10
  v_and_b32 v47, v39, v11
  s_waitcnt vmcnt(18)
  s_nop 1
  v_mfma_f32_16x16x32_bf16 v[28:31], v[44:47], v[124:127], v[28:31]
  buffer_load_dwordx4 v[124:127], v21, s[36:39], s70 offen offset:3072 nt
  s_add_u32 s70, s70, 16384
  s_mov_b32 s71, 6144
  buffer_load_dwordx4 a[12:15], v13, s[40:43], s71 offen
  s_waitcnt lgkmcnt(0)
  ds_read_b128 v[36:39], v22 offset:576
  v_and_b32 v40, v32, v8
  v_and_b32 v41, v32, v9
  v_and_b32 v42, v32, v10
  v_and_b32 v43, v32, v11
  s_waitcnt vmcnt(19)
  s_nop 1
  v_mfma_f32_16x16x32_bf16 v[28:31], v[40:43], v[64:67], v[28:31]
  buffer_load_dwordx4 v[64:67], v21, s[36:39], s70 offen offset:0 nt
  v_and_b32 v44, v33, v8
  v_and_b32 v45, v33, v9
  v_and_b32 v46, v33, v10
  v_and_b32 v47, v33, v11
  s_waitcnt vmcnt(19)
  s_nop 1
  v_mfma_f32_16x16x32_bf16 v[28:31], v[44:47], v[68:71], v[28:31]
  buffer_load_dwordx4 v[68:71], v21, s[36:39], s70 offen offset:1024 nt
  v_and_b32 v40, v34, v8
  v_and_b32 v41, v34, v9
  v_and_b32 v42, v34, v10
  v_and_b32 v43, v34, v11
  s_waitcnt vmcnt(19)
  s_nop 1
  v_mfma_f32_16x16x32_bf16 v[28:31], v[40:43], v[72:75], v[28:31]
  buffer_load_dwordx4 v[72:75], v21, s[36:39], s70 offen offset:2048 nt
  v_and_b32 v44, v35, v8
  v_and_b32 v45, v35, v9
  v_and_b32 v46, v35, v10
  v_and_b32 v47, v35, v11
  s_waitcnt vmcnt(19)
  s_nop 1
  v_mfma_f32_16x16x32_bf16 v[28:31], v[44:47], v[76:79], v[28:31]
  buffer_load_dwordx4 v[76:79], v21, s[36:39], s70 offen offset:3072 nt
  s_add_u32 s70, s70, 16384
  s_mov_b32 s71, 32768
  buffer_load_dwordx4 a[16:19], v13, s[40:43], s71 offen
  s_waitcnt lgkmcnt(0)
  ds_read_b128 v[32:35], v22 offset:640
  v_and_b32 v40, v36, v8
  v_and_b32 v41, v36, v9
  v_and_b32 v42, v36, v10
  v_and_b32 v43, v36, v11
  s_waitcnt vmcnt(19)
  s_nop 1
  v_mfma_f32_16x16x32_bf16 v[28:31], v[40:43], v[80:83], v[28:31]
  buffer_load_dwordx4 v[80:83], v21, s[36:39], s70 offen offset:0 nt
  v_and_b32 v44, v37, v8
  v_and_b32 v45, v37, v9
  v_and_b32 v46, v37, v10
  v_and_b32 v47, v37, v11
  s_waitcnt vmcnt(19)
  s_nop 1
  v_mfma_f32_16x16x32_bf16 v[28:31], v[44:47], v[84:87], v[28:31]
  buffer_load_dwordx4 v[84:87], v21, s[36:39], s70 offen offset:1024 nt
  v_and_b32 v40, v38, v8
  v_and_b32 v41, v38, v9
  v_and_b32 v42, v38, v10
  v_and_b32 v43, v38, v11
  s_waitcnt vmcnt(19)
  s_nop 1
  v_mfma_f32_16x16x32_bf16 v[28:31], v[40:43], v[88:91], v[28:31]
  buffer_load_dwordx4 v[88:91], v21, s[36:39], s70 offen offset:2048 nt
  v_and_b32 v44, v39, v8
  v_and_b32 v45, v39, v9
  v_and_b32 v46, v39, v10
  v_and_b32 v47, v39, v11
  s_waitcnt vmcnt(19)
  s_nop 1
  v_mfma_f32_16x16x32_bf16 v[28:31], v[44:47], v[92:95], v[28:31]
  buffer_load_dwordx4 v[92:95], v21, s[36:39], s70 offen offset:3072 nt
  s_add_u32 s70, s70, 16384
  s_mov_b32 s71, 34816
  buffer_load_dwordx4 a[20:23], v13, s[40:43], s71 offen
  s_waitcnt lgkmcnt(0)
  ds_read_b128 v[36:39], v22 offset:704
  v_and_b32 v40, v32, v8
  v_and_b32 v41, v32, v9
  v_and_b32 v42, v32, v10
  v_and_b32 v43, v32, v11
  s_waitcnt vmcnt(19)
  s_nop 1
  v_mfma_f32_16x16x32_bf16 v[28:31], v[40:43], v[96:99], v[28:31]
  buffer_load_dwordx4 v[96:99], v21, s[36:39], s70 offen offset:0 nt
  v_and_b32 v44, v33, v8
  v_and_b32 v45, v33, v9
  v_and_b32 v46, v33, v10
  v_and_b32 v47, v33, v11
  s_waitcnt vmcnt(19)
  s_nop 1
  v_mfma_f32_16x16x32_bf16 v[28:31], v[44:47], v[100:103], v[28:31]
  buffer_load_dwordx4 v[100:103], v21, s[36:39], s70 offen offset:1024 nt
  v_and_b32 v40, v34, v8
  v_and_b32 v41, v34, v9
  v_and_b32 v42, v34, v10
  v_and_b32 v43, v34, v11
  s_waitcnt vmcnt(19)
  s_nop 1
  v_mfma_f32_16x16x32_bf16 v[28:31], v[40:43], v[104:107], v[28:31]
  buffer_load_dwordx4 v[104:107], v21, s[36:39], s70 offen offset:2048 nt
  v_and_b32 v44, v35, v8
  v_and_b32 v45, v35, v9
  v_and_b32 v46, v35, v10
  v_and_b32 v47, v35, v11
  s_waitcnt vmcnt(19)
  s_nop 1
  v_mfma_f32_16x16x32_bf16 v[28:31], v[44:47], v[108:111], v[28:31]
  buffer_load_dwordx4 v[108:111], v21, s[36:39], s70 offen offset:3072 nt
  s_add_u32 s70, s70, 16384
  s_mov_b32 s71, 36864
  buffer_load_dwordx4 a[24:27], v13, s[40:43], s71 offen
  s_waitcnt lgkmcnt(0)
  ds_read_b128 v[32:35], v22 offset:768
  v_and_b32 v40, v36, v8
  v_and_b32 v41, v36, v9
  v_and_b32 v42, v36, v10
  v_and_b32 v43, v36, v11
  s_waitcnt vmcnt(19)
  s_nop 1
  v_mfma_f32_16x16x32_bf16 v[28:31], v[40:43], v[112:115], v[28:31]
  buffer_load_dwordx4 v[112:115], v21, s[36:39], s70 offen offset:0 nt
  v_and_b32 v44, v37, v8
  v_and_b32 v45, v37, v9
  v_and_b32 v46, v37, v10
  v_and_b32 v47, v37, v11
  s_waitcnt vmcnt(19)
  s_nop 1
  v_mfma_f32_16x16x32_bf16 v[28:31], v[44:47], v[116:119], v[28:31]
  buffer_load_dwordx4 v[116:119], v21, s[36:39], s70 offen offset:1024 nt
  v_and_b32 v40, v38, v8
  v_and_b32 v41, v38, v9
  v_and_b32 v42, v38, v10
  v_and_b32 v43, v38, v11
  s_waitcnt vmcnt(19)
  s_nop 1
  v_mfma_f32_16x16x32_bf16 v[28:31], v[40:43], v[120:123], v[28:31]
  buffer_load_dwordx4 v[120:123], v21, s[36:39], s70 offen offset:2048 nt
  v_and_b32 v44, v39, v8
  v_and_b32 v45, v39, v9
  v_and_b32 v46, v39, v10
  v_and_b32 v47, v39, v11
  s_waitcnt vmcnt(19)
  s_nop 1
  v_mfma_f32_16x16x32_bf16 v[28:31], v[44:47], v[124:127], v[28:31]
  buffer_load_dwordx4 v[124:127], v21, s[36:39], s70 offen offset:3072 nt
  s_add_u32 s70, s70, 16384
  s_mov_b32 s71, 38912
  buffer_load_dwordx4 a[28:31], v13, s[40:43], s71 offen
  s_waitcnt lgkmcnt(0)
  ds_read_b128 v[36:39], v22 offset:832
  v_and_b32 v40, v32, v8
  v_and_b32 v41, v32, v9
  v_and_b32 v42, v32, v10
  v_and_b32 v43, v32, v11
  s_waitcnt vmcnt(19)
  s_nop 1
  v_mfma_f32_16x16x32_bf16 v[28:31], v[40:43], v[64:67], v[28:31]
  buffer_load_dwordx4 v[64:67], v21, s[36:39], s70 offen offset:0 nt
  v_and_b32 v44, v33, v8
  v_and_b32 v45, v33, v9
  v_and_b32 v46, v33, v10
  v_and_b32 v47, v33, v11
  s_waitcnt vmcnt(19)
  s_nop 1
  v_mfma_f32_16x16x32_bf16 v[28:31], v[44:47], v[68:71], v[28:31]
  buffer_load_dwordx4 v[68:71], v21, s[36:39], s70 offen offset:1024 nt
  v_and_b32 v40, v34, v8
  v_and_b32 v41, v34, v9
  v_and_b32 v42, v34, v10
  v_and_b32 v43, v34, v11
  s_waitcnt vmcnt(19)
  s_nop 1
  v_mfma_f32_16x16x32_bf16 v[28:31], v[40:43], v[72:75], v[28:31]
  buffer_load_dwordx4 v[72:75], v21, s[36:39], s70 offen offset:2048 nt
  v_and_b32 v44, v35, v8
  v_and_b32 v45, v35, v9
  v_and_b32 v46, v35, v10
  v_and_b32 v47, v35, v11
  s_waitcnt vmcnt(19)
  s_nop 1
  v_mfma_f32_16x16x32_bf16 v[28:31], v[44:47], v[76:79], v[28:31]
  buffer_load_dwordx4 v[76:79], v21, s[36:39], s70 offen offset:3072 nt
  s_add_u32 s70, s70, 16384
  s_mov_b32 s71, 65536
  buffer_load_dwordx4 a[32:35], v13, s[40:43], s71 offen
  s_waitcnt lgkmcnt(0)
  ds_read_b128 v[32:35], v22 offset:896
  v_and_b32 v40, v36, v8
  v_and_b32 v41, v36, v9
  v_and_b32 v42, v36, v10
  v_and_b32 v43, v36, v11
  s_waitcnt vmcnt(19)
  s_nop 1
  v_mfma_f32_16x16x32_bf16 v[28:31], v[40:43], v[80:83], v[28:31]
  buffer_load_dwordx4 v[80:83], v21, s[36:39], s70 offen offset:0 nt
  v_and_b32 v44, v37, v8
  v_and_b32 v45, v37, v9
  v_and_b32 v46, v37, v10
  v_and_b32 v47, v37, v11
  s_waitcnt vmcnt(19)
  s_nop 1
  v_mfma_f32_16x16x32_bf16 v[28:31], v[44:47], v[84:87], v[28:31]
  buffer_load_dwordx4 v[84:87], v21, s[36:39], s70 offen offset:1024 nt
  v_and_b32 v40, v38, v8
  v_and_b32 v41, v38, v9
  v_and_b32 v42, v38, v10
  v_and_b32 v43, v38, v11
  s_waitcnt vmcnt(19)
  s_nop 1
  v_mfma_f32_16x16x32_bf16 v[28:31], v[40:43], v[88:91], v[28:31]
  buffer_load_dwordx4 v[88:91], v21, s[36:39], s70 offen offset:2048 nt
  v_and_b32 v44, v39, v8
  v_and_b32 v45, v39, v9
  v_and_b32 v46, v39, v10
  v_and_b32 v47, v39, v11
  s_waitcnt vmcnt(19)
  s_nop 1
  v_mfma_f32_16x16x32_bf16 v[28:31], v[44:47], v[92:95], v[28:31]
  buffer_load_dwordx4 v[92:95], v21, s[36:39], s70 offen offset:3072 nt
  s_add_u32 s70, s70, 16384
  s_mov_b32 s71, 67584
  buffer_load_dwordx4 a[36:39], v13, s[40:43], s71 offen
  s_waitcnt lgkmcnt(0)
  ds_read_b128 v[36:39], v22 offset:960
  v_and_b32 v40, v32, v8
  v_and_b32 v41, v32, v9
  v_and_b32 v42, v32, v10
  v_and_b32 v43, v32, v11
  s_waitcnt vmcnt(19)
  s_nop 1
  v_mfma_f32_16x16x32_bf16 v[28:31], v[40:43], v[96:99], v[28:31]
  buffer_load_dwordx4 v[96:99], v21, s[36:39], s70 offen offset:0 nt
  v_and_b32 v44, v33, v8
  v_and_b32 v45, v33, v9
  v_and_b32 v46, v33, v10
  v_and_b32 v47, v33, v11
  s_waitcnt vmcnt(19)
  s_nop 1
  v_mfma_f32_16x16x32_bf16 v[28:31], v[44:47], v[100:103], v[28:31]
  buffer_load_dwordx4 v[100:103], v21, s[36:39], s70 offen offset:1024 nt
  v_and_b32 v40, v34, v8
  v_and_b32 v41, v34, v9
  v_and_b32 v42, v34, v10
  v_and_b32 v43, v34, v11
  s_waitcnt vmcnt(19)
  s_nop 1
  v_mfma_f32_16x16x32_bf16 v[28:31], v[40:43], v[104:107], v[28:31]
  buffer_load_dwordx4 v[104:107], v21, s[36:39], s70 offen offset:2048 nt
  v_and_b32 v44, v35, v8
  v_and_b32 v45, v35, v9
  v_and_b32 v46, v35, v10
  v_and_b32 v47, v35, v11
  s_waitcnt vmcnt(19)
  s_nop 1
  v_mfma_f32_16x16x32_bf16 v[28:31], v[44:47], v[108:111], v[28:31]
  buffer_load_dwordx4 v[108:111], v21, s[36:39], s70 offen offset:3072 nt
  s_add_u32 s70, s70, 16384
  s_mov_b32 s71, 69632
  buffer_load_dwordx4 a[40:43], v13, s[40:43], s71 offen
  s_waitcnt lgkmcnt(0)
  ds_read_b128 v[32:35], v22 offset:1024
  v_and_b32 v40, v36, v8
  v_and_b32 v41, v36, v9
  v_and_b32 v42, v36, v10
  v_and_b32 v43, v36, v11
  s_waitcnt vmcnt(19)
  s_nop 1
  v_mfma_f32_16x16x32_bf16 v[28:31], v[40:43], v[112:115], v[28:31]
  buffer_load_dwordx4 v[112:115], v21, s[36:39], s70 offen offset:0 nt
  v_and_b32 v44, v37, v8
  v_and_b32 v45, v37, v9
  v_and_b32 v46, v37, v10
  v_and_b32 v47, v37, v11
  s_waitcnt vmcnt(19)
  s_nop 1
  v_mfma_f32_16x16x32_bf16 v[28:31], v[44:47], v[116:119], v[28:31]
  buffer_load_dwordx4 v[116:119], v21, s[36:39], s70 offen offset:1024 nt
  v_and_b32 v40, v38, v8
  v_and_b32 v41, v38, v9
  v_and_b32 v42, v38, v10
  v_and_b32 v43, v38, v11
  s_waitcnt vmcnt(19)
  s_nop 1
  v_mfma_f32_16x16x32_bf16 v[28:31], v[40:43], v[120:123], v[28:31]
  buffer_load_dwordx4 v[120:123], v21, s[36:39], s70 offen offset:2048 nt
  v_and_b32 v44, v39, v8
  v_and_b32 v45, v39, v9
  v_and_b32 v46, v39, v10
  v_and_b32 v47, v39, v11
  s_waitcnt vmcnt(19)
  s_nop 1
  v_mfma_f32_16x16x32_bf16 v[28:31], v[44:47], v[124:127], v[28:31]
  buffer_load_dwordx4 v[124:127], v21, s[36:39], s70 offen offset:3072 nt
  s_add_u32 s70, s70, 16384
  s_mov_b32 s71, 71680
  buffer_load_dwordx4 a[44:47], v13, s[40:43], s71 offen
  s_waitcnt lgkmcnt(0)
  ds_read_b128 v[36:39], v22 offset:1088
  v_and_b32 v40, v32, v8
  v_and_b32 v41, v32, v9
  v_and_b32 v42, v32, v10
  v_and_b32 v43, v32, v11
  s_waitcnt vmcnt(19)
  s_nop 1
  v_mfma_f32_16x16x32_bf16 v[28:31], v[40:43], v[64:67], v[28:31]
  buffer_load_dwordx4 v[64:67], v21, s[36:39], s70 offen offset:0 nt
  v_and_b32 v44, v33, v8
  v_and_b32 v45, v33, v9
  v_and_b32 v46, v33, v10
  v_and_b32 v47, v33, v11
  s_waitcnt vmcnt(19)
  s_nop 1
  v_mfma_f32_16x16x32_bf16 v[28:31], v[44:47], v[68:71], v[28:31]
  buffer_load_dwordx4 v[68:71], v21, s[36:39], s70 offen offset:1024 nt
  v_and_b32 v40, v34, v8
  v_and_b32 v41, v34, v9
  v_and_b32 v42, v34, v10
  v_and_b32 v43, v34, v11
  s_waitcnt vmcnt(19)
  s_nop 1
  v_mfma_f32_16x16x32_bf16 v[28:31], v[40:43], v[72:75], v[28:31]
  buffer_load_dwordx4 v[72:75], v21, s[36:39], s70 offen offset:2048 nt
  v_and_b32 v44, v35, v8
  v_and_b32 v45, v35, v9
  v_and_b32 v46, v35, v10
  v_and_b32 v47, v35, v11
  s_waitcnt vmcnt(19)
  s_nop 1
  v_mfma_f32_16x16x32_bf16 v[28:31], v[44:47], v[76:79], v[28:31]
  buffer_load_dwordx4 v[76:79], v21, s[36:39], s70 offen offset:3072 nt
  s_add_u32 s70, s70, 16384
  s_mov_b32 s71, 98304
  buffer_load_dwordx4 a[48:51], v13, s[40:43], s71 offen
  s_waitcnt lgkmcnt(0)
  ds_read_b128 v[32:35], v22 offset:1152
  v_and_b32 v40, v36, v8
  v_and_b32 v41, v36, v9
  v_and_b32 v42, v36, v10
  v_and_b32 v43, v36, v11
  s_waitcnt vmcnt(19)
  s_nop 1
  v_mfma_f32_16x16x32_bf16 v[28:31], v[40:43], v[80:83], v[28:31]
  buffer_load_dwordx4 v[80:83], v21, s[36:39], s70 offen offset:0 nt
  v_and_b32 v44, v37, v8
  v_and_b32 v45, v37, v9
  v_and_b32 v46, v37, v10
  v_and_b32 v47, v37, v11
  s_waitcnt vmcnt(19)
  s_nop 1
  v_mfma_f32_16x16x32_bf16 v[28:31], v[44:47], v[84:87], v[28:31]
  buffer_load_dwordx4 v[84:87], v21, s[36:39], s70 offen offset:1024 nt
  v_and_b32 v40, v38, v8
  v_and_b32 v41, v38, v9
  v_and_b32 v42, v38, v10
  v_and_b32 v43, v38, v11
  s_waitcnt vmcnt(19)
  s_nop 1
  v_mfma_f32_16x16x32_bf16 v[28:31], v[40:43], v[88:91], v[28:31]
  buffer_load_dwordx4 v[88:91], v21, s[36:39], s70 offen offset:2048 nt
  v_and_b32 v44, v39, v8
  v_and_b32 v45, v39, v9
  v_and_b32 v46, v39, v10
  v_and_b32 v47, v39, v11
  s_waitcnt vmcnt(19)
  s_nop 1
  v_mfma_f32_16x16x32_bf16 v[28:31], v[44:47], v[92:95], v[28:31]
  buffer_load_dwordx4 v[92:95], v21, s[36:39], s70 offen offset:3072 nt
  s_add_u32 s70, s70, 16384
  s_mov_b32 s71, 100352
  buffer_load_dwordx4 a[52:55], v13, s[40:43], s71 offen
  s_waitcnt lgkmcnt(0)
  ds_read_b128 v[36:39], v22 offset:1216
  v_and_b32 v40, v32, v8
  v_and_b32 v41, v32, v9
  v_and_b32 v42, v32, v10
  v_and_b32 v43, v32, v11
  s_waitcnt vmcnt(19)
  s_nop 1
  v_mfma_f32_16x16x32_bf16 v[28:31], v[40:43], v[96:99], v[28:31]
  buffer_load_dwordx4 v[96:99], v21, s[36:39], s70 offen offset:0 nt
  v_and_b32 v44, v33, v8
  v_and_b32 v45, v33, v9
  v_and_b32 v46, v33, v10
  v_and_b32 v47, v33, v11
  s_waitcnt vmcnt(19)
  s_nop 1
  v_mfma_f32_16x16x32_bf16 v[28:31], v[44:47], v[100:103], v[28:31]
  buffer_load_dwordx4 v[100:103], v21, s[36:39], s70 offen offset:1024 nt
  v_and_b32 v40, v34, v8
  v_and_b32 v41, v34, v9
  v_and_b32 v42, v34, v10
  v_and_b32 v43, v34, v11
  s_waitcnt vmcnt(19)
  s_nop 1
  v_mfma_f32_16x16x32_bf16 v[28:31], v[40:43], v[104:107], v[28:31]
  buffer_load_dwordx4 v[104:107], v21, s[36:39], s70 offen offset:2048 nt
  v_and_b32 v44, v35, v8
  v_and_b32 v45, v35, v9
  v_and_b32 v46, v35, v10
  v_and_b32 v47, v35, v11
  s_waitcnt vmcnt(19)
  s_nop 1
  v_mfma_f32_16x16x32_bf16 v[28:31], v[44:47], v[108:111], v[28:31]
  buffer_load_dwordx4 v[108:111], v21, s[36:39], s70 offen offset:3072 nt
  s_add_u32 s70, s70, 16384
  s_mov_b32 s71, 102400
  buffer_load_dwordx4 a[56:59], v13, s[40:43], s71 offen
  s_waitcnt lgkmcnt(0)
  ds_read_b128 v[32:35], v22 offset:1280
  v_and_b32 v40, v36, v8
  v_and_b32 v41, v36, v9
  v_and_b32 v42, v36, v10
  v_and_b32 v43, v36, v11
  s_waitcnt vmcnt(19)
  s_nop 1
  v_mfma_f32_16x16x32_bf16 v[28:31], v[40:43], v[112:115], v[28:31]
  buffer_load_dwordx4 v[112:115], v21, s[36:39], s70 offen offset:0 nt
  v_and_b32 v44, v37, v8
  v_and_b32 v45, v37, v9
  v_and_b32 v46, v37, v10
  v_and_b32 v47, v37, v11
  s_waitcnt vmcnt(19)
  s_nop 1
  v_mfma_f32_16x16x32_bf16 v[28:31], v[44:47], v[116:119], v[28:31]
  buffer_load_dwordx4 v[116:119], v21, s[36:39], s70 offen offset:1024 nt
  v_and_b32 v40, v38, v8
  v_and_b32 v41, v38, v9
  v_and_b32 v42, v38, v10
  v_and_b32 v43, v38, v11
  s_waitcnt vmcnt(19)
  s_nop 1
  v_mfma_f32_16x16x32_bf16 v[28:31], v[40:43], v[120:123], v[28:31]
  buffer_load_dwordx4 v[120:123], v21, s[36:39], s70 offen offset:2048 nt
  v_and_b32 v44, v39, v8
  v_and_b32 v45, v39, v9
  v_and_b32 v46, v39, v10
  v_and_b32 v47, v39, v11
  s_waitcnt vmcnt(19)
  s_nop 1
  v_mfma_f32_16x16x32_bf16 v[28:31], v[44:47], v[124:127], v[28:31]
  buffer_load_dwordx4 v[124:127], v21, s[36:39], s70 offen offset:3072 nt
  s_add_u32 s70, s70, 16384
  s_mov_b32 s71, 104448
  buffer_load_dwordx4 a[60:63], v13, s[40:43], s71 offen
  s_waitcnt lgkmcnt(0)
  ds_read_b128 v[36:39], v22 offset:1344
  v_and_b32 v40, v32, v8
  v_and_b32 v41, v32, v9
  v_and_b32 v42, v32, v10
  v_and_b32 v43, v32, v11
  s_waitcnt vmcnt(19)
  s_nop 1
  v_mfma_f32_16x16x32_bf16 v[28:31], v[40:43], v[64:67], v[28:31]
  buffer_load_dwordx4 v[64:67], v21, s[36:39], s70 offen offset:0 nt
  v_and_b32 v44, v33, v8
  v_and_b32 v45, v33, v9
  v_and_b32 v46, v33, v10
  v_and_b32 v47, v33, v11
  s_waitcnt vmcnt(19)
  s_nop 1
  v_mfma_f32_16x16x32_bf16 v[28:31], v[44:47], v[68:71], v[28:31]
  buffer_load_dwordx4 v[68:71], v21, s[36:39], s70 offen offset:1024 nt
  v_and_b32 v40, v34, v8
  v_and_b32 v41, v34, v9
  v_and_b32 v42, v34, v10
  v_and_b32 v43, v34, v11
  s_waitcnt vmcnt(19)
  s_nop 1
  v_mfma_f32_16x16x32_bf16 v[28:31], v[40:43], v[72:75], v[28:31]
  buffer_load_dwordx4 v[72:75], v21, s[36:39], s70 offen offset:2048 nt
  v_and_b32 v44, v35, v8
  v_and_b32 v45, v35, v9
  v_and_b32 v46, v35, v10
  v_and_b32 v47, v35, v11
  s_waitcnt vmcnt(19)
  s_nop 1
  v_mfma_f32_16x16x32_bf16 v[28:31], v[44:47], v[76:79], v[28:31]
  buffer_load_dwordx4 v[76:79], v21, s[36:39], s70 offen offset:3072 nt
  s_add_u32 s70, s70, 16384
  s_mov_b32 s71, 131072
  buffer_load_dwordx4 a[64:67], v13, s[40:43], s71 offen
  s_waitcnt lgkmcnt(0)
  ds_read_b128 v[32:35], v22 offset:1408
  v_and_b32 v40, v36, v8
  v_and_b32 v41, v36, v9
  v_and_b32 v42, v36, v10
  v_and_b32 v43, v36, v11
  s_waitcnt vmcnt(19)
  s_nop 1
  v_mfma_f32_16x16x32_bf16 v[28:31], v[40:43], v[80:83], v[28:31]
  buffer_load_dwordx4 v[80:83], v21, s[36:39], s70 offen offset:0 nt
  v_and_b32 v44, v37, v8
  v_and_b32 v45, v37, v9
  v_and_b32 v46, v37, v10
  v_and_b32 v47, v37, v11
  s_waitcnt vmcnt(19)
  s_nop 1
  v_mfma_f32_16x16x32_bf16 v[28:31], v[44:47], v[84:87], v[28:31]
  buffer_load_dwordx4 v[84:87], v21, s[36:39], s70 offen offset:1024 nt
  v_and_b32 v40, v38, v8
  v_and_b32 v41, v38, v9
  v_and_b32 v42, v38, v10
  v_and_b32 v43, v38, v11
  s_waitcnt vmcnt(19)
  s_nop 1
  v_mfma_f32_16x16x32_bf16 v[28:31], v[40:43], v[88:91], v[28:31]
  buffer_load_dwordx4 v[88:91], v21, s[36:39], s70 offen offset:2048 nt
  v_and_b32 v44, v39, v8
  v_and_b32 v45, v39, v9
  v_and_b32 v46, v39, v10
  v_and_b32 v47, v39, v11
  s_waitcnt vmcnt(19)
  s_nop 1
  v_mfma_f32_16x16x32_bf16 v[28:31], v[44:47], v[92:95], v[28:31]
  buffer_load_dwordx4 v[92:95], v21, s[36:39], s70 offen offset:3072 nt
  s_add_u32 s70, s70, 16384
  s_mov_b32 s71, 133120
  buffer_load_dwordx4 a[68:71], v13, s[40:43], s71 offen
  s_waitcnt lgkmcnt(0)
  ds_read_b128 v[36:39], v22 offset:1472
  v_and_b32 v40, v32, v8
  v_and_b32 v41, v32, v9
  v_and_b32 v42, v32, v10
  v_and_b32 v43, v32, v11
  s_waitcnt vmcnt(19)
  s_nop 1
  v_mfma_f32_16x16x32_bf16 v[28:31], v[40:43], v[96:99], v[28:31]
  buffer_load_dwordx4 v[96:99], v21, s[36:39], s70 offen offset:0 nt
  v_and_b32 v44, v33, v8
  v_and_b32 v45, v33, v9
  v_and_b32 v46, v33, v10
  v_and_b32 v47, v33, v11
  s_waitcnt vmcnt(19)
  s_nop 1
  v_mfma_f32_16x16x32_bf16 v[28:31], v[44:47], v[100:103], v[28:31]
  buffer_load_dwordx4 v[100:103], v21, s[36:39], s70 offen offset:1024 nt
  v_and_b32 v40, v34, v8
  v_and_b32 v41, v34, v9
  v_and_b32 v42, v34, v10
  v_and_b32 v43, v34, v11
  s_waitcnt vmcnt(19)
  s_nop 1
  v_mfma_f32_16x16x32_bf16 v[28:31], v[40:43], v[104:107], v[28:31]
  buffer_load_dwordx4 v[104:107], v21, s[36:39], s70 offen offset:2048 nt
  v_and_b32 v44, v35, v8
  v_and_b32 v45, v35, v9
  v_and_b32 v46, v35, v10
  v_and_b32 v47, v35, v11
  s_waitcnt vmcnt(19)
  s_nop 1
  v_mfma_f32_16x16x32_bf16 v[28:31], v[44:47], v[108:111], v[28:31]
  buffer_load_dwordx4 v[108:111], v21, s[36:39], s70 offen offset:3072 nt
  s_add_u32 s70, s70, 16384
  s_mov_b32 s71, 135168
  buffer_load_dwordx4 a[72:75], v13, s[40:43], s71 offen
  s_waitcnt lgkmcnt(0)
  ds_read_b128 v[32:35], v22 offset:1536
  v_and_b32 v40, v36, v8
  v_and_b32 v41, v36, v9
  v_and_b32 v42, v36, v10
  v_and_b32 v43, v36, v11
  s_waitcnt vmcnt(19)
  s_nop 1
  v_mfma_f32_16x16x32_bf16 v[28:31], v[40:43], v[112:115], v[28:31]
  buffer_load_dwordx4 v[112:115], v21, s[36:39], s70 offen offset:0 nt
  v_and_b32 v44, v37, v8
  v_and_b32 v45, v37, v9
  v_and_b32 v46, v37, v10
  v_and_b32 v47, v37, v11
  s_waitcnt vmcnt(19)
  s_nop 1
  v_mfma_f32_16x16x32_bf16 v[28:31], v[44:47], v[116:119], v[28:31]
  buffer_load_dwordx4 v[116:119], v21, s[36:39], s70 offen offset:1024 nt
  v_and_b32 v40, v38, v8
  v_and_b32 v41, v38, v9
  v_and_b32 v42, v38, v10
  v_and_b32 v43, v38, v11
  s_waitcnt vmcnt(19)
  s_nop 1
  v_mfma_f32_16x16x32_bf16 v[28:31], v[40:43], v[120:123], v[28:31]
  buffer_load_dwordx4 v[120:123], v21, s[36:39], s70 offen offset:2048 nt
  v_and_b32 v44, v39, v8
  v_and_b32 v45, v39, v9
  v_and_b32 v46, v39, v10
  v_and_b32 v47, v39, v11
  s_waitcnt vmcnt(19)
  s_nop 1
  v_mfma_f32_16x16x32_bf16 v[28:31], v[44:47], v[124:127], v[28:31]
  buffer_load_dwordx4 v[124:127], v21, s[36:39], s70 offen offset:3072 nt
  s_add_u32 s70, s70, 16384
  s_mov_b32 s71, 137216
  buffer_load_dwordx4 a[76:79], v13, s[40:43], s71 offen
  s_waitcnt lgkmcnt(0)
  ds_read_b128 v[36:39], v22 offset:1600
  v_and_b32 v40, v32, v8
  v_and_b32 v41, v32, v9
  v_and_b32 v42, v32, v10
  v_and_b32 v43, v32, v11
  s_waitcnt vmcnt(19)
  s_nop 1
  v_mfma_f32_16x16x32_bf16 v[28:31], v[40:43], v[64:67], v[28:31]
  buffer_load_dwordx4 v[64:67], v21, s[36:39], s70 offen offset:0 nt
  v_and_b32 v44, v33, v8
  v_and_b32 v45, v33, v9
  v_and_b32 v46, v33, v10
  v_and_b32 v47, v33, v11
  s_waitcnt vmcnt(19)
  s_nop 1
  v_mfma_f32_16x16x32_bf16 v[28:31], v[44:47], v[68:71], v[28:31]
  buffer_load_dwordx4 v[68:71], v21, s[36:39], s70 offen offset:1024 nt
  v_and_b32 v40, v34, v8
  v_and_b32 v41, v34, v9
  v_and_b32 v42, v34, v10
  v_and_b32 v43, v34, v11
  s_waitcnt vmcnt(19)
  s_nop 1
  v_mfma_f32_16x16x32_bf16 v[28:31], v[40:43], v[72:75], v[28:31]
  buffer_load_dwordx4 v[72:75], v21, s[36:39], s70 offen offset:2048 nt
  v_and_b32 v44, v35, v8
  v_and_b32 v45, v35, v9
  v_and_b32 v46, v35, v10
  v_and_b32 v47, v35, v11
  s_waitcnt vmcnt(19)
  s_nop 1
  v_mfma_f32_16x16x32_bf16 v[28:31], v[44:47], v[76:79], v[28:31]
  buffer_load_dwordx4 v[76:79], v21, s[36:39], s70 offen offset:3072 nt
  s_add_u32 s70, s70, 16384
  s_mov_b32 s71, 163840
  buffer_load_dwordx4 a[80:83], v13, s[40:43], s71 offen
  s_waitcnt lgkmcnt(0)
  s_mov_b64 exec, 1
  v_mov_b32 v19, 1
  ds_add_u32 v7, v19 offset:31056
  s_mov_b64 exec, -1
  s_waitcnt lgkmcnt(0)
  ds_read_b128 v[32:35], v22 offset:1664
  v_and_b32 v40, v36, v8
  v_and_b32 v41, v36, v9
  v_and_b32 v42, v36, v10
  v_and_b32 v43, v36, v11
  s_waitcnt vmcnt(19)
  s_nop 1
  v_mfma_f32_16x16x32_bf16 v[28:31], v[40:43], v[80:83], v[28:31]
  buffer_load_dwordx4 v[80:83], v21, s[36:39], s70 offen offset:0 nt
  v_and_b32 v44, v37, v8
  v_and_b32 v45, v37, v9
  v_and_b32 v46, v37, v10
  v_and_b32 v47, v37, v11
  s_waitcnt vmcnt(19)
  s_nop 1
  v_mfma_f32_16x16x32_bf16 v[28:31], v[44:47], v[84:87], v[28:31]
  buffer_load_dwordx4 v[84:87], v21, s[36:39], s70 offen offset:1024 nt
  v_and_b32 v40, v38, v8
  v_and_b32 v41, v38, v9
  v_and_b32 v42, v38, v10
  v_and_b32 v43, v38, v11
  s_waitcnt vmcnt(19)
  s_nop 1
  v_mfma_f32_16x16x32_bf16 v[28:31], v[40:43], v[88:91], v[28:31]
  buffer_load_dwordx4 v[88:91], v21, s[36:39], s70 offen offset:2048 nt
  v_and_b32 v44, v39, v8
  v_and_b32 v45, v39, v9
  v_and_b32 v46, v39, v10
  v_and_b32 v47, v39, v11
  s_waitcnt vmcnt(19)
  s_nop 1
  v_mfma_f32_16x16x32_bf16 v[28:31], v[44:47], v[92:95], v[28:31]
  buffer_load_dwordx4 v[92:95], v21, s[36:39], s70 offen offset:3072 nt
  s_add_u32 s70, s70, 16384
  s_mov_b32 s71, 165888
  buffer_load_dwordx4 a[84:87], v13, s[40:43], s71 offen
  s_waitcnt lgkmcnt(0)
  ds_read_b128 v[36:39], v22 offset:1728
  v_and_b32 v40, v32, v8
  v_and_b32 v41, v32, v9
  v_and_b32 v42, v32, v10
  v_and_b32 v43, v32, v11
  s_waitcnt vmcnt(19)
  s_nop 1
  v_mfma_f32_16x16x32_bf16 v[28:31], v[40:43], v[96:99], v[28:31]
  buffer_load_dwordx4 v[96:99], v21, s[36:39], s70 offen offset:0 nt
  v_and_b32 v44, v33, v8
  v_and_b32 v45, v33, v9
  v_and_b32 v46, v33, v10
  v_and_b32 v47, v33, v11
  s_waitcnt vmcnt(19)
  s_nop 1
  v_mfma_f32_16x16x32_bf16 v[28:31], v[44:47], v[100:103], v[28:31]
  buffer_load_dwordx4 v[100:103], v21, s[36:39], s70 offen offset:1024 nt
  v_and_b32 v40, v34, v8
  v_and_b32 v41, v34, v9
  v_and_b32 v42, v34, v10
  v_and_b32 v43, v34, v11
  s_waitcnt vmcnt(19)
  s_nop 1
  v_mfma_f32_16x16x32_bf16 v[28:31], v[40:43], v[104:107], v[28:31]
  buffer_load_dwordx4 v[104:107], v21, s[36:39], s70 offen offset:2048 nt
  v_and_b32 v44, v35, v8
  v_and_b32 v45, v35, v9
  v_and_b32 v46, v35, v10
  v_and_b32 v47, v35, v11
  s_waitcnt vmcnt(19)
  s_nop 1
  v_mfma_f32_16x16x32_bf16 v[28:31], v[44:47], v[108:111], v[28:31]
  buffer_load_dwordx4 v[108:111], v21, s[36:39], s70 offen offset:3072 nt
  s_add_u32 s70, s70, 16384
  s_mov_b32 s71, 167936
  buffer_load_dwordx4 a[88:91], v13, s[40:43], s71 offen
  s_waitcnt lgkmcnt(0)
  ds_read_b128 v[32:35], v22 offset:1792
  v_and_b32 v40, v36, v8
  v_and_b32 v41, v36, v9
  v_and_b32 v42, v36, v10
  v_and_b32 v43, v36, v11
  s_waitcnt vmcnt(19)
  s_nop 1
  v_mfma_f32_16x16x32_bf16 v[28:31], v[40:43], v[112:115], v[28:31]
  buffer_load_dwordx4 v[112:115], v21, s[36:39], s70 offen offset:0 nt
  v_and_b32 v44, v37, v8
  v_and_b32 v45, v37, v9
  v_and_b32 v46, v37, v10
  v_and_b32 v47, v37, v11
  s_waitcnt vmcnt(19)
  s_nop 1
  v_mfma_f32_16x16x32_bf16 v[28:31], v[44:47], v[116:119], v[28:31]
  buffer_load_dwordx4 v[116:119], v21, s[36:39], s70 offen offset:1024 nt
  v_and_b32 v40, v38, v8
  v_and_b32 v41, v38, v9
  v_and_b32 v42, v38, v10
  v_and_b32 v43, v38, v11
  s_waitcnt vmcnt(19)
  s_nop 1
  v_mfma_f32_16x16x32_bf16 v[28:31], v[40:43], v[120:123], v[28:31]
  buffer_load_dwordx4 v[120:123], v21, s[36:39], s70 offen offset:2048 nt
  v_and_b32 v44, v39, v8
  v_and_b32 v45, v39, v9
  v_and_b32 v46, v39, v10
  v_and_b32 v47, v39, v11
  s_waitcnt vmcnt(19)
  s_nop 1
  v_mfma_f32_16x16x32_bf16 v[28:31], v[44:47], v[124:127], v[28:31]
  buffer_load_dwordx4 v[124:127], v21, s[36:39], s70 offen offset:3072 nt
  s_add_u32 s70, s70, 16384
  s_mov_b32 s71, 169984
  buffer_load_dwordx4 a[92:95], v13, s[40:43], s71 offen
  s_waitcnt lgkmcnt(0)
  ds_read_b128 v[36:39], v22 offset:1856
  v_and_b32 v40, v32, v8
  v_and_b32 v41, v32, v9
  v_and_b32 v42, v32, v10
  v_and_b32 v43, v32, v11
  s_waitcnt vmcnt(19)
  s_nop 1
  v_mfma_f32_16x16x32_bf16 v[28:31], v[40:43], v[64:67], v[28:31]
  buffer_load_dwordx4 v[64:67], v21, s[36:39], s70 offen offset:0 nt
  v_and_b32 v44, v33, v8
  v_and_b32 v45, v33, v9
  v_and_b32 v46, v33, v10
  v_and_b32 v47, v33, v11
  s_waitcnt vmcnt(19)
  s_nop 1
  v_mfma_f32_16x16x32_bf16 v[28:31], v[44:47], v[68:71], v[28:31]
  buffer_load_dwordx4 v[68:71], v21, s[36:39], s70 offen offset:1024 nt
  v_and_b32 v40, v34, v8
  v_and_b32 v41, v34, v9
  v_and_b32 v42, v34, v10
  v_and_b32 v43, v34, v11
  s_waitcnt vmcnt(19)
  s_nop 1
  v_mfma_f32_16x16x32_bf16 v[28:31], v[40:43], v[72:75], v[28:31]
  buffer_load_dwordx4 v[72:75], v21, s[36:39], s70 offen offset:2048 nt
  v_and_b32 v44, v35, v8
  v_and_b32 v45, v35, v9
  v_and_b32 v46, v35, v10
  v_and_b32 v47, v35, v11
  s_waitcnt vmcnt(19)
  s_nop 1
  v_mfma_f32_16x16x32_bf16 v[28:31], v[44:47], v[76:79], v[28:31]
  buffer_load_dwordx4 v[76:79], v21, s[36:39], s70 offen offset:3072 nt
  s_add_u32 s70, s70, 16384
  s_mov_b32 s71, 196608
  buffer_load_dwordx4 a[96:99], v13, s[40:43], s71 offen
  s_waitcnt lgkmcnt(0)
  ds_read_b128 v[32:35], v22 offset:1920
  v_and_b32 v40, v36, v8
  v_and_b32 v41, v36, v9
  v_and_b32 v42, v36, v10
  v_and_b32 v43, v36, v11
  s_waitcnt vmcnt(19)
  s_nop 1
  v_mfma_f32_16x16x32_bf16 v[28:31], v[40:43], v[80:83], v[28:31]
  buffer_load_dwordx4 v[80:83], v21, s[36:39], s70 offen offset:0 nt
  v_and_b32 v44, v37, v8
  v_and_b32 v45, v37, v9
  v_and_b32 v46, v37, v10
  v_and_b32 v47, v37, v11
  s_waitcnt vmcnt(19)
  s_nop 1
  v_mfma_f32_16x16x32_bf16 v[28:31], v[44:47], v[84:87], v[28:31]
  buffer_load_dwordx4 v[84:87], v21, s[36:39], s70 offen offset:1024 nt
  v_and_b32 v40, v38, v8
  v_and_b32 v41, v38, v9
  v_and_b32 v42, v38, v10
  v_and_b32 v43, v38, v11
  s_waitcnt vmcnt(19)
  s_nop 1
  v_mfma_f32_16x16x32_bf16 v[28:31], v[40:43], v[88:91], v[28:31]
  buffer_load_dwordx4 v[88:91], v21, s[36:39], s70 offen offset:2048 nt
  v_and_b32 v44, v39, v8
  v_and_b32 v45, v39, v9
  v_and_b32 v46, v39, v10
  v_and_b32 v47, v39, v11
  s_waitcnt vmcnt(19)
  s_nop 1
  v_mfma_f32_16x16x32_bf16 v[28:31], v[44:47], v[92:95], v[28:31]
  buffer_load_dwordx4 v[92:95], v21, s[36:39], s70 offen offset:3072 nt
  s_add_u32 s70, s70, 16384
  s_mov_b32 s71, 198656
  buffer_load_dwordx4 a[100:103], v13, s[40:43], s71 offen
  s_waitcnt lgkmcnt(0)
  ds_read_b128 v[36:39], v22 offset:1984
  v_and_b32 v40, v32, v8
  v_and_b32 v41, v32, v9
  v_and_b32 v42, v32, v10
  v_and_b32 v43, v32, v11
  s_waitcnt vmcnt(19)
  s_nop 1
  v_mfma_f32_16x16x32_bf16 v[28:31], v[40:43], v[96:99], v[28:31]
  buffer_load_dwordx4 v[96:99], v21, s[36:39], s70 offen offset:0 nt
  v_and_b32 v44, v33, v8
  v_and_b32 v45, v33, v9
  v_and_b32 v46, v33, v10
  v_and_b32 v47, v33, v11
  s_waitcnt vmcnt(19)
  s_nop 1
  v_mfma_f32_16x16x32_bf16 v[28:31], v[44:47], v[100:103], v[28:31]
  buffer_load_dwordx4 v[100:103], v21, s[36:39], s70 offen offset:1024 nt
  v_and_b32 v40, v34, v8
  v_and_b32 v41, v34, v9
  v_and_b32 v42, v34, v10
  v_and_b32 v43, v34, v11
  s_waitcnt vmcnt(19)
  s_nop 1
  v_mfma_f32_16x16x32_bf16 v[28:31], v[40:43], v[104:107], v[28:31]
  buffer_load_dwordx4 v[104:107], v21, s[36:39], s70 offen offset:2048 nt
  v_and_b32 v44, v35, v8
  v_and_b32 v45, v35, v9
  v_and_b32 v46, v35, v10
  v_and_b32 v47, v35, v11
  s_waitcnt vmcnt(19)
  s_nop 1
  v_mfma_f32_16x16x32_bf16 v[28:31], v[44:47], v[108:111], v[28:31]
  buffer_load_dwordx4 v[108:111], v21, s[36:39], s70 offen offset:3072 nt
  s_add_u32 s70, s70, 16384
  s_mov_b32 s71, 200704
  buffer_load_dwordx4 a[104:107], v13, s[40:43], s71 offen
  s_waitcnt lgkmcnt(0)
  ds_read_b128 v[32:35], v22 offset:2048
  v_and_b32 v40, v36, v8
  v_and_b32 v41, v36, v9
  v_and_b32 v42, v36, v10
  v_and_b32 v43, v36, v11
  s_waitcnt vmcnt(19)
  s_nop 1
  v_mfma_f32_16x16x32_bf16 v[28:31], v[40:43], v[112:115], v[28:31]
  buffer_load_dwordx4 v[112:115], v21, s[36:39], s70 offen offset:0 nt
  v_and_b32 v44, v37, v8
  v_and_b32 v45, v37, v9
  v_and_b32 v46, v37, v10
  v_and_b32 v47, v37, v11
  s_waitcnt vmcnt(19)
  s_nop 1
  v_mfma_f32_16x16x32_bf16 v[28:31], v[44:47], v[116:119], v[28:31]
  buffer_load_dwordx4 v[116:119], v21, s[36:39], s70 offen offset:1024 nt
  v_and_b32 v40, v38, v8
  v_and_b32 v41, v38, v9
  v_and_b32 v42, v38, v10
  v_and_b32 v43, v38, v11
  s_waitcnt vmcnt(19)
  s_nop 1
  v_mfma_f32_16x16x32_bf16 v[28:31], v[40:43], v[120:123], v[28:31]
  buffer_load_dwordx4 v[120:123], v21, s[36:39], s70 offen offset:2048 nt
  v_and_b32 v44, v39, v8
  v_and_b32 v45, v39, v9
  v_and_b32 v46, v39, v10
  v_and_b32 v47, v39, v11
  s_waitcnt vmcnt(19)
  s_nop 1
  v_mfma_f32_16x16x32_bf16 v[28:31], v[44:47], v[124:127], v[28:31]
  buffer_load_dwordx4 v[124:127], v21, s[36:39], s70 offen offset:3072 nt
  s_add_u32 s70, s70, 16384
  s_mov_b32 s71, 202752
  buffer_load_dwordx4 a[108:111], v13, s[40:43], s71 offen
  s_waitcnt lgkmcnt(0)
  ds_read_b128 v[36:39], v22 offset:2112
  v_and_b32 v40, v32, v8
  v_and_b32 v41, v32, v9
  v_and_b32 v42, v32, v10
  v_and_b32 v43, v32, v11
  s_waitcnt vmcnt(19)
  s_nop 1
  v_mfma_f32_16x16x32_bf16 v[28:31], v[40:43], v[64:67], v[28:31]
  buffer_load_dwordx4 v[64:67], v21, s[36:39], s70 offen offset:0 nt
  v_and_b32 v44, v33, v8
  v_and_b32 v45, v33, v9
  v_and_b32 v46, v33, v10
  v_and_b32 v47, v33, v11
  s_waitcnt vmcnt(19)
  s_nop 1
  v_mfma_f32_16x16x32_bf16 v[28:31], v[44:47], v[68:71], v[28:31]
  buffer_load_dwordx4 v[68:71], v21, s[36:39], s70 offen offset:1024 nt
  v_and_b32 v40, v34, v8
  v_and_b32 v41, v34, v9
  v_and_b32 v42, v34, v10
  v_and_b32 v43, v34, v11
  s_waitcnt vmcnt(19)
  s_nop 1
  v_mfma_f32_16x16x32_bf16 v[28:31], v[40:43], v[72:75], v[28:31]
  buffer_load_dwordx4 v[72:75], v21, s[36:39], s70 offen offset:2048 nt
  v_and_b32 v44, v35, v8
  v_and_b32 v45, v35, v9
  v_and_b32 v46, v35, v10
  v_and_b32 v47, v35, v11
  s_waitcnt vmcnt(19)
  s_nop 1
  v_mfma_f32_16x16x32_bf16 v[28:31], v[44:47], v[76:79], v[28:31]
  buffer_load_dwordx4 v[76:79], v21, s[36:39], s70 offen offset:3072 nt
  s_add_u32 s70, s70, 16384
  s_mov_b32 s71, 229376
  buffer_load_dwordx4 a[112:115], v13, s[40:43], s71 offen
  s_waitcnt lgkmcnt(0)
  ds_read_b128 v[32:35], v22 offset:2176
  v_and_b32 v40, v36, v8
  v_and_b32 v41, v36, v9
  v_and_b32 v42, v36, v10
  v_and_b32 v43, v36, v11
  s_waitcnt vmcnt(19)
  s_nop 1
  v_mfma_f32_16x16x32_bf16 v[28:31], v[40:43], v[80:83], v[28:31]
  buffer_load_dwordx4 v[80:83], v21, s[36:39], s70 offen offset:0 nt
  v_and_b32 v44, v37, v8
  v_and_b32 v45, v37, v9
  v_and_b32 v46, v37, v10
  v_and_b32 v47, v37, v11
  s_waitcnt vmcnt(19)
  s_nop 1
  v_mfma_f32_16x16x32_bf16 v[28:31], v[44:47], v[84:87], v[28:31]
  buffer_load_dwordx4 v[84:87], v21, s[36:39], s70 offen offset:1024 nt
  v_and_b32 v40, v38, v8
  v_and_b32 v41, v38, v9
  v_and_b32 v42, v38, v10
  v_and_b32 v43, v38, v11
  s_waitcnt vmcnt(19)
  s_nop 1
  v_mfma_f32_16x16x32_bf16 v[28:31], v[40:43], v[88:91], v[28:31]
  buffer_load_dwordx4 v[88:91], v21, s[36:39], s70 offen offset:2048 nt
  v_and_b32 v44, v39, v8
  v_and_b32 v45, v39, v9
  v_and_b32 v46, v39, v10
  v_and_b32 v47, v39, v11
  s_waitcnt vmcnt(19)
  s_nop 1
  v_mfma_f32_16x16x32_bf16 v[28:31], v[44:47], v[92:95], v[28:31]
  buffer_load_dwordx4 v[92:95], v21, s[36:39], s70 offen offset:3072 nt
  s_add_u32 s70, s70, 16384
  s_mov_b32 s71, 231424
  buffer_load_dwordx4 a[116:119], v13, s[40:43], s71 offen
  s_waitcnt lgkmcnt(0)
  ds_read_b128 v[36:39], v22 offset:2240
  v_and_b32 v40, v32, v8
  v_and_b32 v41, v32, v9
  v_and_b32 v42, v32, v10
  v_and_b32 v43, v32, v11
  s_waitcnt vmcnt(19)
  s_nop 1
  v_mfma_f32_16x16x32_bf16 v[28:31], v[40:43], v[96:99], v[28:31]
  buffer_load_dwordx4 v[96:99], v21, s[36:39], s70 offen offset:0 nt
  v_and_b32 v44, v33, v8
  v_and_b32 v45, v33, v9
  v_and_b32 v46, v33, v10
  v_and_b32 v47, v33, v11
  s_waitcnt vmcnt(19)
  s_nop 1
  v_mfma_f32_16x16x32_bf16 v[28:31], v[44:47], v[100:103], v[28:31]
  buffer_load_dwordx4 v[100:103], v21, s[36:39], s70 offen offset:1024 nt
  v_and_b32 v40, v34, v8
  v_and_b32 v41, v34, v9
  v_and_b32 v42, v34, v10
  v_and_b32 v43, v34, v11
  s_waitcnt vmcnt(19)
  s_nop 1
  v_mfma_f32_16x16x32_bf16 v[28:31], v[40:43], v[104:107], v[28:31]
  buffer_load_dwordx4 v[104:107], v21, s[36:39], s70 offen offset:2048 nt
  v_and_b32 v44, v35, v8
  v_and_b32 v45, v35, v9
  v_and_b32 v46, v35, v10
  v_and_b32 v47, v35, v11
  s_waitcnt vmcnt(19)
  s_nop 1
  v_mfma_f32_16x16x32_bf16 v[28:31], v[44:47], v[108:111], v[28:31]
  buffer_load_dwordx4 v[108:111], v21, s[36:39], s70 offen offset:3072 nt
  s_add_u32 s70, s70, 16384
  s_mov_b32 s71, 233472
  buffer_load_dwordx4 a[120:123], v13, s[40:43], s71 offen
  s_waitcnt lgkmcnt(0)
  ds_read_b128 v[32:35], v22 offset:2304
  v_and_b32 v40, v36, v8
  v_and_b32 v41, v36, v9
  v_and_b32 v42, v36, v10
  v_and_b32 v43, v36, v11
  s_waitcnt vmcnt(19)
  s_nop 1
  v_mfma_f32_16x16x32_bf16 v[28:31], v[40:43], v[112:115], v[28:31]
  buffer_load_dwordx4 v[112:115], v21, s[36:39], s70 offen offset:0 nt
  v_and_b32 v44, v37, v8
  v_and_b32 v45, v37, v9
  v_and_b32 v46, v37, v10
  v_and_b32 v47, v37, v11
  s_waitcnt vmcnt(19)
  s_nop 1
  v_mfma_f32_16x16x32_bf16 v[28:31], v[44:47], v[116:119], v[28:31]
  buffer_load_dwordx4 v[116:119], v21, s[36:39], s70 offen offset:1024 nt
  v_and_b32 v40, v38, v8
  v_and_b32 v41, v38, v9
  v_and_b32 v42, v38, v10
  v_and_b32 v43, v38, v11
  s_waitcnt vmcnt(19)
  s_nop 1
  v_mfma_f32_16x16x32_bf16 v[28:31], v[40:43], v[120:123], v[28:31]
  buffer_load_dwordx4 v[120:123], v21, s[36:39], s70 offen offset:2048 nt
  v_and_b32 v44, v39, v8
  v_and_b32 v45, v39, v9
  v_and_b32 v46, v39, v10
  v_and_b32 v47, v39, v11
  s_waitcnt vmcnt(19)
  s_nop 1
  v_mfma_f32_16x16x32_bf16 v[28:31], v[44:47], v[124:127], v[28:31]
  buffer_load_dwordx4 v[124:127], v21, s[36:39], s70 offen offset:3072 nt
  s_add_u32 s70, s70, 16384
  s_mov_b32 s71, 235520
  buffer_load_dwordx4 a[124:127], v13, s[40:43], s71 offen
  s_waitcnt lgkmcnt(0)
  ds_read_b128 v[36:39], v22 offset:2368
  v_and_b32 v40, v32, v8
  v_and_b32 v41, v32, v9
  v_and_b32 v42, v32, v10
  v_and_b32 v43, v32, v11
  s_waitcnt vmcnt(19)
  s_nop 1
  v_mfma_f32_16x16x32_bf16 v[28:31], v[40:43], v[64:67], v[28:31]
  buffer_load_dwordx4 v[64:67], v21, s[36:39], s70 offen offset:0 nt
  v_and_b32 v44, v33, v8
  v_and_b32 v45, v33, v9
  v_and_b32 v46, v33, v10
  v_and_b32 v47, v33, v11
  s_waitcnt vmcnt(19)
  s_nop 1
  v_mfma_f32_16x16x32_bf16 v[28:31], v[44:47], v[68:71], v[28:31]
  buffer_load_dwordx4 v[68:71], v21, s[36:39], s70 offen offset:1024 nt
  v_and_b32 v40, v34, v8
  v_and_b32 v41, v34, v9
  v_and_b32 v42, v34, v10
  v_and_b32 v43, v34, v11
  s_waitcnt vmcnt(19)
  s_nop 1
  v_mfma_f32_16x16x32_bf16 v[28:31], v[40:43], v[72:75], v[28:31]
  buffer_load_dwordx4 v[72:75], v21, s[36:39], s70 offen offset:2048 nt
  v_and_b32 v44, v35, v8
  v_and_b32 v45, v35, v9
  v_and_b32 v46, v35, v10
  v_and_b32 v47, v35, v11
  s_waitcnt vmcnt(19)
  s_nop 1
  v_mfma_f32_16x16x32_bf16 v[28:31], v[44:47], v[76:79], v[28:31]
  buffer_load_dwordx4 v[76:79], v21, s[36:39], s70 offen offset:3072 nt
  s_add_u32 s70, s70, 16384
  s_waitcnt lgkmcnt(0)
  ds_read_b128 v[32:35], v22 offset:2432
  v_and_b32 v40, v36, v8
  v_and_b32 v41, v36, v9
  v_and_b32 v42, v36, v10
  v_and_b32 v43, v36, v11
  s_waitcnt vmcnt(18)
  s_nop 1
  v_mfma_f32_16x16x32_bf16 v[28:31], v[40:43], v[80:83], v[28:31]
  buffer_load_dwordx4 v[80:83], v21, s[36:39], s70 offen offset:0 nt
  v_and_b32 v44, v37, v8
  v_and_b32 v45, v37, v9
  v_and_b32 v46, v37, v10
  v_and_b32 v47, v37, v11
  s_waitcnt vmcnt(18)
  s_nop 1
  v_mfma_f32_16x16x32_bf16 v[28:31], v[44:47], v[84:87], v[28:31]
  buffer_load_dwordx4 v[84:87], v21, s[36:39], s70 offen offset:1024 nt
  v_and_b32 v40, v38, v8
  v_and_b32 v41, v38, v9
  v_and_b32 v42, v38, v10
  v_and_b32 v43, v38, v11
  s_waitcnt vmcnt(18)
  s_nop 1
  v_mfma_f32_16x16x32_bf16 v[28:31], v[40:43], v[88:91], v[28:31]
  buffer_load_dwordx4 v[88:91], v21, s[36:39], s70 offen offset:2048 nt
  v_and_b32 v44, v39, v8
  v_and_b32 v45, v39, v9
  v_and_b32 v46, v39, v10
  v_and_b32 v47, v39, v11
  s_waitcnt vmcnt(18)
  s_nop 1
  v_mfma_f32_16x16x32_bf16 v[28:31], v[44:47], v[92:95], v[28:31]
  buffer_load_dwordx4 v[92:95], v21, s[36:39], s70 offen offset:3072 nt
  s_add_u32 s70, s70, 16384
  s_waitcnt lgkmcnt(0)
  ds_read_b128 v[36:39], v22 offset:2496
  v_and_b32 v40, v32, v8
  v_and_b32 v41, v32, v9
  v_and_b32 v42, v32, v10
  v_and_b32 v43, v32, v11
  s_waitcnt vmcnt(17)
  s_nop 1
  v_mfma_f32_16x16x32_bf16 v[28:31], v[40:43], v[96:99], v[28:31]
  buffer_load_dwordx4 v[96:99], v21, s[36:39], s70 offen offset:0 nt
  v_and_b32 v44, v33, v8
  v_and_b32 v45, v33, v9
  v_and_b32 v46, v33, v10
  v_and_b32 v47, v33, v11
  s_waitcnt vmcnt(17)
  s_nop 1
  v_mfma_f32_16x16x32_bf16 v[28:31], v[44:47], v[100:103], v[28:31]
  buffer_load_dwordx4 v[100:103], v21, s[36:39], s70 offen offset:1024 nt
  v_and_b32 v40, v34, v8
  v_and_b32 v41, v34, v9
  v_and_b32 v42, v34, v10
  v_and_b32 v43, v34, v11
  s_waitcnt vmcnt(17)
  s_nop 1
  v_mfma_f32_16x16x32_bf16 v[28:31], v[40:43], v[104:107], v[28:31]
  buffer_load_dwordx4 v[104:107], v21, s[36:39], s70 offen offset:2048 nt
  v_and_b32 v44, v35, v8
  v_and_b32 v45, v35, v9
  v_and_b32 v46, v35, v10
  v_and_b32 v47, v35, v11
  s_waitcnt vmcnt(17)
  s_nop 1
  v_mfma_f32_16x16x32_bf16 v[28:31], v[44:47], v[108:111], v[28:31]
  buffer_load_dwordx4 v[108:111], v21, s[36:39], s70 offen offset:3072 nt
  s_add_u32 s70, s70, 16384
  s_waitcnt lgkmcnt(0)
  ds_read_b128 v[32:35], v22 offset:2560
  v_and_b32 v40, v36, v8
  v_and_b32 v41, v36, v9
  v_and_b32 v42, v36, v10
  v_and_b32 v43, v36, v11
  s_waitcnt vmcnt(16)
  s_nop 1
  v_mfma_f32_16x16x32_bf16 v[28:31], v[40:43], v[112:115], v[28:31]
  buffer_load_dwordx4 v[112:115], v21, s[36:39], s70 offen offset:0 nt
  v_and_b32 v44, v37, v8
  v_and_b32 v45, v37, v9
  v_and_b32 v46, v37, v10
  v_and_b32 v47, v37, v11
  s_waitcnt vmcnt(16)
  s_nop 1
  v_mfma_f32_16x16x32_bf16 v[28:31], v[44:47], v[116:119], v[28:31]
  buffer_load_dwordx4 v[116:119], v21, s[36:39], s70 offen offset:1024 nt
  v_and_b32 v40, v38, v8
  v_and_b32 v41, v38, v9
  v_and_b32 v42, v38, v10
  v_and_b32 v43, v38, v11
  s_waitcnt vmcnt(16)
  s_nop 1
  v_mfma_f32_16x16x32_bf16 v[28:31], v[40:43], v[120:123], v[28:31]
  buffer_load_dwordx4 v[120:123], v21, s[36:39], s70 offen offset:2048 nt
  v_and_b32 v44, v39, v8
  v_and_b32 v45, v39, v9
  v_and_b32 v46, v39, v10
  v_and_b32 v47, v39, v11
  s_waitcnt vmcnt(16)
  s_nop 1
  v_mfma_f32_16x16x32_bf16 v[28:31], v[44:47], v[124:127], v[28:31]
  buffer_load_dwordx4 v[124:127], v21, s[36:39], s70 offen offset:3072 nt
  s_add_u32 s70, s70, 16384
  s_waitcnt lgkmcnt(0)
  ds_read_b128 v[36:39], v22 offset:2624
  v_and_b32 v40, v32, v8
  v_and_b32 v41, v32, v9
  v_and_b32 v42, v32, v10
  v_and_b32 v43, v32, v11
  s_waitcnt vmcnt(15)
  s_nop 1
  v_mfma_f32_16x16x32_bf16 v[28:31], v[40:43], v[64:67], v[28:31]
  buffer_load_dwordx4 v[64:67], v21, s[36:39], s70 offen offset:0 nt
  v_and_b32 v44, v33, v8
  v_and_b32 v45, v33, v9
  v_and_b32 v46, v33, v10
  v_and_b32 v47, v33, v11
  s_waitcnt vmcnt(15)
  s_nop 1
  v_mfma_f32_16x16x32_bf16 v[28:31], v[44:47], v[68:71], v[28:31]
  buffer_load_dwordx4 v[68:71], v21, s[36:39], s70 offen offset:1024 nt
  v_and_b32 v40, v34, v8
  v_and_b32 v41, v34, v9
  v_and_b32 v42, v34, v10
  v_and_b32 v43, v34, v11
  s_waitcnt vmcnt(15)
  s_nop 1
  v_mfma_f32_16x16x32_bf16 v[28:31], v[40:43], v[72:75], v[28:31]
  buffer_load_dwordx4 v[72:75], v21, s[36:39], s70 offen offset:2048 nt
  v_and_b32 v44, v35, v8
  v_and_b32 v45, v35, v9
  v_and_b32 v46, v35, v10
  v_and_b32 v47, v35, v11
  s_waitcnt vmcnt(15)
  s_nop 1
  v_mfma_f32_16x16x32_bf16 v[28:31], v[44:47], v[76:79], v[28:31]
  buffer_load_dwordx4 v[76:79], v21, s[36:39], s70 offen offset:3072 nt
  s_add_u32 s70, s70, 16384
  s_waitcnt lgkmcnt(0)
  ds_read_b128 v[32:35], v22 offset:2688
  v_and_b32 v40, v36, v8
  v_and_b32 v41, v36, v9
  v_and_b32 v42, v36, v10
  v_and_b32 v43, v36, v11
  s_waitcnt vmcnt(15)
  s_nop 1
  v_mfma_f32_16x16x32_bf16 v[28:31], v[40:43], v[80:83], v[28:31]
  buffer_load_dwordx4 v[80:83], v21, s[36:39], s70 offen offset:0 nt
  v_and_b32 v44, v37, v8
  v_and_b32 v45, v37, v9
  v_and_b32 v46, v37, v10
  v_and_b32 v47, v37, v11
  s_waitcnt vmcnt(15)
  s_nop 1
  v_mfma_f32_16x16x32_bf16 v[28:31], v[44:47], v[84:87], v[28:31]
  buffer_load_dwordx4 v[84:87], v21, s[36:39], s70 offen offset:1024 nt
  v_and_b32 v40, v38, v8
  v_and_b32 v41, v38, v9
  v_and_b32 v42, v38, v10
  v_and_b32 v43, v38, v11
  s_waitcnt vmcnt(15)
  s_nop 1
  v_mfma_f32_16x16x32_bf16 v[28:31], v[40:43], v[88:91], v[28:31]
  buffer_load_dwordx4 v[88:91], v21, s[36:39], s70 offen offset:2048 nt
  v_and_b32 v44, v39, v8
  v_and_b32 v45, v39, v9
  v_and_b32 v46, v39, v10
  v_and_b32 v47, v39, v11
  s_waitcnt vmcnt(15)
  s_nop 1
  v_mfma_f32_16x16x32_bf16 v[28:31], v[44:47], v[92:95], v[28:31]
  buffer_load_dwordx4 v[92:95], v21, s[36:39], s70 offen offset:3072 nt
  s_add_u32 s70, s70, 16384
  s_waitcnt lgkmcnt(0)
  ds_read_b128 v[36:39], v22 offset:2752
  v_and_b32 v40, v32, v8
  v_and_b32 v41, v32, v9
  v_and_b32 v42, v32, v10
  v_and_b32 v43, v32, v11
  s_waitcnt vmcnt(15)
  s_nop 1
  v_mfma_f32_16x16x32_bf16 v[28:31], v[40:43], v[96:99], v[28:31]
  buffer_load_dwordx4 v[96:99], v21, s[36:39], s70 offen offset:0 nt
  v_and_b32 v44, v33, v8
  v_and_b32 v45, v33, v9
  v_and_b32 v46, v33, v10
  v_and_b32 v47, v33, v11
  s_waitcnt vmcnt(15)
  s_nop 1
  v_mfma_f32_16x16x32_bf16 v[28:31], v[44:47], v[100:103], v[28:31]
  buffer_load_dwordx4 v[100:103], v21, s[36:39], s70 offen offset:1024 nt
  v_and_b32 v40, v34, v8
  v_and_b32 v41, v34, v9
  v_and_b32 v42, v34, v10
  v_and_b32 v43, v34, v11
  s_waitcnt vmcnt(15)
  s_nop 1
  v_mfma_f32_16x16x32_bf16 v[28:31], v[40:43], v[104:107], v[28:31]
  buffer_load_dwordx4 v[104:107], v21, s[36:39], s70 offen offset:2048 nt
  v_and_b32 v44, v35, v8
  v_and_b32 v45, v35, v9
  v_and_b32 v46, v35, v10
  v_and_b32 v47, v35, v11
  s_waitcnt vmcnt(15)
  s_nop 1
  v_mfma_f32_16x16x32_bf16 v[28:31], v[44:47], v[108:111], v[28:31]
  buffer_load_dwordx4 v[108:111], v21, s[36:39], s70 offen offset:3072 nt
  s_add_u32 s70, s70, 16384
  s_waitcnt lgkmcnt(0)
  ds_read_b128 v[32:35], v22 offset:2816
  v_and_b32 v40, v36, v8
  v_and_b32 v41, v36, v9
  v_and_b32 v42, v36, v10
  v_and_b32 v43, v36, v11
  s_waitcnt vmcnt(15)
  s_nop 1
  v_mfma_f32_16x16x32_bf16 v[28:31], v[40:43], v[112:115], v[28:31]
  buffer_load_dwordx4 v[112:115], v21, s[36:39], s70 offen offset:0 nt
  v_and_b32 v44, v37, v8
  v_and_b32 v45, v37, v9
  v_and_b32 v46, v37, v10
  v_and_b32 v47, v37, v11
  s_waitcnt vmcnt(15)
  s_nop 1
  v_mfma_f32_16x16x32_bf16 v[28:31], v[44:47], v[116:119], v[28:31]
  buffer_load_dwordx4 v[116:119], v21, s[36:39], s70 offen offset:1024 nt
  v_and_b32 v40, v38, v8
  v_and_b32 v41, v38, v9
  v_and_b32 v42, v38, v10
  v_and_b32 v43, v38, v11
  s_waitcnt vmcnt(15)
  s_nop 1
  v_mfma_f32_16x16x32_bf16 v[28:31], v[40:43], v[120:123], v[28:31]
  buffer_load_dwordx4 v[120:123], v21, s[36:39], s70 offen offset:2048 nt
  v_and_b32 v44, v39, v8
  v_and_b32 v45, v39, v9
  v_and_b32 v46, v39, v10
  v_and_b32 v47, v39, v11
  s_waitcnt vmcnt(15)
  s_nop 1
  v_mfma_f32_16x16x32_bf16 v[28:31], v[44:47], v[124:127], v[28:31]
  buffer_load_dwordx4 v[124:127], v21, s[36:39], s70 offen offset:3072 nt
  s_add_u32 s70, s70, 16384
  s_waitcnt lgkmcnt(0)
  ds_read_b128 v[36:39], v22 offset:2880
  v_and_b32 v40, v32, v8
  v_and_b32 v41, v32, v9
  v_and_b32 v42, v32, v10
  v_and_b32 v43, v32, v11
  s_waitcnt vmcnt(15)
  s_nop 1
  v_mfma_f32_16x16x32_bf16 v[28:31], v[40:43], v[64:67], v[28:31]
  buffer_load_dwordx4 v[64:67], v21, s[36:39], s70 offen offset:0 nt
  v_and_b32 v44, v33, v8
  v_and_b32 v45, v33, v9
  v_and_b32 v46, v33, v10
  v_and_b32 v47, v33, v11
  s_waitcnt vmcnt(15)
  s_nop 1
  v_mfma_f32_16x16x32_bf16 v[28:31], v[44:47], v[68:71], v[28:31]
  buffer_load_dwordx4 v[68:71], v21, s[36:39], s70 offen offset:1024 nt
  v_and_b32 v40, v34, v8
  v_and_b32 v41, v34, v9
  v_and_b32 v42, v34, v10
  v_and_b32 v43, v34, v11
  s_waitcnt vmcnt(15)
  s_nop 1
  v_mfma_f32_16x16x32_bf16 v[28:31], v[40:43], v[72:75], v[28:31]
  buffer_load_dwordx4 v[72:75], v21, s[36:39], s70 offen offset:2048 nt
  v_and_b32 v44, v35, v8
  v_and_b32 v45, v35, v9
  v_and_b32 v46, v35, v10
  v_and_b32 v47, v35, v11
  s_waitcnt vmcnt(15)
  s_nop 1
  v_mfma_f32_16x16x32_bf16 v[28:31], v[44:47], v[76:79], v[28:31]
  buffer_load_dwordx4 v[76:79], v21, s[36:39], s70 offen offset:3072 nt
  s_add_u32 s70, s70, 16384
  s_waitcnt lgkmcnt(0)
  ds_read_b128 v[32:35], v22 offset:2944
  v_and_b32 v40, v36, v8
  v_and_b32 v41, v36, v9
  v_and_b32 v42, v36, v10
  v_and_b32 v43, v36, v11
  s_waitcnt vmcnt(15)
  s_nop 1
  v_mfma_f32_16x16x32_bf16 v[28:31], v[40:43], v[80:83], v[28:31]
  buffer_load_dwordx4 v[80:83], v21, s[36:39], s70 offen offset:0 nt
  v_and_b32 v44, v37, v8
  v_and_b32 v45, v37, v9
  v_and_b32 v46, v37, v10
  v_and_b32 v47, v37, v11
  s_waitcnt vmcnt(15)
  s_nop 1
  v_mfma_f32_16x16x32_bf16 v[28:31], v[44:47], v[84:87], v[28:31]
  buffer_load_dwordx4 v[84:87], v21, s[36:39], s70 offen offset:1024 nt
  v_and_b32 v40, v38, v8
  v_and_b32 v41, v38, v9
  v_and_b32 v42, v38, v10
  v_and_b32 v43, v38, v11
  s_waitcnt vmcnt(15)
  s_nop 1
  v_mfma_f32_16x16x32_bf16 v[28:31], v[40:43], v[88:91], v[28:31]
  buffer_load_dwordx4 v[88:91], v21, s[36:39], s70 offen offset:2048 nt
  v_and_b32 v44, v39, v8
  v_and_b32 v45, v39, v9
  v_and_b32 v46, v39, v10
  v_and_b32 v47, v39, v11
  s_waitcnt vmcnt(15)
  s_nop 1
  v_mfma_f32_16x16x32_bf16 v[28:31], v[44:47], v[92:95], v[28:31]
  buffer_load_dwordx4 v[92:95], v21, s[36:39], s70 offen offset:3072 nt
  s_add_u32 s70, s70, 16384
  s_waitcnt lgkmcnt(0)
  ds_read_b128 v[36:39], v22 offset:3008
  v_and_b32 v40, v32, v8
  v_and_b32 v41, v32, v9
  v_and_b32 v42, v32, v10
  v_and_b32 v43, v32, v11
  s_waitcnt vmcnt(15)
  s_nop 1
  v_mfma_f32_16x16x32_bf16 v[28:31], v[40:43], v[96:99], v[28:31]
  buffer_load_dwordx4 v[96:99], v21, s[36:39], s70 offen offset:0 nt
  v_and_b32 v44, v33, v8
  v_and_b32 v45, v33, v9
  v_and_b32 v46, v33, v10
  v_and_b32 v47, v33, v11
  s_waitcnt vmcnt(15)
  s_nop 1
  v_mfma_f32_16x16x32_bf16 v[28:31], v[44:47], v[100:103], v[28:31]
  buffer_load_dwordx4 v[100:103], v21, s[36:39], s70 offen offset:1024 nt
  v_and_b32 v40, v34, v8
  v_and_b32 v41, v34, v9
  v_and_b32 v42, v34, v10
  v_and_b32 v43, v34, v11
  s_waitcnt vmcnt(15)
  s_nop 1
  v_mfma_f32_16x16x32_bf16 v[28:31], v[40:43], v[104:107], v[28:31]
  buffer_load_dwordx4 v[104:107], v21, s[36:39], s70 offen offset:2048 nt
  v_and_b32 v44, v35, v8
  v_and_b32 v45, v35, v9
  v_and_b32 v46, v35, v10
  v_and_b32 v47, v35, v11
  s_waitcnt vmcnt(15)
  s_nop 1
  v_mfma_f32_16x16x32_bf16 v[28:31], v[44:47], v[108:111], v[28:31]
  buffer_load_dwordx4 v[108:111], v21, s[36:39], s70 offen offset:3072 nt
  s_add_u32 s70, s70, 16384
  s_waitcnt lgkmcnt(0)
  ds_read_b128 v[32:35], v22 offset:3072
  v_and_b32 v40, v36, v8
  v_and_b32 v41, v36, v9
  v_and_b32 v42, v36, v10
  v_and_b32 v43, v36, v11
  s_waitcnt vmcnt(15)
  s_nop 1
  v_mfma_f32_16x16x32_bf16 v[28:31], v[40:43], v[112:115], v[28:31]
  buffer_load_dwordx4 v[112:115], v21, s[36:39], s70 offen offset:0 nt
  v_and_b32 v44, v37, v8
  v_and_b32 v45, v37, v9
  v_and_b32 v46, v37, v10
  v_and_b32 v47, v37, v11
  s_waitcnt vmcnt(15)
  s_nop 1
  v_mfma_f32_16x16x32_bf16 v[28:31], v[44:47], v[116:119], v[28:31]
  buffer_load_dwordx4 v[116:119], v21, s[36:39], s70 offen offset:1024 nt
  v_and_b32 v40, v38, v8
  v_and_b32 v41, v38, v9
  v_and_b32 v42, v38, v10
  v_and_b32 v43, v38, v11
  s_waitcnt vmcnt(15)
  s_nop 1
  v_mfma_f32_16x16x32_bf16 v[28:31], v[40:43], v[120:123], v[28:31]
  buffer_load_dwordx4 v[120:123], v21, s[36:39], s70 offen offset:2048 nt
  v_and_b32 v44, v39, v8
  v_and_b32 v45, v39, v9
  v_and_b32 v46, v39, v10
  v_and_b32 v47, v39, v11
  s_waitcnt vmcnt(15)
  s_nop 1
  v_mfma_f32_16x16x32_bf16 v[28:31], v[44:47], v[124:127], v[28:31]
  buffer_load_dwordx4 v[124:127], v21, s[36:39], s70 offen offset:3072 nt
  s_add_u32 s70, s70, 16384
  s_waitcnt lgkmcnt(0)
  ds_read_b128 v[36:39], v22 offset:3136
  v_and_b32 v40, v32, v8
  v_and_b32 v41, v32, v9
  v_and_b32 v42, v32, v10
  v_and_b32 v43, v32, v11
  s_waitcnt vmcnt(15)
  s_nop 1
  v_mfma_f32_16x16x32_bf16 v[28:31], v[40:43], v[64:67], v[28:31]
  buffer_load_dwordx4 v[64:67], v21, s[36:39], s70 offen offset:0 nt
  v_and_b32 v44, v33, v8
  v_and_b32 v45, v33, v9
  v_and_b32 v46, v33, v10
  v_and_b32 v47, v33, v11
  s_waitcnt vmcnt(15)
  s_nop 1
  v_mfma_f32_16x16x32_bf16 v[28:31], v[44:47], v[68:71], v[28:31]
  buffer_load_dwordx4 v[68:71], v21, s[36:39], s70 offen offset:1024 nt
  v_and_b32 v40, v34, v8
  v_and_b32 v41, v34, v9
  v_and_b32 v42, v34, v10
  v_and_b32 v43, v34, v11
  s_waitcnt vmcnt(15)
  s_nop 1
  v_mfma_f32_16x16x32_bf16 v[28:31], v[40:43], v[72:75], v[28:31]
  buffer_load_dwordx4 v[72:75], v21, s[36:39], s70 offen offset:2048 nt
  v_and_b32 v44, v35, v8
  v_and_b32 v45, v35, v9
  v_and_b32 v46, v35, v10
  v_and_b32 v47, v35, v11
  s_waitcnt vmcnt(15)
  s_nop 1
  v_mfma_f32_16x16x32_bf16 v[28:31], v[44:47], v[76:79], v[28:31]
  buffer_load_dwordx4 v[76:79], v21, s[36:39], s70 offen offset:3072 nt
  s_add_u32 s70, s70, 16384
  s_waitcnt lgkmcnt(0)
  ds_read_b128 v[32:35], v22 offset:3200
  v_and_b32 v40, v36, v8
  v_and_b32 v41, v36, v9
  v_and_b32 v42, v36, v10
  v_and_b32 v43, v36, v11
  s_waitcnt vmcnt(15)
  s_nop 1
  v_mfma_f32_16x16x32_bf16 v[28:31], v[40:43], v[80:83], v[28:31]
  buffer_load_dwordx4 v[80:83], v21, s[36:39], s70 offen offset:0 nt
  v_and_b32 v44, v37, v8
  v_and_b32 v45, v37, v9
  v_and_b32 v46, v37, v10
  v_and_b32 v47, v37, v11
  s_waitcnt vmcnt(15)
  s_nop 1
  v_mfma_f32_16x16x32_bf16 v[28:31], v[44:47], v[84:87], v[28:31]
  buffer_load_dwordx4 v[84:87], v21, s[36:39], s70 offen offset:1024 nt
  v_and_b32 v40, v38, v8
  v_and_b32 v41, v38, v9
  v_and_b32 v42, v38, v10
  v_and_b32 v43, v38, v11
  s_waitcnt vmcnt(15)
  s_nop 1
  v_mfma_f32_16x16x32_bf16 v[28:31], v[40:43], v[88:91], v[28:31]
  buffer_load_dwordx4 v[88:91], v21, s[36:39], s70 offen offset:2048 nt
  v_and_b32 v44, v39, v8
  v_and_b32 v45, v39, v9
  v_and_b32 v46, v39, v10
  v_and_b32 v47, v39, v11
  s_waitcnt vmcnt(15)
  s_nop 1
  v_mfma_f32_16x16x32_bf16 v[28:31], v[44:47], v[92:95], v[28:31]
  buffer_load_dwordx4 v[92:95], v21, s[36:39], s70 offen offset:3072 nt
  s_add_u32 s70, s70, 16384
  s_waitcnt lgkmcnt(0)
  ds_read_b128 v[36:39], v22 offset:3264
  v_and_b32 v40, v32, v8
  v_and_b32 v41, v32, v9
  v_and_b32 v42, v32, v10
  v_and_b32 v43, v32, v11
  s_waitcnt vmcnt(15)
  s_nop 1
  v_mfma_f32_16x16x32_bf16 v[28:31], v[40:43], v[96:99], v[28:31]
  buffer_load_dwordx4 v[96:99], v21, s[36:39], s70 offen offset:0 nt
  v_and_b32 v44, v33, v8
  v_and_b32 v45, v33, v9
  v_and_b32 v46, v33, v10
  v_and_b32 v47, v33, v11
  s_waitcnt vmcnt(15)
  s_nop 1
  v_mfma_f32_16x16x32_bf16 v[28:31], v[44:47], v[100:103], v[28:31]
  buffer_load_dwordx4 v[100:103], v21, s[36:39], s70 offen offset:1024 nt
  v_and_b32 v40, v34, v8
  v_and_b32 v41, v34, v9
  v_and_b32 v42, v34, v10
  v_and_b32 v43, v34, v11
  s_waitcnt vmcnt(15)
  s_nop 1
  v_mfma_f32_16x16x32_bf16 v[28:31], v[40:43], v[104:107], v[28:31]
  buffer_load_dwordx4 v[104:107], v21, s[36:39], s70 offen offset:2048 nt
  v_and_b32 v44, v35, v8
  v_and_b32 v45, v35, v9
  v_and_b32 v46, v35, v10
  v_and_b32 v47, v35, v11
  s_waitcnt vmcnt(15)
  s_nop 1
  v_mfma_f32_16x16x32_bf16 v[28:31], v[44:47], v[108:111], v[28:31]
  buffer_load_dwordx4 v[108:111], v21, s[36:39], s70 offen offset:3072 nt
  s_add_u32 s70, s70, 16384
  s_waitcnt lgkmcnt(0)
  ds_read_b128 v[32:35], v22 offset:3328
  v_and_b32 v40, v36, v8
  v_and_b32 v41, v36, v9
  v_and_b32 v42, v36, v10
  v_and_b32 v43, v36, v11
  s_waitcnt vmcnt(15)
  s_nop 1
  v_mfma_f32_16x16x32_bf16 v[28:31], v[40:43], v[112:115], v[28:31]
  buffer_load_dwordx4 v[112:115], v21, s[36:39], s70 offen offset:0 nt
  v_and_b32 v44, v37, v8
  v_and_b32 v45, v37, v9
  v_and_b32 v46, v37, v10
  v_and_b32 v47, v37, v11
  s_waitcnt vmcnt(15)
  s_nop 1
  v_mfma_f32_16x16x32_bf16 v[28:31], v[44:47], v[116:119], v[28:31]
  buffer_load_dwordx4 v[116:119], v21, s[36:39], s70 offen offset:1024 nt
  v_and_b32 v40, v38, v8
  v_and_b32 v41, v38, v9
  v_and_b32 v42, v38, v10
  v_and_b32 v43, v38, v11
  s_waitcnt vmcnt(15)
  s_nop 1
  v_mfma_f32_16x16x32_bf16 v[28:31], v[40:43], v[120:123], v[28:31]
  buffer_load_dwordx4 v[120:123], v21, s[36:39], s70 offen offset:2048 nt
  v_and_b32 v44, v39, v8
  v_and_b32 v45, v39, v9
  v_and_b32 v46, v39, v10
  v_and_b32 v47, v39, v11
  s_waitcnt vmcnt(15)
  s_nop 1
  v_mfma_f32_16x16x32_bf16 v[28:31], v[44:47], v[124:127], v[28:31]
  buffer_load_dwordx4 v[124:127], v21, s[36:39], s70 offen offset:3072 nt
  s_add_u32 s70, s70, 16384
  s_waitcnt lgkmcnt(0)
  ds_read_b128 v[36:39], v22 offset:3392
  v_and_b32 v40, v32, v8
  v_and_b32 v41, v32, v9
  v_and_b32 v42, v32, v10
  v_and_b32 v43, v32, v11
  s_waitcnt vmcnt(15)
  s_nop 1
  v_mfma_f32_16x16x32_bf16 v[28:31], v[40:43], v[64:67], v[28:31]
  buffer_load_dwordx4 v[64:67], v21, s[36:39], s70 offen offset:0 nt
  v_and_b32 v44, v33, v8
  v_and_b32 v45, v33, v9
  v_and_b32 v46, v33, v10
  v_and_b32 v47, v33, v11
  s_waitcnt vmcnt(15)
  s_nop 1
  v_mfma_f32_16x16x32_bf16 v[28:31], v[44:47], v[68:71], v[28:31]
  buffer_load_dwordx4 v[68:71], v21, s[36:39], s70 offen offset:1024 nt
  v_and_b32 v40, v34, v8
  v_and_b32 v41, v34, v9
  v_and_b32 v42, v34, v10
  v_and_b32 v43, v34, v11
  s_waitcnt vmcnt(15)
  s_nop 1
  v_mfma_f32_16x16x32_bf16 v[28:31], v[40:43], v[72:75], v[28:31]
  buffer_load_dwordx4 v[72:75], v21, s[36:39], s70 offen offset:2048 nt
  v_and_b32 v44, v35, v8
  v_and_b32 v45, v35, v9
  v_and_b32 v46, v35, v10
  v_and_b32 v47, v35, v11
  s_waitcnt vmcnt(15)
  s_nop 1
  v_mfma_f32_16x16x32_bf16 v[28:31], v[44:47], v[76:79], v[28:31]
  buffer_load_dwordx4 v[76:79], v21, s[36:39], s70 offen offset:3072 nt
  s_add_u32 s70, s70, 16384
  s_waitcnt lgkmcnt(0)
  ds_read_b128 v[32:35], v22 offset:3456
  v_and_b32 v40, v36, v8
  v_and_b32 v41, v36, v9
  v_and_b32 v42, v36, v10
  v_and_b32 v43, v36, v11
  s_waitcnt vmcnt(15)
  s_nop 1
  v_mfma_f32_16x16x32_bf16 v[28:31], v[40:43], v[80:83], v[28:31]
  buffer_load_dwordx4 v[80:83], v21, s[36:39], s70 offen offset:0 nt
  v_and_b32 v44, v37, v8
  v_and_b32 v45, v37, v9
  v_and_b32 v46, v37, v10
  v_and_b32 v47, v37, v11
  s_waitcnt vmcnt(15)
  s_nop 1
  v_mfma_f32_16x16x32_bf16 v[28:31], v[44:47], v[84:87], v[28:31]
  buffer_load_dwordx4 v[84:87], v21, s[36:39], s70 offen offset:1024 nt
  v_and_b32 v40, v38, v8
  v_and_b32 v41, v38, v9
  v_and_b32 v42, v38, v10
  v_and_b32 v43, v38, v11
  s_waitcnt vmcnt(15)
  s_nop 1
  v_mfma_f32_16x16x32_bf16 v[28:31], v[40:43], v[88:91], v[28:31]
  buffer_load_dwordx4 v[88:91], v21, s[36:39], s70 offen offset:2048 nt
  v_and_b32 v44, v39, v8
  v_and_b32 v45, v39, v9
  v_and_b32 v46, v39, v10
  v_and_b32 v47, v39, v11
  s_waitcnt vmcnt(15)
  s_nop 1
  v_mfma_f32_16x16x32_bf16 v[28:31], v[44:47], v[92:95], v[28:31]
  buffer_load_dwordx4 v[92:95], v21, s[36:39], s70 offen offset:3072 nt
  s_add_u32 s70, s70, 16384
  s_waitcnt lgkmcnt(0)
  ds_read_b128 v[36:39], v22 offset:3520
  v_and_b32 v40, v32, v8
  v_and_b32 v41, v32, v9
  v_and_b32 v42, v32, v10
  v_and_b32 v43, v32, v11
  s_waitcnt vmcnt(15)
  s_nop 1
  v_mfma_f32_16x16x32_bf16 v[28:31], v[40:43], v[96:99], v[28:31]
  buffer_load_dwordx4 v[96:99], v21, s[36:39], s70 offen offset:0 nt
  v_and_b32 v44, v33, v8
  v_and_b32 v45, v33, v9
  v_and_b32 v46, v33, v10
  v_and_b32 v47, v33, v11
  s_waitcnt vmcnt(15)
  s_nop 1
  v_mfma_f32_16x16x32_bf16 v[28:31], v[44:47], v[100:103], v[28:31]
  buffer_load_dwordx4 v[100:103], v21, s[36:39], s70 offen offset:1024 nt
  v_and_b32 v40, v34, v8
  v_and_b32 v41, v34, v9
  v_and_b32 v42, v34, v10
  v_and_b32 v43, v34, v11
  s_waitcnt vmcnt(15)
  s_nop 1
  v_mfma_f32_16x16x32_bf16 v[28:31], v[40:43], v[104:107], v[28:31]
  buffer_load_dwordx4 v[104:107], v21, s[36:39], s70 offen offset:2048 nt
  v_and_b32 v44, v35, v8
  v_and_b32 v45, v35, v9
  v_and_b32 v46, v35, v10
  v_and_b32 v47, v35, v11
  s_waitcnt vmcnt(15)
  s_nop 1
  v_mfma_f32_16x16x32_bf16 v[28:31], v[44:47], v[108:111], v[28:31]
  buffer_load_dwordx4 v[108:111], v21, s[36:39], s70 offen offset:3072 nt
  s_add_u32 s70, s70, 16384
  s_waitcnt lgkmcnt(0)
  ds_read_b128 v[32:35], v22 offset:3584
  v_and_b32 v40, v36, v8
  v_and_b32 v41, v36, v9
  v_and_b32 v42, v36, v10
  v_and_b32 v43, v36, v11
  s_waitcnt vmcnt(15)
  s_nop 1
  v_mfma_f32_16x16x32_bf16 v[28:31], v[40:43], v[112:115], v[28:31]
  buffer_load_dwordx4 v[112:115], v21, s[36:39], s70 offen offset:0 nt
  v_and_b32 v44, v37, v8
  v_and_b32 v45, v37, v9
  v_and_b32 v46, v37, v10
  v_and_b32 v47, v37, v11
  s_waitcnt vmcnt(15)
  s_nop 1
  v_mfma_f32_16x16x32_bf16 v[28:31], v[44:47], v[116:119], v[28:31]
  buffer_load_dwordx4 v[116:119], v21, s[36:39], s70 offen offset:1024 nt
  v_and_b32 v40, v38, v8
  v_and_b32 v41, v38, v9
  v_and_b32 v42, v38, v10
  v_and_b32 v43, v38, v11
  s_waitcnt vmcnt(15)
  s_nop 1
  v_mfma_f32_16x16x32_bf16 v[28:31], v[40:43], v[120:123], v[28:31]
  buffer_load_dwordx4 v[120:123], v21, s[36:39], s70 offen offset:2048 nt
  v_and_b32 v44, v39, v8
  v_and_b32 v45, v39, v9
  v_and_b32 v46, v39, v10
  v_and_b32 v47, v39, v11
  s_waitcnt vmcnt(15)
  s_nop 1
  v_mfma_f32_16x16x32_bf16 v[28:31], v[44:47], v[124:127], v[28:31]
  buffer_load_dwordx4 v[124:127], v21, s[36:39], s70 offen offset:3072 nt
  s_add_u32 s70, s70, 16384
  s_waitcnt lgkmcnt(0)
  ds_read_b128 v[36:39], v22 offset:3648
  v_and_b32 v40, v32, v8
  v_and_b32 v41, v32, v9
  v_and_b32 v42, v32, v10
  v_and_b32 v43, v32, v11
  s_waitcnt vmcnt(15)
  s_nop 1
  v_mfma_f32_16x16x32_bf16 v[28:31], v[40:43], v[64:67], v[28:31]
  buffer_load_dwordx4 v[64:67], v21, s[36:39], s70 offen offset:0 nt
  v_and_b32 v44, v33, v8
  v_and_b32 v45, v33, v9
  v_and_b32 v46, v33, v10
  v_and_b32 v47, v33, v11
  s_waitcnt vmcnt(15)
  s_nop 1
  v_mfma_f32_16x16x32_bf16 v[28:31], v[44:47], v[68:71], v[28:31]
  buffer_load_dwordx4 v[68:71], v21, s[36:39], s70 offen offset:1024 nt
  v_and_b32 v40, v34, v8
  v_and_b32 v41, v34, v9
  v_and_b32 v42, v34, v10
  v_and_b32 v43, v34, v11
  s_waitcnt vmcnt(15)
  s_nop 1
  v_mfma_f32_16x16x32_bf16 v[28:31], v[40:43], v[72:75], v[28:31]
  buffer_load_dwordx4 v[72:75], v21, s[36:39], s70 offen offset:2048 nt
  v_and_b32 v44, v35, v8
  v_and_b32 v45, v35, v9
  v_and_b32 v46, v35, v10
  v_and_b32 v47, v35, v11
  s_waitcnt vmcnt(15)
  s_nop 1
  v_mfma_f32_16x16x32_bf16 v[28:31], v[44:47], v[76:79], v[28:31]
  buffer_load_dwordx4 v[76:79], v21, s[36:39], s70 offen offset:3072 nt
  s_add_u32 s70, s70, 16384
  s_waitcnt lgkmcnt(0)
  ds_read_b128 v[32:35], v22 offset:3712
  v_and_b32 v40, v36, v8
  v_and_b32 v41, v36, v9
  v_and_b32 v42, v36, v10
  v_and_b32 v43, v36, v11
  s_waitcnt vmcnt(15)
  s_nop 1
  v_mfma_f32_16x16x32_bf16 v[28:31], v[40:43], v[80:83], v[28:31]
  buffer_load_dwordx4 v[80:83], v21, s[36:39], s70 offen offset:0 nt
  v_and_b32 v44, v37, v8
  v_and_b32 v45, v37, v9
  v_and_b32 v46, v37, v10
  v_and_b32 v47, v37, v11
  s_waitcnt vmcnt(15)
  s_nop 1
  v_mfma_f32_16x16x32_bf16 v[28:31], v[44:47], v[84:87], v[28:31]
  buffer_load_dwordx4 v[84:87], v21, s[36:39], s70 offen offset:1024 nt
  v_and_b32 v40, v38, v8
  v_and_b32 v41, v38, v9
  v_and_b32 v42, v38, v10
  v_and_b32 v43, v38, v11
  s_waitcnt vmcnt(15)
  s_nop 1
  v_mfma_f32_16x16x32_bf16 v[28:31], v[40:43], v[88:91], v[28:31]
  buffer_load_dwordx4 v[88:91], v21, s[36:39], s70 offen offset:2048 nt
  v_and_b32 v44, v39, v8
  v_and_b32 v45, v39, v9
  v_and_b32 v46, v39, v10
  v_and_b32 v47, v39, v11
  s_waitcnt vmcnt(15)
  s_nop 1
  v_mfma_f32_16x16x32_bf16 v[28:31], v[44:47], v[92:95], v[28:31]
  buffer_load_dwordx4 v[92:95], v21, s[36:39], s70 offen offset:3072 nt
  s_add_u32 s70, s70, 16384
  s_waitcnt lgkmcnt(0)
  ds_read_b128 v[36:39], v22 offset:3776
  v_and_b32 v40, v32, v8
  v_and_b32 v41, v32, v9
  v_and_b32 v42, v32, v10
  v_and_b32 v43, v32, v11
  s_waitcnt vmcnt(15)
  s_nop 1
  v_mfma_f32_16x16x32_bf16 v[28:31], v[40:43], v[96:99], v[28:31]
  buffer_load_dwordx4 v[96:99], v21, s[36:39], s70 offen offset:0 nt
  v_and_b32 v44, v33, v8
  v_and_b32 v45, v33, v9
  v_and_b32 v46, v33, v10
  v_and_b32 v47, v33, v11
  s_waitcnt vmcnt(15)
  s_nop 1
  v_mfma_f32_16x16x32_bf16 v[28:31], v[44:47], v[100:103], v[28:31]
  buffer_load_dwordx4 v[100:103], v21, s[36:39], s70 offen offset:1024 nt
  v_and_b32 v40, v34, v8
  v_and_b32 v41, v34, v9
  v_and_b32 v42, v34, v10
  v_and_b32 v43, v34, v11
  s_waitcnt vmcnt(15)
  s_nop 1
  v_mfma_f32_16x16x32_bf16 v[28:31], v[40:43], v[104:107], v[28:31]
  buffer_load_dwordx4 v[104:107], v21, s[36:39], s70 offen offset:2048 nt
  v_and_b32 v44, v35, v8
  v_and_b32 v45, v35, v9
  v_and_b32 v46, v35, v10
  v_and_b32 v47, v35, v11
  s_waitcnt vmcnt(15)
  s_nop 1
  v_mfma_f32_16x16x32_bf16 v[28:31], v[44:47], v[108:111], v[28:31]
  buffer_load_dwordx4 v[108:111], v21, s[36:39], s70 offen offset:3072 nt
  s_add_u32 s70, s70, 16384
  s_waitcnt lgkmcnt(0)
  ds_read_b128 v[32:35], v22 offset:3840
  v_and_b32 v40, v36, v8
  v_and_b32 v41, v36, v9
  v_and_b32 v42, v36, v10
  v_and_b32 v43, v36, v11
  s_waitcnt vmcnt(15)
  s_nop 1
  v_mfma_f32_16x16x32_bf16 v[28:31], v[40:43], v[112:115], v[28:31]
  buffer_load_dwordx4 v[112:115], v21, s[36:39], s70 offen offset:0 nt
  v_and_b32 v44, v37, v8
  v_and_b32 v45, v37, v9
  v_and_b32 v46, v37, v10
  v_and_b32 v47, v37, v11
  s_waitcnt vmcnt(15)
  s_nop 1
  v_mfma_f32_16x16x32_bf16 v[28:31], v[44:47], v[116:119], v[28:31]
  buffer_load_dwordx4 v[116:119], v21, s[36:39], s70 offen offset:1024 nt
  v_and_b32 v40, v38, v8
  v_and_b32 v41, v38, v9
  v_and_b32 v42, v38, v10
  v_and_b32 v43, v38, v11
  s_waitcnt vmcnt(15)
  s_nop 1
  v_mfma_f32_16x16x32_bf16 v[28:31], v[40:43], v[120:123], v[28:31]
  buffer_load_dwordx4 v[120:123], v21, s[36:39], s70 offen offset:2048 nt
  v_and_b32 v44, v39, v8
  v_and_b32 v45, v39, v9
  v_and_b32 v46, v39, v10
  v_and_b32 v47, v39, v11
  s_waitcnt vmcnt(15)
  s_nop 1
  v_mfma_f32_16x16x32_bf16 v[28:31], v[44:47], v[124:127], v[28:31]
  buffer_load_dwordx4 v[124:127], v21, s[36:39], s70 offen offset:3072 nt
  s_add_u32 s70, s70, 16384
  s_waitcnt lgkmcnt(0)
  ds_read_b128 v[36:39], v22 offset:3904
  v_and_b32 v40, v32, v8
  v_and_b32 v41, v32, v9
  v_and_b32 v42, v32, v10
  v_and_b32 v43, v32, v11
  s_waitcnt vmcnt(15)
  s_nop 1
  v_mfma_f32_16x16x32_bf16 v[28:31], v[40:43], v[64:67], v[28:31]
  v_and_b32 v44, v33, v8
  v_and_b32 v45, v33, v9
  v_and_b32 v46, v33, v10
  v_and_b32 v47, v33, v11
  s_waitcnt vmcnt(14)
  s_nop 1
  v_mfma_f32_16x16x32_bf16 v[28:31], v[44:47], v[68:71], v[28:31]
  v_and_b32 v40, v34, v8
  v_and_b32 v41, v34, v9
  v_and_b32 v42, v34, v10
  v_and_b32 v43, v34, v11
  s_waitcnt vmcnt(13)
  s_nop 1
  v_mfma_f32_16x16x32_bf16 v[28:31], v[40:43], v[72:75], v[28:31]
  v_and_b32 v44, v35, v8
  v_and_b32 v45, v35, v9
  v_and_b32 v46, v35, v10
  v_and_b32 v47, v35, v11
  s_waitcnt vmcnt(12)
  s_nop 1
  v_mfma_f32_16x16x32_bf16 v[28:31], v[44:47], v[76:79], v[28:31]
  s_waitcnt lgkmcnt(0)
  ds_read_b128 v[32:35], v22 offset:3968
  v_and_b32 v40, v36, v8
  v_and_b32 v41, v36, v9
  v_and_b32 v42, v36, v10
  v_and_b32 v43, v36, v11
  s_waitcnt vmcnt(11)
  s_nop 1
  v_mfma_f32_16x16x32_bf16 v[28:31], v[40:43], v[80:83], v[28:31]
  v_and_b32 v44, v37, v8
  v_and_b32 v45, v37, v9
  v_and_b32 v46, v37, v10
  v_and_b32 v47, v37, v11
  s_waitcnt vmcnt(10)
  s_nop 1
  v_mfma_f32_16x16x32_bf16 v[28:31], v[44:47], v[84:87], v[28:31]
  v_and_b32 v40, v38, v8
  v_and_b32 v41, v38, v9
  v_and_b32 v42, v38, v10
  v_and_b32 v43, v38, v11
  s_waitcnt vmcnt(9)
  s_nop 1
  v_mfma_f32_16x16x32_bf16 v[28:31], v[40:43], v[88:91], v[28:31]
  v_and_b32 v44, v39, v8
  v_and_b32 v45, v39, v9
  v_and_b32 v46, v39, v10
  v_and_b32 v47, v39, v11
  s_waitcnt vmcnt(8)
  s_nop 1
  v_mfma_f32_16x16x32_bf16 v[28:31], v[44:47], v[92:95], v[28:31]
  s_waitcnt lgkmcnt(0)
  ds_read_b128 v[36:39], v22 offset:4032
  v_and_b32 v40, v32, v8
  v_and_b32 v41, v32, v9
  v_and_b32 v42, v32, v10
  v_and_b32 v43, v32, v11
  s_waitcnt vmcnt(7)
  s_nop 1
  v_mfma_f32_16x16x32_bf16 v[28:31], v[40:43], v[96:99], v[28:31]
  v_and_b32 v44, v33, v8
  v_and_b32 v45, v33, v9
  v_and_b32 v46, v33, v10
  v_and_b32 v47, v33, v11
  s_waitcnt vmcnt(6)
  s_nop 1
  v_mfma_f32_16x16x32_bf16 v[28:31], v[44:47], v[100:103], v[28:31]
  v_and_b32 v40, v34, v8
  v_and_b32 v41, v34, v9
  v_and_b32 v42, v34, v10
  v_and_b32 v43, v34, v11
  s_waitcnt vmcnt(5)
  s_nop 1
  v_mfma_f32_16x16x32_bf16 v[28:31], v[40:43], v[104:107], v[28:31]
  v_and_b32 v44, v35, v8
  v_and_b32 v45, v35, v9
  v_and_b32 v46, v35, v10
  v_and_b32 v47, v35, v11
  s_waitcnt vmcnt(4)
  s_nop 1
  v_mfma_f32_16x16x32_bf16 v[28:31], v[44:47], v[108:111], v[28:31]
  s_waitcnt lgkmcnt(0)
  v_and_b32 v40, v36, v8
  v_and_b32 v41, v36, v9
  v_and_b32 v42, v36, v10
  v_and_b32 v43, v36, v11
  s_waitcnt vmcnt(3)
  s_nop 1
  v_mfma_f32_16x16x32_bf16 v[28:31], v[40:43], v[112:115], v[28:31]
  v_and_b32 v44, v37, v8
  v_and_b32 v45, v37, v9
  v_and_b32 v46, v37, v10
  v_and_b32 v47, v37, v11
  s_waitcnt vmcnt(2)
  s_nop 1
  v_mfma_f32_16x16x32_bf16 v[28:31], v[44:47], v[116:119], v[28:31]
  v_and_b32 v40, v38, v8
  v_and_b32 v41, v38, v9
  v_and_b32 v42, v38, v10
  v_and_b32 v43, v38, v11
  s_waitcnt vmcnt(1)
  s_nop 1
  v_mfma_f32_16x16x32_bf16 v[28:31], v[40:43], v[120:123], v[28:31]
  v_and_b32 v44, v39, v8
  v_and_b32 v45, v39, v9
  v_and_b32 v46, v39, v10
  v_and_b32 v47, v39, v11
  s_waitcnt vmcnt(0)
  s_nop 1
  v_mfma_f32_16x16x32_bf16 v[28:31], v[44:47], v[124:127], v[28:31]
  s_nop 9
  s_lshl_b32 s72, s64, 9
  v_add_u32 v14, s72, v12
  ds_write_b128 v14, v[28:31] offset:16384
L_tail:
  s_waitcnt vmcnt(0) lgkmcnt(0)
  s_barrier
  ds_read_b64 v[48:49], v6 offset:16384
  ds_read_b64 v[50:51], v6 offset:16896
  ds_read_b64 v[52:53], v6 offset:17408
  ds_read_b64 v[54:55], v6 offset:17920
  ds_read_b64 v[56:57], v7 offset:31064
  s_lshl_b32 s72, s64, 9
  v_add_u32 v17, s72, v6
  s_cmp_eq_u32 s64, 4
  s_cbranch_scc0 L_pf_4
  s_lshl_b32 s72, s2, 3
  s_add_u32 s72, s72, 3166208
  v_mov_b32 v18, s76
  v_mov_b32 v19, s77
  s_mov_b64 exec, 1
  buffer_store_dwordx2 v[18:19], v7, s[48:51], s72 offen sc1
  s_mov_b64 exec, -1
L_pf_4:
  s_waitcnt lgkmcnt(0)
  v_add_f32 v48, v48, v50
  v_add_f32 v52, v52, v54
  v_add_f32 v48, v48, v52
  v_cvt_pk_bf16_f32 v48, v48, v48
  v_add_f32 v49, v49, v51
  v_add_f32 v53, v53, v55
  v_add_f32 v49, v49, v53
  v_cvt_pk_bf16_f32 v49, v49, v49
  ds_write_b64 v17, v[48:49] offset:18432
  v_mov_b32 v28, 0
  v_mov_b32 v29, 0
  v_mov_b32 v30, 0
  v_mov_b32 v31, 0
  s_waitcnt lgkmcnt(0)
  ds_read_b128 v[32:35], v20 offset:18432
  v_lshrrev_b32 v14, 2, v3
  s_lshl_b32 s72, s64, 2
  v_add_u32 v14, s72, v14
  v_lshlrev_b32 v14, 13, v14
  v_and_b32 v15, 3, v3
  v_lshl_add_u32 v14, v15, 6, v14
  v_and_b32 v15, 1, v2
  v_lshl_add_u32 v14, v15, 5, v14
  v_lshrrev_b32 v15, 1, v2
  v_lshl_add_u32 v14, v15, 4, v14
  s_lshl_b32 s71, s65, 18
  s_lshl_b32 s72, s66, 8
  s_add_u32 s71, s71, s72
  s_add_u32 s71, s71, 4194304
  s_mov_b32 s84, 0
  s_mov_b32 s85, -1
  s_waitcnt lgkmcnt(0)
  ds_read_b128 v[36:39], v20 offset:18496
  v_and_b32 v40, v32, v8
  v_and_b32 v41, v32, v9
  v_and_b32 v42, v32, v10
  v_and_b32 v43, v32, v11
  s_nop 1
  v_mfma_f32_16x16x32_bf16 v[28:31], v[40:43], a[0:3], v[28:31]
  v_and_b32 v44, v33, v8
  v_and_b32 v45, v33, v9
  v_and_b32 v46, v33, v10
  v_and_b32 v47, v33, v11
  s_nop 1
  v_mfma_f32_16x16x32_bf16 v[28:31], v[44:47], a[4:7], v[28:31]
  v_and_b32 v40, v34, v8
  v_and_b32 v41, v34, v9
  v_and_b32 v42, v34, v10
  v_and_b32 v43, v34, v11
  s_nop 1
  v_mfma_f32_16x16x32_bf16 v[28:31], v[40:43], a[8:11], v[28:31]
  v_and_b32 v44, v35, v8
  v_and_b32 v45, v35, v9
  v_and_b32 v46, v35, v10
  v_and_b32 v47, v35, v11
  s_nop 1
  v_mfma_f32_16x16x32_bf16 v[28:31], v[44:47], a[12:15], v[28:31]
  s_waitcnt lgkmcnt(0)
  ds_read_b128 v[32:35], v20 offset:18560
  v_and_b32 v40, v36, v8
  v_and_b32 v41, v36, v9
  v_and_b32 v42, v36, v10
  v_and_b32 v43, v36, v11
  s_nop 1
  v_mfma_f32_16x16x32_bf16 v[28:31], v[40:43], a[16:19], v[28:31]
  v_and_b32 v44, v37, v8
  v_and_b32 v45, v37, v9
  v_and_b32 v46, v37, v10
  v_and_b32 v47, v37, v11
  s_nop 1
  v_mfma_f32_16x16x32_bf16 v[28:31], v[44:47], a[20:23], v[28:31]
  v_and_b32 v40, v38, v8
  v_and_b32 v41, v38, v9
  v_and_b32 v42, v38, v10
  v_and_b32 v43, v38, v11
  s_nop 1
  v_mfma_f32_16x16x32_bf16 v[28:31], v[40:43], a[24:27], v[28:31]
  v_and_b32 v44, v39, v8
  v_and_b32 v45, v39, v9
  v_and_b32 v46, v39, v10
  v_and_b32 v47, v39, v11
  s_nop 1
  v_mfma_f32_16x16x32_bf16 v[28:31], v[44:47], a[28:31], v[28:31]
  s_waitcnt lgkmcnt(0)
  ds_read_b128 v[36:39], v20 offset:18624
  v_and_b32 v40, v32, v8
  v_and_b32 v41, v32, v9
  v_and_b32 v42, v32, v10
  v_and_b32 v43, v32, v11
  s_nop 1
  v_mfma_f32_16x16x32_bf16 v[28:31], v[40:43], a[32:35], v[28:31]
  v_and_b32 v44, v33, v8
  v_and_b32 v45, v33, v9
  v_and_b32 v46, v33, v10
  v_and_b32 v47, v33, v11
  s_nop 1
  v_mfma_f32_16x16x32_bf16 v[28:31], v[44:47], a[36:39], v[28:31]
  v_and_b32 v40, v34, v8
  v_and_b32 v41, v34, v9
  v_and_b32 v42, v34, v10
  v_and_b32 v43, v34, v11
  s_nop 1
  v_mfma_f32_16x16x32_bf16 v[28:31], v[40:43], a[40:43], v[28:31]
  v_and_b32 v44, v35, v8
  v_and_b32 v45, v35, v9
  v_and_b32 v46, v35, v10
  v_and_b32 v47, v35, v11
  s_nop 1
  v_mfma_f32_16x16x32_bf16 v[28:31], v[44:47], a[44:47], v[28:31]
  s_waitcnt lgkmcnt(0)
  ds_read_b128 v[32:35], v20 offset:18688
  v_and_b32 v40, v36, v8
  v_and_b32 v41, v36, v9
  v_and_b32 v42, v36, v10
  v_and_b32 v43, v36, v11
  s_nop 1
  v_mfma_f32_16x16x32_bf16 v[28:31], v[40:43], a[48:51], v[28:31]
  v_and_b32 v44, v37, v8
  v_and_b32 v45, v37, v9
  v_and_b32 v46, v37, v10
  v_and_b32 v47, v37, v11
  s_nop 1
  v_mfma_f32_16x16x32_bf16 v[28:31], v[44:47], a[52:55], v[28:31]
  v_and_b32 v40, v38, v8
  v_and_b32 v41, v38, v9
  v_and_b32 v42, v38, v10
  v_and_b32 v43, v38, v11
  s_nop 1
  v_mfma_f32_16x16x32_bf16 v[28:31], v[40:43], a[56:59], v[28:31]
  v_and_b32 v44, v39, v8
  v_and_b32 v45, v39, v9
  v_and_b32 v46, v39, v10
  v_and_b32 v47, v39, v11
  s_nop 1
  v_mfma_f32_16x16x32_bf16 v[28:31], v[44:47], a[60:63], v[28:31]
  s_waitcnt lgkmcnt(0)
  ds_read_b128 v[36:39], v20 offset:18752
  v_and_b32 v40, v32, v8
  v_and_b32 v41, v32, v9
  v_and_b32 v42, v32, v10
  v_and_b32 v43, v32, v11
  s_nop 1
  v_mfma_f32_16x16x32_bf16 v[28:31], v[40:43], a[64:67], v[28:31]
  v_and_b32 v44, v33, v8
  v_and_b32 v45, v33, v9
  v_and_b32 v46, v33, v10
  v_and_b32 v47, v33, v11
  s_nop 1
  v_mfma_f32_16x16x32_bf16 v[28:31], v[44:47], a[68:71], v[28:31]
  v_and_b32 v40, v34, v8
  v_and_b32 v41, v34, v9
  v_and_b32 v42, v34, v10
  v_and_b32 v43, v34, v11
  s_nop 1
  v_mfma_f32_16x16x32_bf16 v[28:31], v[40:43], a[72:75], v[28:31]
  v_and_b32 v44, v35, v8
  v_and_b32 v45, v35, v9
  v_and_b32 v46, v35, v10
  v_and_b32 v47, v35, v11
  s_nop 1
  v_mfma_f32_16x16x32_bf16 v[28:31], v[44:47], a[76:79], v[28:31]
  s_waitcnt lgkmcnt(0)
  ds_read_b128 v[32:35], v20 offset:18816
  v_and_b32 v40, v36, v8
  v_and_b32 v41, v36, v9
  v_and_b32 v42, v36, v10
  v_and_b32 v43, v36, v11
  s_nop 1
  v_mfma_f32_16x16x32_bf16 v[28:31], v[40:43], a[80:83], v[28:31]
  v_and_b32 v44, v37, v8
  v_and_b32 v45, v37, v9
  v_and_b32 v46, v37, v10
  v_and_b32 v47, v37, v11
  s_nop 1
  v_mfma_f32_16x16x32_bf16 v[28:31], v[44:47], a[84:87], v[28:31]
  v_and_b32 v40, v38, v8
  v_and_b32 v41, v38, v9
  v_and_b32 v42, v38, v10
  v_and_b32 v43, v38, v11
  s_nop 1
  v_mfma_f32_16x16x32_bf16 v[28:31], v[40:43], a[88:91], v[28:31]
  v_and_b32 v44, v39, v8
  v_and_b32 v45, v39, v9
  v_and_b32 v46, v39, v10
  v_and_b32 v47, v39, v11
  s_nop 1
  v_mfma_f32_16x16x32_bf16 v[28:31], v[44:47], a[92:95], v[28:31]
  s_waitcnt lgkmcnt(0)
  ds_read_b128 v[36:39], v20 offset:18880
  v_and_b32 v40, v32, v8
  v_and_b32 v41, v32, v9
  v_and_b32 v42, v32, v10
  v_and_b32 v43, v32, v11
  s_nop 1
  v_mfma_f32_16x16x32_bf16 v[28:31], v[40:43], a[96:99], v[28:31]
  v_and_b32 v44, v33, v8
  v_and_b32 v45, v33, v9
  v_and_b32 v46, v33, v10
  v_and_b32 v47, v33, v11
  s_nop 1
  v_mfma_f32_16x16x32_bf16 v[28:31], v[44:47], a[100:103], v[28:31]
  v_and_b32 v40, v34, v8
  v_and_b32 v41, v34, v9
  v_and_b32 v42, v34, v10
  v_and_b32 v43, v34, v11
  s_nop 1
  v_mfma_f32_16x16x32_bf16 v[28:31], v[40:43], a[104:107], v[28:31]
  v_and_b32 v44, v35, v8
  v_and_b32 v45, v35, v9
  v_and_b32 v46, v35, v10
  v_and_b32 v47, v35, v11
  s_nop 1
  v_mfma_f32_16x16x32_bf16 v[28:31], v[44:47], a[108:111], v[28:31]
  s_waitcnt lgkmcnt(0)
  v_and_b32 v40, v36, v8
  v_and_b32 v41, v36, v9
  v_and_b32 v42, v36, v10
  v_and_b32 v43, v36, v11
  s_nop 1
  v_mfma_f32_16x16x32_bf16 v[28:31], v[40:43], a[112:115], v[28:31]
  v_and_b32 v44, v37, v8
  v_and_b32 v45, v37, v9
  v_and_b32 v46, v37, v10
  v_and_b32 v47, v37, v11
  s_nop 1
  v_mfma_f32_16x16x32_bf16 v[28:31], v[44:47], a[116:119], v[28:31]
  v_and_b32 v40, v38, v8
  v_and_b32 v41, v38, v9
  v_and_b32 v42, v38, v10
  v_and_b32 v43, v38, v11
  s_nop 1
  v_mfma_f32_16x16x32_bf16 v[28:31], v[40:43], a[120:123], v[28:31]
  v_and_b32 v44, v39, v8
  v_and_b32 v45, v39, v9
  v_and_b32 v46, v39, v10
  v_and_b32 v47, v39, v11
  s_nop 1
  v_mfma_f32_16x16x32_bf16 v[28:31], v[44:47], a[124:127], v[28:31]
  s_nop 9
  v_cndmask_b32 v54, v28, v30, s[84:85]
  v_cndmask_b32 v55, v29, v31, s[84:85]
  buffer_store_dwordx4 v[54:57], v14, s[48:51], s71 offen sc1
  s_cmp_eq_u32 s64, 4
  s_cbranch_scc0 L_fin
  v_and_b32 v14, 31, v1
  v_lshlrev_b32 v14, 3, v14
  s_lshl_b32 s74, s65, 8
  s_add_u32 s74, s74, 3166208
  s_mov_b32 s75, 0
L_spin_6:
  buffer_load_dwordx2 v[16:17], v14, s[48:51], s74 offen sc1
  s_waitcnt vmcnt(0)
  v_cmp_ne_u64 vcc, s[76:77], v[16:17]
  s_add_u32 s75, s75, 1
  s_cmp_ge_u32 s75, 0x4000
  s_cbranch_scc1 L_ok_5
  s_nop 1
  s_cbranch_vccz L_ok_5
  s_sleep 12
  s_branch L_spin_6
L_ok_5:
  s_lshl_b32 s72, s2, 13
  s_add_u32 s72, s72, 4194304
  s_mov_b32 s73, 0
  s_add_u32 s71, s72, 0
  buffer_load_dwordx4 v[64:67], v4, s[48:51], s71 offen sc1
  s_add_u32 s71, s72, 1024
  buffer_load_dwordx4 v[68:71], v4, s[48:51], s71 offen sc1
  s_add_u32 s71, s72, 2048
  buffer_load_dwordx4 v[72:75], v4, s[48:51], s71 offen sc1
  s_add_u32 s71, s72, 3072
  buffer_load_dwordx4 v[76:79], v4, s[48:51], s71 offen sc1
  s_add_u32 s71, s72, 4096
  buffer_load_dwordx4 v[80:83], v4, s[48:51], s71 offen sc1
  s_add_u32 s71, s72, 5120
  buffer_load_dwordx4 v[84:87], v4, s[48:51], s71 offen sc1
  s_add_u32 s71, s72, 6144
  buffer_load_dwordx4 v[88:91], v4, s[48:51], s71 offen sc1
  s_add_u32 s71, s72, 7168
  buffer_load_dwordx4 v[92:95], v4, s[48:51], s71 offen sc1
L_gp_7:
  s_add_u32 s71, s72, 0
  buffer_load_dwordx4 v[96:99], v4, s[48:51], s71 offen sc1
  s_add_u32 s71, s72, 1024
  buffer_load_dwordx4 v[100:103], v4, s[48:51], s71 offen sc1
  s_add_u32 s71, s72, 2048
  buffer_load_dwordx4 v[104:107], v4, s[48:51], s71 offen sc1
  s_add_u32 s71, s72, 3072
  buffer_load_dwordx4 v[108:111], v4, s[48:51], s71 offen sc1
  s_add_u32 s71, s72, 4096
  buffer_load_dwordx4 v[112:115], v4, s[48:51], s71 offen sc1
  s_add_u32 s71, s72, 5120
  buffer_load_dwordx4 v[116:119], v4, s[48:51], s71 offen sc1
  s_add_u32 s71, s72, 6144
  buffer_load_dwordx4 v[120:123], v4, s[48:51], s71 offen sc1
  s_add_u32 s71, s72, 7168
  buffer_load_dwordx4 v[124:127], v4, s[48:51], s71 offen sc1
  s_waitcnt vmcnt(8)
  s_mov_b64 s[74:75], 0
  v_cmp_ne_u64 vcc, s[76:77], v[66:67]
  s_nop 0
  s_or_b64 s[74:75], s[74:75], vcc
  v_cmp_ne_u64 vcc, s[76:77], v[70:71]
  s_nop 0
  s_or_b64 s[74:75], s[74:75], vcc
  v_cmp_ne_u64 vcc, s[76:77], v[74:75]
  s_nop 0
  s_or_b64 s[74:75], s[74:75], vcc
  v_cmp_ne_u64 vcc, s[76:77], v[78:79]
  s_nop 0
  s_or_b64 s[74:75], s[74:75], vcc
  v_cmp_ne_u64 vcc, s[76:77], v[82:83]
  s_nop 0
  s_or_b64 s[74:75], s[74:75], vcc
  v_cmp_ne_u64 vcc, s[76:77], v[86:87]
  s_nop 0
  s_or_b64 s[74:75], s[74:75], vcc
  v_cmp_ne_u64 vcc, s[76:77], v[90:91]
  s_nop 0
  s_or_b64 s[74:75], s[74:75], vcc
  v_cmp_ne_u64 vcc, s[76:77], v[94:95]
  s_nop 0
  s_or_b64 s[74:75], s[74:75], vcc
  s_cmp_eq_u64 s[74:75], 0
  s_cbranch_scc1 L_gp_7_a
  s_add_u32 s71, s72, 0
  buffer_load_dwordx4 v[64:67], v4, s[48:51], s71 offen sc1
  s_add_u32 s71, s72, 1024
  buffer_load_dwordx4 v[68:71], v4, s[48:51], s71 offen sc1
  s_add_u32 s71, s72, 2048
  buffer_load_dwordx4 v[72:75], v4, s[48:51], s71 offen sc1
  s_add_u32 s71, s72, 3072
  buffer_load_dwordx4 v[76:79], v4, s[48:51], s71 offen sc1
  s_add_u32 s71, s72, 4096
  buffer_load_dwordx4 v[80:83], v4, s[48:51], s71 offen sc1
  s_add_u32 s71, s72, 5120
  buffer_load_dwordx4 v[84:87], v4, s[48:51], s71 offen sc1
  s_add_u32 s71, s72, 6144
  buffer_load_dwordx4 v[88:91], v4, s[48:51], s71 offen sc1
  s_add_u32 s71, s72, 7168
  buffer_load_dwordx4 v[92:95], v4, s[48:51], s71 offen sc1
  s_waitcnt vmcnt(8)
  s_mov_b64 s[74:75], 0
  v_cmp_ne_u64 vcc, s[76:77], v[98:99]
  s_nop 0
  s_or_b64 s[74:75], s[74:75], vcc
  v_cmp_ne_u64 vcc, s[76:77], v[102:103]
  s_nop 0
  s_or_b64 s[74:75], s[74:75], vcc
  v_cmp_ne_u64 vcc, s[76:77], v[106:107]
  s_nop 0
  s_or_b64 s[74:75], s[74:75], vcc
  v_cmp_ne_u64 vcc, s[76:77], v[110:111]
  s_nop 0
  s_or_b64 s[74:75], s[74:75], vcc
  v_cmp_ne_u64 vcc, s[76:77], v[114:115]
  s_nop 0
  s_or_b64 s[74:75], s[74:75], vcc
  v_cmp_ne_u64 vcc, s[76:77], v[118:119]
  s_nop 0
  s_or_b64 s[74:75], s[74:75], vcc
  v_cmp_ne_u64 vcc, s[76:77], v[122:123]
  s_nop 0
  s_or_b64 s[74:75], s[74:75], vcc
  v_cmp_ne_u64 vcc, s[76:77], v[126:127]
  s_nop 0
  s_or_b64 s[74:75], s[74:75], vcc
  s_cmp_eq_u64 s[74:75], 0
  s_cbranch_scc1 L_gp_7_b
  s_add_u32 s73, s73, 1
  s_cmp_lt_u32 s73, 0x2000
  s_cbranch_scc1 L_gp_7
L_gp_7_b:
  v_add_f32 v14, v96, v100
  v_add_f32 v15, v97, v101
  v_add_f32 v14, v14, v104
  v_add_f32 v15, v15, v105
  v_add_f32 v14, v14, v108
  v_add_f32 v15, v15, v109
  v_add_f32 v14, v14, v112
  v_add_f32 v15, v15, v113
  v_add_f32 v14, v14, v116
  v_add_f32 v15, v15, v117
  v_add_f32 v14, v14, v120
  v_add_f32 v15, v15, v121
  v_add_f32 v14, v14, v124
  v_add_f32 v15, v15, v125
  s_branch L_gp_7_done
L_gp_7_a:
  v_add_f32 v14, v64, v68
  v_add_f32 v15, v65, v69
  v_add_f32 v14, v14, v72
  v_add_f32 v15, v15, v73
  v_add_f32 v14, v14, v76
  v_add_f32 v15, v15, v77
  v_add_f32 v14, v14, v80
  v_add_f32 v15, v15, v81
  v_add_f32 v14, v14, v84
  v_add_f32 v15, v15, v85
  v_add_f32 v14, v14, v88
  v_add_f32 v15, v15, v89
  v_add_f32 v14, v14, v92
  v_add_f32 v15, v15, v93
L_gp_7_done:
  v_mov_b32 v16, v14
  v_mov_b32 v17, v15
  s_nop 1
  v_permlane32_swap_b32 v14, v16
  v_permlane32_swap_b32 v15, v17
  s_nop 0
  v_add_f32 v14, v14, v16
  v_add_f32 v15, v15, v17
  v_mov_b32 v16, v14
  v_mov_b32 v17, v15
  s_nop 1
  v_permlane16_swap_b32 v14, v16
  v_permlane16_swap_b32 v15, v17
  s_nop 0
  v_add_f32 v14, v14, v16
  v_add_f32 v15, v15, v17
  v_cvt_pk_bf16_f32 v14, v14, v14
  v_lshlrev_b32 v14, 16, v14
  v_add_f32 v14, v14, v24
  v_cvt_pk_bf16_f32 v14, v14, v14
  v_lshlrev_b32 v14, 16, v14
  v_add_f32 v14, v14, v26
  v_cvt_pk_bf16_f32 v15, v15, v15
  v_lshlrev_b32 v15, 16, v15
  v_add_f32 v15, v15, v25
  v_cvt_pk_bf16_f32 v15, v15, v15
  v_lshlrev_b32 v15, 16, v15
  v_add_f32 v15, v15, v27
  v_cvt_pk_bf16_f32 v14, v14, v15
  v_lshlrev_b32 v16, 2, v3
  s_lshl_b32 s73, s2, 6
  s_mov_b64 exec, 0xffff
  buffer_store_dword v14, v16, s[60:63], s73 offen
  s_mov_b64 exec, -1
L_fin:
L_done:
  s_endpgm
L_aux_pro:
  s_setprio 3
  v_lshl_add_u32 v18, v2, 15, v15
  s_lshl_b32 s72, s65, 2
  s_add_u32 s72, s72, s78
  s_lshl_b32 s72, s72, 18
  s_lshl_b32 s73, s66, 8
  s_add_u32 s72, s72, s73
  s_add_u32 s40, s10, s72
  s_addc_u32 s41, s11, 0
  s_sub_u32 s42, 0x800000, s72
  s_mov_b32 s71, 0
  buffer_load_dwordx4 a[0:3], v18, s[40:43], s71 offen nt
  s_mov_b32 s71, 8192
  buffer_load_dwordx4 a[4:7], v18, s[40:43], s71 offen nt
  s_mov_b32 s71, 16384
  buffer_load_dwordx4 a[8:11], v18, s[40:43], s71 offen nt
  s_mov_b32 s71, 24576
  buffer_load_dwordx4 a[12:15], v18, s[40:43], s71 offen nt
  s_mov_b32 s71, 131072
  buffer_load_dwordx4 a[16:19], v18, s[40:43], s71 offen nt
  s_mov_b32 s71, 139264
  buffer_load_dwordx4 a[20:23], v18, s[40:43], s71 offen nt
  s_mov_b32 s71, 147456
  buffer_load_dwordx4 a[24:27], v18, s[40:43], s71 offen nt
  s_mov_b32 s71, 155648
  buffer_load_dwordx4 a[28:31], v18, s[40:43], s71 offen nt
  s_or_b32 s72, s2, s78
  s_cmp_eq_u32 s72, 0
  s_cbranch_scc0 L_no_nonce
  s_memrealtime s[72:73]
  s_waitcnt lgkmcnt(0)
  s_or_b32 s72, s72, 1
  v_mov_b32 v120, s72
  v_mov_b32 v121, s73
  s_mov_b64 exec, 1
  buffer_store_dwordx2 v[120:121], v7, s[52:55], 0 offen offset:8 sc1
  s_mov_b64 exec, -1
  s_nop 1
L_no_nonce:
  buffer_load_dwordx2 v[120:121], v7, s[52:55], 0 offen offset:8 sc1
  s_lshr_b32 s72, s2, 3
  s_and_b32 s73, s2, 7
  s_mul_i32 s73, s73, 14
  s_add_u32 s74, s73, s72
  s_sub_u32 s75, s74, 14
  s_and_b32 s68, s74, 3
  s_lshr_b32 s69, s74, 2
  s_cmp_lt_u32 s72, 14
  s_cselect_b32 s67, 1, 0
  s_cbranch_scc1 L_role_done
  s_cmp_lt_u32 s72, 28
  s_cselect_b32 s67, 2, 0
  s_lshr_b32 s68, s75, 3
  s_and_b32 s69, s75, 7
L_role_done:
  s_mov_b32 s60, s24
  s_mov_b32 s61, s25
  s_mov_b32 s62, 16384
  s_mov_b32 s63, 0x00020000
  v_and_b32 v14, 1, v3
  v_lshlrev_b32 v14, 4, v14
  v_mov_b32 v15, 0xffff
  v_lshlrev_b32 v15, v14, v15
  v_bfe_u32 v14, v3, 1, 2
  v_cmp_eq_u32 vcc, 0, v14
  s_nop 1
  v_cndmask_b32 v8, 0, v15, vcc
  v_cmp_eq_u32 vcc, 1, v14
  s_nop 1
  v_cndmask_b32 v9, 0, v15, vcc
  v_cmp_eq_u32 vcc, 2, v14
  s_nop 1
  v_cndmask_b32 v10, 0, v15, vcc
  v_cmp_eq_u32 vcc, 3, v14
  s_nop 1
  v_cndmask_b32 v11, 0, v15, vcc
  v_lshlrev_b32 v14, 4, v2
  v_lshl_add_u32 v20, v16, 9, v14
  v_and_b32 v15, 1, v2
  v_lshlrev_b32 v15, 4, v15
  v_lshl_add_u32 v12, v3, 5, v15
  v_and_b32 v16, 3, v16
  v_lshlrev_b32 v14, 4, v2
  v_lshrrev_b32 v15, 3, v3
  v_lshl_add_u32 v21, v15, 12, v14
  v_lshrrev_b32 v14, 1, v2
  v_lshl_add_u32 v22, v14, 9, v12
  v_lshl_add_u32 v22, v16, 12, v22
  v_lshl_add_u32 v23, v16, 10, v4
  s_lshl_b32 s72, s64, 12
  s_add_u32 s72, s72, 49152
  v_add_u32 v17, s72, v5
  s_waitcnt vmcnt(9)
  v_lshlrev_b32 v32, 16, v24
  v_and_b32 v33, s92, v24
  v_lshlrev_b32 v34, 16, v25
  v_and_b32 v35, s92, v25
  v_lshlrev_b32 v36, 16, v26
  v_and_b32 v37, s92, v26
  v_lshlrev_b32 v38, 16, v27
  v_and_b32 v39, s92, v27
  v_lshlrev_b32 v40, 16, v28
  v_and_b32 v41, s92, v28
  v_lshlrev_b32 v42, 16, v29
  v_and_b32 v43, s92, v29
  v_lshlrev_b32 v44, 16, v30
  v_and_b32 v45, s92, v30
  v_lshlrev_b32 v46, 16, v31
  v_and_b32 v47, s92, v31
  v_add_f32 v48, v32, v33
  v_add_f32 v49, v34, v35
  v_add_f32 v50, v36, v37
  v_add_f32 v51, v38, v39
  v_add_f32 v48, v48, v40
  v_add_f32 v48, v48, v41
  v_add_f32 v49, v49, v42
  v_add_f32 v49, v49, v43
  v_add_f32 v50, v50, v44
  v_add_f32 v50, v50, v45
  v_add_f32 v51, v51, v46
  v_add_f32 v51, v51, v47
  v_add_f32 v48, v48, v49
  v_add_f32 v50, v50, v51
  v_add_f32 v48, v48, v50
  s_nop 1
  v_add_f32_dpp v48, v48, v48 row_ror:8 row_mask:0xf bank_mask:0xf
  s_nop 1
  v_add_f32_dpp v48, v48, v48 row_ror:4 row_mask:0xf bank_mask:0xf
  s_nop 1
  v_add_f32_dpp v48, v48, v48 row_ror:2 row_mask:0xf bank_mask:0xf
  s_nop 1
  v_add_f32_dpp v48, v48, v48 row_ror:1 row_mask:0xf bank_mask:0xf
  s_nop 0
  v_readlane_b32 s86, v48, 0
  v_readlane_b32 s87, v48, 16
  v_readlane_b32 s88, v48, 32
  v_readlane_b32 s89, v48, 48
  s_nop 1
  v_mov_b32 v48, s86
  v_add_f32 v48, s87, v48
  v_add_f32 v48, s88, v48
  v_add_f32 v48, s89, v48
  v_mul_f32 v48, 0x3a800000, v48
  v_cvt_pk_bf16_f32 v49, v48, v48
  v_lshlrev_b32 v49, 16, v49
  v_mov_b32 v50, 0
  v_mov_b32 v51, 0
  v_sub_f32 v52, v32, v48
  v_fmac_f32 v50, v52, v52
  v_sub_f32 v53, v33, v48
  v_fmac_f32 v51, v53, v53
  v_sub_f32 v52, v34, v48
  v_fmac_f32 v50, v52, v52
  v_sub_f32 v53, v35, v48
  v_fmac_f32 v51, v53, v53
  v_sub_f32 v52, v36, v48
  v_fmac_f32 v50, v52, v52
  v_sub_f32 v53, v37, v48
  v_fmac_f32 v51, v53, v53
  v_sub_f32 v52, v38, v48
  v_fmac_f32 v50, v52, v52
  v_sub_f32 v53, v39, v48
  v_fmac_f32 v51, v53, v53
  v_sub_f32 v52, v40, v48
  v_fmac_f32 v50, v52, v52
  v_sub_f32 v53, v41, v48
  v_fmac_f32 v51, v53, v53
  v_sub_f32 v52, v42, v48
  v_fmac_f32 v50, v52, v52
  v_sub_f32 v53, v43, v48
  v_fmac_f32 v51, v53, v53
  v_sub_f32 v52, v44, v48
  v_fmac_f32 v50, v52, v52
  v_sub_f32 v53, v45, v48
  v_fmac_f32 v51, v53, v53
  v_sub_f32 v52, v46, v48
  v_fmac_f32 v50, v52, v52
  v_sub_f32 v53, v47, v48
  v_fmac_f32 v51, v53, v53
  v_add_f32 v50, v50, v51
  s_nop 1
  v_add_f32_dpp v50, v50, v50 row_ror:8 row_mask:0xf bank_mask:0xf
  s_nop 1
  v_add_f32_dpp v50, v50, v50 row_ror:4 row_mask:0xf bank_mask:0xf
  s_nop 1
  v_add_f32_dpp v50, v50, v50 row_ror:2 row_mask:0xf bank_mask:0xf
  s_nop 1
  v_add_f32_dpp v50, v50, v50 row_ror:1 row_mask:0xf bank_mask:0xf
  s_nop 0
  v_readlane_b32 s86, v50, 0
  v_readlane_b32 s87, v50, 16
  v_readlane_b32 s88, v50, 32
  v_readlane_b32 s89, v50, 48
  s_nop 1
  v_mov_b32 v50, s86
  v_add_f32 v50, s87, v50
  v_add_f32 v50, s88, v50
  v_add_f32 v50, s89, v50
  v_mul_f32 v50, 0x3a800000, v50
  v_cvt_pk_bf16_f32 v50, v50, v50
  v_lshlrev_b32 v50, 16, v50
  v_add_f32 v50, 0x3727c5ac, v50
  v_cvt_pk_bf16_f32 v50, v50, v50
  v_lshlrev_b32 v50, 16, v50
  v_sqrt_f32 v50, v50
  s_nop 0
  v_cvt_pk_bf16_f32 v50, v50, v50
  v_lshlrev_b32 v50, 16, v50
  v_rcp_f32 v51, v50
  s_nop 0
  v_sub_f32 v32, v32, v49
  v_sub_f32 v33, v33, v49
  v_cvt_pk_bf16_f32 v52, v32, v33
  v_lshlrev_b32 v32, 16, v52
  v_and_b32 v33, s92, v52
  v_mul_f32 v52, v32, v51
  v_mul_f32 v53, v33, v51
  v_fma_f32 v54, -v52, v50, v32
  v_fma_f32 v55, -v53, v50, v33
  v_fmac_f32 v52, v54, v51
  v_fmac_f32 v53, v55, v51
  v_cvt_pk_bf16_f32 v24, v52, v53
  v_sub_f32 v34, v34, v49
  v_sub_f32 v35, v35, v49
  v_cvt_pk_bf16_f32 v52, v34, v35
  v_lshlrev_b32 v34, 16, v52
  v_and_b32 v35, s92, v52
  v_mul_f32 v52, v34, v51
  v_mul_f32 v53, v35, v51
  v_fma_f32 v54, -v52, v50, v34
  v_fma_f32 v55, -v53, v50, v35
  v_fmac_f32 v52, v54, v51
  v_fmac_f32 v53, v55, v51
  v_cvt_pk_bf16_f32 v25, v52, v53
  v_sub_f32 v36, v36, v49
  v_sub_f32 v37, v37, v49
  v_cvt_pk_bf16_f32 v52, v36, v37
  v_lshlrev_b32 v36, 16, v52
  v_and_b32 v37, s92, v52
  v_mul_f32 v52, v36, v51
  v_mul_f32 v53, v37, v51
  v_fma_f32 v54, -v52, v50, v36
  v_fma_f32 v55, -v53, v50, v37
  v_fmac_f32 v52, v54, v51
  v_fmac_f32 v53, v55, v51
  v_cvt_pk_bf16_f32 v26, v52, v53
  v_sub_f32 v38, v38, v49
  v_sub_f32 v39, v39, v49
  v_cvt_pk_bf16_f32 v52, v38, v39
  v_lshlrev_b32 v38, 16, v52
  v_and_b32 v39, s92, v52
  v_mul_f32 v52, v38, v51
  v_mul_f32 v53, v39, v51
  v_fma_f32 v54, -v52, v50, v38
  v_fma_f32 v55, -v53, v50, v39
  v_fmac_f32 v52, v54, v51
  v_fmac_f32 v53, v55, v51
  v_cvt_pk_bf16_f32 v27, v52, v53
  v_sub_f32 v40, v40, v49
  v_sub_f32 v41, v41, v49
  v_cvt_pk_bf16_f32 v52, v40, v41
  v_lshlrev_b32 v40, 16, v52
  v_and_b32 v41, s92, v52
  v_mul_f32 v52, v40, v51
  v_mul_f32 v53, v41, v51
  v_fma_f32 v54, -v52, v50, v40
  v_fma_f32 v55, -v53, v50, v41
  v_fmac_f32 v52, v54, v51
  v_fmac_f32 v53, v55, v51
  v_cvt_pk_bf16_f32 v28, v52, v53
  v_sub_f32 v42, v42, v49
  v_sub_f32 v43, v43, v49
  v_cvt_pk_bf16_f32 v52, v42, v43
  v_lshlrev_b32 v42, 16, v52
  v_and_b32 v43, s92, v52
  v_mul_f32 v52, v42, v51
  v_mul_f32 v53, v43, v51
  v_fma_f32 v54, -v52, v50, v42
  v_fma_f32 v55, -v53, v50, v43
  v_fmac_f32 v52, v54, v51
  v_fmac_f32 v53, v55, v51
  v_cvt_pk_bf16_f32 v29, v52, v53
  v_sub_f32 v44, v44, v49
  v_sub_f32 v45, v45, v49
  v_cvt_pk_bf16_f32 v52, v44, v45
  v_lshlrev_b32 v44, 16, v52
  v_and_b32 v45, s92, v52
  v_mul_f32 v52, v44, v51
  v_mul_f32 v53, v45, v51
  v_fma_f32 v54, -v52, v50, v44
  v_fma_f32 v55, -v53, v50, v45
  v_fmac_f32 v52, v54, v51
  v_fmac_f32 v53, v55, v51
  v_cvt_pk_bf16_f32 v30, v52, v53
  v_sub_f32 v46, v46, v49
  v_sub_f32 v47, v47, v49
  v_cvt_pk_bf16_f32 v52, v46, v47
  v_lshlrev_b32 v46, 16, v52
  v_and_b32 v47, s92, v52
  v_mul_f32 v52, v46, v51
  v_mul_f32 v53, v47, v51
  v_fma_f32 v54, -v52, v50, v46
  v_fma_f32 v55, -v53, v50, v47
  v_fmac_f32 v52, v54, v51
  v_fmac_f32 v53, v55, v51
  v_cvt_pk_bf16_f32 v31, v52, v53
  v_perm_b32 v32, v24, v24, s90
  v_perm_b32 v33, v24, v24, s91
  v_perm_b32 v34, v25, v25, s90
  v_perm_b32 v35, v25, v25, s91
  v_perm_b32 v36, v26, v26, s90
  v_perm_b32 v37, v26, v26, s91
  v_perm_b32 v38, v27, v27, s90
  v_perm_b32 v39, v27, v27, s91
  v_perm_b32 v40, v28, v28, s90
  v_perm_b32 v41, v28, v28, s91
  v_perm_b32 v42, v29, v29, s90
  v_perm_b32 v43, v29, v29, s91
  v_perm_b32 v44, v30, v30, s90
  v_perm_b32 v45, v30, v30, s91
  v_perm_b32 v46, v31, v31, s90
  v_perm_b32 v47, v31, v31, s91
  ds_write_b128 v17, v[32:35] offset:0
  ds_write_b128 v17, v[36:39] offset:16
  ds_write_b128 v17, v[40:43] offset:2048
  ds_write_b128 v17, v[44:47] offset:2064
  s_waitcnt lgkmcnt(0)
  s_barrier
  s_lshl_b32 s72, s65, 9
  s_lshl_b32 s73, s78, 7
  s_add_u32 s72, s72, s73
  s_add_u32 s72, s72, 49152
  v_add_u32 v18, s72, v21
  v_mov_b32 v64, 0
  v_mov_b32 v65, 0
  v_mov_b32 v66, 0
  v_mov_b32 v67, 0
  v_mov_b32 v68, 0
  v_mov_b32 v69, 0
  v_mov_b32 v70, 0
  v_mov_b32 v71, 0
  v_mov_b32 v72, 0
  v_mov_b32 v73, 0
  v_mov_b32 v74, 0
  v_mov_b32 v75, 0
  v_mov_b32 v76, 0
  v_mov_b32 v77, 0
  v_mov_b32 v78, 0
  v_mov_b32 v79, 0
  ds_read_b128 v[32:35], v18 offset:0
  s_waitcnt lgkmcnt(0)
  ds_read_b128 v[36:39], v18 offset:8192
  v_and_b32 v40, v32, v8
  v_and_b32 v41, v32, v9
  v_and_b32 v42, v32, v10
  v_and_b32 v43, v32, v11
  s_waitcnt vmcnt(8)
  s_nop 1
  v_mfma_f32_16x16x32_bf16 v[64:67], v[40:43], a[0:3], v[64:67]
  v_and_b32 v44, v33, v8
  v_and_b32 v45, v33, v9
  v_and_b32 v46, v33, v10
  v_and_b32 v47, v33, v11
  s_waitcnt vmcnt(7)
  s_nop 1
  v_mfma_f32_16x16x32_bf16 v[64:67], v[44:47], a[4:7], v[64:67]
  v_and_b32 v40, v34, v8
  v_and_b32 v41, v34, v9
  v_and_b32 v42, v34, v10
  v_and_b32 v43, v34, v11
  s_waitcnt vmcnt(6)
  s_nop 1
  v_mfma_f32_16x16x32_bf16 v[64:67], v[40:43], a[8:11], v[64:67]
  v_and_b32 v44, v35, v8
  v_and_b32 v45, v35, v9
  v_and_b32 v46, v35, v10
  v_and_b32 v47, v35, v11
  s_waitcnt vmcnt(5)
  s_nop 1
  v_mfma_f32_16x16x32_bf16 v[64:67], v[44:47], a[12:15], v[64:67]
  s_waitcnt lgkmcnt(0)
  ds_read_b128 v[32:35], v18 offset:16384
  v_and_b32 v40, v36, v8
  v_and_b32 v41, v36, v9
  v_and_b32 v42, v36, v10
  v_and_b32 v43, v36, v11
  s_nop 1
  v_mfma_f32_16x16x32_bf16 v[68:71], v[40:43], a[0:3], v[68:71]
  v_and_b32 v44, v37, v8
  v_and_b32 v45, v37, v9
  v_and_b32 v46, v37, v10
  v_and_b32 v47, v37, v11
  s_nop 1
  v_mfma_f32_16x16x32_bf16 v[68:71], v[44:47], a[4:7], v[68:71]
  v_and_b32 v40, v38, v8
  v_and_b32 v41, v38, v9
  v_and_b32 v42, v38, v10
  v_and_b32 v43, v38, v11
  s_nop 1
  v_mfma_f32_16x16x32_bf16 v[68:71], v[40:43], a[8:11], v[68:71]
  v_and_b32 v44, v39, v8
  v_and_b32 v45, v39, v9
  v_and_b32 v46, v39, v10
  v_and_b32 v47, v39, v11
  s_nop 1
  v_mfma_f32_16x16x32_bf16 v[68:71], v[44:47], a[12:15], v[68:71]
  s_waitcnt lgkmcnt(0)
  ds_read_b128 v[36:39], v18 offset:24576
  v_and_b32 v40, v32, v8
  v_and_b32 v41, v32, v9
  v_and_b32 v42, v32, v10
  v_and_b32 v43, v32, v11
  s_nop 1
  v_mfma_f32_16x16x32_bf16 v[72:75], v[40:43], a[0:3], v[72:75]
  v_and_b32 v44, v33, v8
  v_and_b32 v45, v33, v9
  v_and_b32 v46, v33, v10
  v_and_b32 v47, v33, v11
  s_nop 1
  v_mfma_f32_16x16x32_bf16 v[72:75], v[44:47], a[4:7], v[72:75]
  v_and_b32 v40, v34, v8
  v_and_b32 v41, v34, v9
  v_and_b32 v42, v34, v10
  v_and_b32 v43, v34, v11
  s_nop 1
  v_mfma_f32_16x16x32_bf16 v[72:75], v[40:43], a[8:11], v[72:75]
  v_and_b32 v44, v35, v8
  v_and_b32 v45, v35, v9
  v_and_b32 v46, v35, v10
  v_and_b32 v47, v35, v11
  s_nop 1
  v_mfma_f32_16x16x32_bf16 v[72:75], v[44:47], a[12:15], v[72:75]
  s_waitcnt lgkmcnt(0)
  ds_read_b128 v[32:35], v18 offset:64
  v_and_b32 v40, v36, v8
  v_and_b32 v41, v36, v9
  v_and_b32 v42, v36, v10
  v_and_b32 v43, v36, v11
  s_nop 1
  v_mfma_f32_16x16x32_bf16 v[76:79], v[40:43], a[0:3], v[76:79]
  v_and_b32 v44, v37, v8
  v_and_b32 v45, v37, v9
  v_and_b32 v46, v37, v10
  v_and_b32 v47, v37, v11
  s_nop 1
  v_mfma_f32_16x16x32_bf16 v[76:79], v[44:47], a[4:7], v[76:79]
  v_and_b32 v40, v38, v8
  v_and_b32 v41, v38, v9
  v_and_b32 v42, v38, v10
  v_and_b32 v43, v38, v11
  s_nop 1
  v_mfma_f32_16x16x32_bf16 v[76:79], v[40:43], a[8:11], v[76:79]
  v_and_b32 v44, v39, v8
  v_and_b32 v45, v39, v9
  v_and_b32 v46, v39, v10
  v_and_b32 v47, v39, v11
  s_nop 1
  v_mfma_f32_16x16x32_bf16 v[76:79], v[44:47], a[12:15], v[76:79]
  s_waitcnt lgkmcnt(0)
  ds_read_b128 v[36:39], v18 offset:8256
  v_and_b32 v40, v32, v8
  v_and_b32 v41, v32, v9
  v_and_b32 v42, v32, v10
  v_and_b32 v43, v32, v11
  s_waitcnt vmcnt(4)
  s_nop 1
  v_mfma_f32_16x16x32_bf16 v[64:67], v[40:43], a[16:19], v[64:67]
  v_and_b32 v44, v33, v8
  v_and_b32 v45, v33, v9
  v_and_b32 v46, v33, v10
  v_and_b32 v47, v33, v11
  s_waitcnt vmcnt(3)
  s_nop 1
  v_mfma_f32_16x16x32_bf16 v[64:67], v[44:47], a[20:23], v[64:67]
  v_and_b32 v40, v34, v8
  v_and_b32 v41, v34, v9
  v_and_b32 v42, v34, v10
  v_and_b32 v43, v34, v11
  s_waitcnt vmcnt(2)
  s_nop 1
  v_mfma_f32_16x16x32_bf16 v[64:67], v[40:43], a[24:27], v[64:67]
  v_and_b32 v44, v35, v8
  v_and_b32 v45, v35, v9
  v_and_b32 v46, v35, v10
  v_and_b32 v47, v35, v11
  s_waitcnt vmcnt(1)
  s_nop 1
  v_mfma_f32_16x16x32_bf16 v[64:67], v[44:47], a[28:31], v[64:67]
  s_waitcnt lgkmcnt(0)
  ds_read_b128 v[32:35], v18 offset:16448
  v_and_b32 v40, v36, v8
  v_and_b32 v41, v36, v9
  v_and_b32 v42, v36, v10
  v_and_b32 v43, v36, v11
  s_nop 1
  v_mfma_f32_16x16x32_bf16 v[68:71], v[40:43], a[16:19], v[68:71]
  v_and_b32 v44, v37, v8
  v_and_b32 v45, v37, v9
  v_and_b32 v46, v37, v10
  v_and_b32 v47, v37, v11
  s_nop 1
  v_mfma_f32_16x16x32_bf16 v[68:71], v[44:47], a[20:23], v[68:71]
  v_and_b32 v40, v38, v8
  v_and_b32 v41, v38, v9
  v_and_b32 v42, v38, v10
  v_and_b32 v43, v38, v11
  s_nop 1
  v_mfma_f32_16x16x32_bf16 v[68:71], v[40:43], a[24:27], v[68:71]
  v_and_b32 v44, v39, v8
  v_and_b32 v45, v39, v9
  v_and_b32 v46, v39, v10
  v_and_b32 v47, v39, v11
  s_nop 1
  v_mfma_f32_16x16x32_bf16 v[68:71], v[44:47], a[28:31], v[68:71]
  s_waitcnt lgkmcnt(0)
  ds_read_b128 v[36:39], v18 offset:24640
  v_and_b32 v40, v32, v8
  v_and_b32 v41, v32, v9
  v_and_b32 v42, v32, v10
  v_and_b32 v43, v32, v11
  s_nop 1
  v_mfma_f32_16x16x32_bf16 v[72:75], v[40:43], a[16:19], v[72:75]
  v_and_b32 v44, v33, v8
  v_and_b32 v45, v33, v9
  v_and_b32 v46, v33, v10
  v_and_b32 v47, v33, v11
  s_nop 1
  v_mfma_f32_16x16x32_bf16 v[72:75], v[44:47], a[20:23], v[72:75]
  v_and_b32 v40, v34, v8
  v_and_b32 v41, v34, v9
  v_and_b32 v42, v34, v10
  v_and_b32 v43, v34, v11
  s_nop 1
  v_mfma_f32_16x16x32_bf16 v[72:75], v[40:43], a[24:27], v[72:75]
  v_and_b32 v44, v35, v8
  v_and_b32 v45, v35, v9
  v_and_b32 v46, v35, v10
  v_and_b32 v47, v35, v11
  s_nop 1
  v_mfma_f32_16x16x32_bf16 v[72:75], v[44:47], a[28:31], v[72:75]
  s_waitcnt lgkmcnt(0)
  v_and_b32 v40, v36, v8
  v_and_b32 v41, v36, v9
  v_and_b32 v42, v36, v10
  v_and_b32 v43, v36, v11
  s_nop 1
  v_mfma_f32_16x16x32_bf16 v[76:79], v[40:43], a[16:19], v[76:79]
  v_and_b32 v44, v37, v8
  v_and_b32 v45, v37, v9
  v_and_b32 v46, v37, v10
  v_and_b32 v47, v37, v11
  s_nop 1
  v_mfma_f32_16x16x32_bf16 v[76:79], v[44:47], a[20:23], v[76:79]
  v_and_b32 v40, v38, v8
  v_and_b32 v41, v38, v9
  v_and_b32 v42, v38, v10
  v_and_b32 v43, v38, v11
  s_nop 1
  v_mfma_f32_16x16x32_bf16 v[76:79], v[40:43], a[24:27], v[76:79]
  v_and_b32 v44, v39, v8
  v_and_b32 v45, v39, v9
  v_and_b32 v46, v39, v10
  v_and_b32 v47, v39, v11
  s_nop 1
  v_mfma_f32_16x16x32_bf16 v[76:79], v[44:47], a[28:31], v[76:79]
  s_nop 9
  ds_write_b128 v22, v[64:67] offset:32768
  ds_write_b128 v22, v[68:71] offset:33792
  ds_write_b128 v22, v[72:75] offset:34816
  ds_write_b128 v22, v[76:79] offset:35840
  s_waitcnt lgkmcnt(0)
  s_mov_b64 exec, 1
  v_mov_b32 v19, 1
  ds_add_u32 v7, v19 offset:31040
  s_mov_b64 exec, -1
  s_add_u32 s79, s79, 4
L_lspin_8:
  ds_read_b32 v19, v7 offset:31040
  s_waitcnt lgkmcnt(0)
  v_readfirstlane_b32 s72, v19
  s_nop 0
  s_cmp_ge_u32 s72, s79
  s_cbranch_scc1 L_lspin_8_ok
  s_branch L_lspin_8
L_lspin_8_ok:
  ds_read_b128 v[64:67], v23 offset:32768
  ds_read_b128 v[68:71], v23 offset:36864
  ds_read_b128 v[72:75], v23 offset:40960
  ds_read_b128 v[76:79], v23 offset:45056
  s_waitcnt lgkmcnt(0)
  v_add_f32 v64, v64, v68
  v_add_f32 v72, v72, v76
  v_add_f32 v65, v65, v69
  v_add_f32 v73, v73, v77
  v_add_f32 v66, v66, v70
  v_add_f32 v74, v74, v78
  v_add_f32 v67, v67, v71
  v_add_f32 v75, v75, v79
  v_add_f32 v64, v64, v72
  v_add_f32 v65, v65, v73
  v_add_f32 v66, v66, v74
  v_add_f32 v67, v67, v75
  s_lshl_b32 s72, s66, 3
  s_add_u32 s72, s72, s65
  s_lshl_b32 s71, s72, 12
  s_add_u32 s71, s71, 2097152
  buffer_store_dwordx4 v[64:67], v23, s[48:51], s71 offen sc1
  s_waitcnt vmcnt(1)
  s_cmp_eq_u32 s78, 0
  s_cbranch_scc0 L_non_skip
  s_mov_b32 s73, 0
L_spin_10:
  v_readfirstlane_b32 s76, v120
  v_readfirstlane_b32 s77, v121
  s_nop 0
  s_cmp_lg_u32 s76, 0
  s_cbranch_scc1 L_ok_9
  s_add_u32 s73, s73, 1
  s_cmp_ge_u32 s73, 0x4000
  s_cbranch_scc1 L_ok_9
  buffer_load_dwordx2 v[120:121], v7, s[52:55], 0 offen offset:8 sc1
  s_waitcnt vmcnt(0)
  s_branch L_spin_10
L_ok_9:
  v_mov_b32 v120, s76
  v_mov_b32 v121, s77
  ds_write_b64 v7, v[120:121] offset:31064
L_non_skip:
  s_lshl_b32 s74, s66, 6
  s_add_u32 s74, s74, 3145728
  s_lshl_b32 s73, s65, 3
  s_add_u32 s73, s73, s74
  v_and_b32 v14, 7, v1
  v_lshlrev_b32 v14, 3, v14
  s_waitcnt vmcnt(0)
  s_waitcnt lgkmcnt(0)
  s_mov_b64 exec, 1
  v_mov_b32 v19, 1
  ds_add_u32 v7, v19 offset:31040
  s_mov_b64 exec, -1
  s_add_u32 s79, s79, 4
L_lspin_11:
  ds_read_b32 v19, v7 offset:31040
  s_waitcnt lgkmcnt(0)
  v_readfirstlane_b32 s72, v19
  s_nop 0
  s_cmp_ge_u32 s72, s79
  s_cbranch_scc1 L_lspin_11_ok
  s_branch L_lspin_11
L_lspin_11_ok:
  s_cmp_eq_u32 s78, 0
  s_cbranch_scc0 L_no_gather
  v_mov_b32 v18, s76
  v_mov_b32 v19, s77
  s_mov_b64 exec, 1
  buffer_store_dwordx2 v[18:19], v7, s[48:51], s73 offen sc1
  s_mov_b64 exec, -1
  s_mov_b32 s75, 0
L_spin_13:
  buffer_load_dwordx2 v[16:17], v14, s[48:51], s74 offen sc1
  s_waitcnt vmcnt(0)
  v_cmp_ne_u64 vcc, s[76:77], v[16:17]
  s_add_u32 s75, s75, 1
  s_cmp_ge_u32 s75, 0x4000
  s_cbranch_scc1 L_ok_12
  s_nop 1
  s_cbranch_vccz L_ok_12
  s_branch L_spin_13
L_ok_12:
  s_lshl_b32 s72, s66, 15
  s_lshl_b32 s73, s65, 9
  s_add_u32 s72, s72, s73
  s_add_u32 s71, s72, 2097152
  buffer_load_dwordx2 v[64:65], v6, s[48:51], s71 offen sc1
  s_add_u32 s71, s72, 2101248
  buffer_load_dwordx2 v[66:67], v6, s[48:51], s71 offen sc1
  s_add_u32 s71, s72, 2105344
  buffer_load_dwordx2 v[68:69], v6, s[48:51], s71 offen sc1
  s_add_u32 s71, s72, 2109440
  buffer_load_dwordx2 v[70:71], v6, s[48:51], s71 offen sc1
  s_add_u32 s71, s72, 2113536
  buffer_load_dwordx2 v[72:73], v6, s[48:51], s71 offen sc1
  s_add_u32 s71, s72, 2117632
  buffer_load_dwordx2 v[74:75], v6, s[48:51], s71 offen sc1
  s_add_u32 s71, s72, 2121728
  buffer_load_dwordx2 v[76:77], v6, s[48:51], s71 offen sc1
  s_add_u32 s71, s72, 2125824
  buffer_load_dwordx2 v[78:79], v6, s[48:51], s71 offen sc1
  v_lshlrev_b32 v14, 2, v1
  s_waitcnt vmcnt(0)
  v_add_f32 v64, v64, v66
  v_add_f32 v65, v65, v67
  v_add_f32 v64, v64, v68
  v_add_f32 v65, v65, v69
  v_add_f32 v64, v64, v70
  v_add_f32 v65, v65, v71
  v_add_f32 v64, v64, v72
  v_add_f32 v65, v65, v73
  v_add_f32 v64, v64, v74
  v_add_f32 v65, v65, v75
  v_add_f32 v64, v64, v76
  v_add_f32 v65, v65, v77
  v_add_f32 v64, v64, v78
  v_add_f32 v65, v65, v79
  v_cvt_pk_bf16_f32 v64, v64, v65
  ds_write_b32 v14, v64 offset:30720
  s_waitcnt lgkmcnt(0)
  s_mov_b64 exec, 1
  v_mov_b32 v19, 1
  ds_add_u32 v7, v19 offset:31048
  s_mov_b64 exec, -1
L_no_gather:
  s_setprio 3
  s_cmp_eq_u32 s67, 1
  s_cbranch_scc0 L_not_a
  v_lshlrev_b32 v14, 4, v3
  v_mul_u32_u24 v18, 28672, v2
  v_add_u32 v18, v18, v14
  s_lshl_b32 s72, s68, 2
  s_add_u32 s72, s72, s78
  s_mul_i32 s72, s72, 458752
  s_lshl_b32 s73, s69, 8
  s_add_u32 s72, s72, s73
  s_add_u32 s40, s16, s72
  s_addc_u32 s41, s17, 0
  s_sub_u32 s42, 7340032, s72
  s_mov_b32 s71, 0
  buffer_load_dwordx4 a[64:67], v18, s[40:43], s71 offen nt
  s_mov_b32 s71, 7168
  buffer_load_dwordx4 a[68:71], v18, s[40:43], s71 offen nt
  s_mov_b32 s71, 14336
  buffer_load_dwordx4 a[72:75], v18, s[40:43], s71 offen nt
  s_mov_b32 s71, 21504
  buffer_load_dwordx4 a[76:79], v18, s[40:43], s71 offen nt
  s_mov_b32 s71, 114688
  buffer_load_dwordx4 a[80:83], v18, s[40:43], s71 offen nt
  s_mov_b32 s71, 121856
  buffer_load_dwordx4 a[84:87], v18, s[40:43], s71 offen nt
  s_mov_b32 s71, 129024
  buffer_load_dwordx4 a[88:91], v18, s[40:43], s71 offen nt
  s_mov_b32 s71, 136192
  buffer_load_dwordx4 a[92:95], v18, s[40:43], s71 offen nt
  s_mov_b32 s71, 229376
  buffer_load_dwordx4 a[96:99], v18, s[40:43], s71 offen nt
  s_mov_b32 s71, 236544
  buffer_load_dwordx4 a[100:103], v18, s[40:43], s71 offen nt
  s_mov_b32 s71, 243712
  buffer_load_dwordx4 a[104:107], v18, s[40:43], s71 offen nt
  s_mov_b32 s71, 250880
  buffer_load_dwordx4 a[108:111], v18, s[40:43], s71 offen nt
  s_mov_b32 s71, 344064
  buffer_load_dwordx4 a[112:115], v18, s[40:43], s71 offen nt
  s_mov_b32 s71, 351232
  buffer_load_dwordx4 a[116:119], v18, s[40:43], s71 offen nt
  s_mov_b32 s71, 358400
  buffer_load_dwordx4 a[120:123], v18, s[40:43], s71 offen nt
  s_mov_b32 s71, 365568
  buffer_load_dwordx4 a[124:127], v18, s[40:43], s71 offen nt
  s_lshl_b32 s72, s78, 13
  s_add_u32 s72, s72, 49152
  v_add_u32 v17, s72, v5
  v_add_u32 v18, 32768, v17
  ds_read_b128 v[32:35], v17 offset:0
  ds_read_b128 v[36:39], v17 offset:16
  ds_read_b128 v[40:43], v17 offset:2048
  ds_read_b128 v[44:47], v17 offset:2064
  s_waitcnt lgkmcnt(0)
  v_and_b32 v32, s92, v32
  v_and_b32 v33, s92, v33
  v_and_b32 v34, s92, v34
  v_and_b32 v35, s92, v35
  v_and_b32 v36, s92, v36
  v_and_b32 v37, s92, v37
  v_and_b32 v38, s92, v38
  v_and_b32 v39, s92, v39
  v_and_b32 v40, s92, v40
  v_and_b32 v41, s92, v41
  v_and_b32 v42, s92, v42
  v_and_b32 v43, s92, v43
  v_and_b32 v44, s92, v44
  v_and_b32 v45, s92, v45
  v_and_b32 v46, s92, v46
  v_and_b32 v47, s92, v47
  v_add_f32 v48, v32, v33
  v_add_f32 v49, v34, v35
  v_add_f32 v50, v36, v37
  v_add_f32 v51, v38, v39
  v_add_f32 v48, v48, v40
  v_add_f32 v48, v48, v41
  v_add_f32 v49, v49, v42
  v_add_f32 v49, v49, v43
  v_add_f32 v50, v50, v44
  v_add_f32 v50, v50, v45
  v_add_f32 v51, v51, v46
  v_add_f32 v51, v51, v47
  v_add_f32 v48, v48, v49
  v_add_f32 v50, v50, v51
  v_add_f32 v48, v48, v50
  s_nop 1
  v_add_f32_dpp v48, v48, v48 row_ror:8 row_mask:0xf bank_mask:0xf
  s_nop 1
  v_add_f32_dpp v48, v48, v48 row_ror:4 row_mask:0xf bank_mask:0xf
  s_nop 1
  v_add_f32_dpp v48, v48, v48 row_ror:2 row_mask:0xf bank_mask:0xf
  s_nop 1
  v_add_f32_dpp v48, v48, v48 row_ror:1 row_mask:0xf bank_mask:0xf
  s_nop 0
  v_readlane_b32 s86, v48, 0
  v_readlane_b32 s87, v48, 16
  v_readlane_b32 s88, v48, 32
  v_readlane_b32 s89, v48, 48
  s_nop 1
  v_mov_b32 v48, s86
  v_add_f32 v48, s87, v48
  v_add_f32 v48, s88, v48
  v_add_f32 v48, s89, v48
  v_mul_f32 v48, 0x3a800000, v48
  v_cvt_pk_bf16_f32 v49, v48, v48
  v_lshlrev_b32 v49, 16, v49
  v_mov_b32 v50, 0
  v_mov_b32 v51, 0
  v_sub_f32 v52, v32, v48
  v_fmac_f32 v50, v52, v52
  v_sub_f32 v53, v33, v48
  v_fmac_f32 v51, v53, v53
  v_sub_f32 v52, v34, v48
  v_fmac_f32 v50, v52, v52
  v_sub_f32 v53, v35, v48
  v_fmac_f32 v51, v53, v53
  v_sub_f32 v52, v36, v48
  v_fmac_f32 v50, v52, v52
  v_sub_f32 v53, v37, v48
  v_fmac_f32 v51, v53, v53
  v_sub_f32 v52, v38, v48
  v_fmac_f32 v50, v52, v52
  v_sub_f32 v53, v39, v48
  v_fmac_f32 v51, v53, v53
  v_sub_f32 v52, v40, v48
  v_fmac_f32 v50, v52, v52
  v_sub_f32 v53, v41, v48
  v_fmac_f32 v51, v53, v53
  v_sub_f32 v52, v42, v48
  v_fmac_f32 v50, v52, v52
  v_sub_f32 v53, v43, v48
  v_fmac_f32 v51, v53, v53
  v_sub_f32 v52, v44, v48
  v_fmac_f32 v50, v52, v52
  v_sub_f32 v53, v45, v48
  v_fmac_f32 v51, v53, v53
  v_sub_f32 v52, v46, v48
  v_fmac_f32 v50, v52, v52
  v_sub_f32 v53, v47, v48
  v_fmac_f32 v51, v53, v53
  v_add_f32 v50, v50, v51
  s_nop 1
  v_add_f32_dpp v50, v50, v50 row_ror:8 row_mask:0xf bank_mask:0xf
  s_nop 1
  v_add_f32_dpp v50, v50, v50 row_ror:4 row_mask:0xf bank_mask:0xf
  s_nop 1
  v_add_f32_dpp v50, v50, v50 row_ror:2 row_mask:0xf bank_mask:0xf
  s_nop 1
  v_add_f32_dpp v50, v50, v50 row_ror:1 row_mask:0xf bank_mask:0xf
  s_nop 0
  v_readlane_b32 s86, v50, 0
  v_readlane_b32 s87, v50, 16
  v_readlane_b32 s88, v50, 32
  v_readlane_b32 s89, v50, 48
  s_nop 1
  v_mov_b32 v50, s86
  v_add_f32 v50, s87, v50
  v_add_f32 v50, s88, v50
  v_add_f32 v50, s89, v50
  v_mul_f32 v50, 0x3a800000, v50
  v_cvt_pk_bf16_f32 v50, v50, v50
  v_lshlrev_b32 v50, 16, v50
  v_add_f32 v50, 0x3727c5ac, v50
  v_cvt_pk_bf16_f32 v50, v50, v50
  v_lshlrev_b32 v50, 16, v50
  v_sqrt_f32 v50, v50
  s_nop 0
  v_cvt_pk_bf16_f32 v50, v50, v50
  v_lshlrev_b32 v50, 16, v50
  v_rcp_f32 v51, v50
  s_nop 0
  v_sub_f32 v32, v32, v49
  v_sub_f32 v33, v33, v49
  v_cvt_pk_bf16_f32 v52, v32, v33
  v_lshlrev_b32 v32, 16, v52
  v_and_b32 v33, s92, v52
  v_mul_f32 v52, v32, v51
  v_mul_f32 v53, v33, v51
  v_fma_f32 v54, -v52, v50, v32
  v_fma_f32 v55, -v53, v50, v33
  v_fmac_f32 v52, v54, v51
  v_fmac_f32 v53, v55, v51
  v_cvt_pk_bf16_f32 v24, v52, v53
  v_sub_f32 v34, v34, v49
  v_sub_f32 v35, v35, v49
  v_cvt_pk_bf16_f32 v52, v34, v35
  v_lshlrev_b32 v34, 16, v52
  v_and_b32 v35, s92, v52
  v_mul_f32 v52, v34, v51
  v_mul_f32 v53, v35, v51
  v_fma_f32 v54, -v52, v50, v34
  v_fma_f32 v55, -v53, v50, v35
  v_fmac_f32 v52, v54, v51
  v_fmac_f32 v53, v55, v51
  v_cvt_pk_bf16_f32 v25, v52, v53
  v_sub_f32 v36, v36, v49
  v_sub_f32 v37, v37, v49
  v_cvt_pk_bf16_f32 v52, v36, v37
  v_lshlrev_b32 v36, 16, v52
  v_and_b32 v37, s92, v52
  v_mul_f32 v52, v36, v51
  v_mul_f32 v53, v37, v51
  v_fma_f32 v54, -v52, v50, v36
  v_fma_f32 v55, -v53, v50, v37
  v_fmac_f32 v52, v54, v51
  v_fmac_f32 v53, v55, v51
  v_cvt_pk_bf16_f32 v26, v52, v53
  v_sub_f32 v38, v38, v49
  v_sub_f32 v39, v39, v49
  v_cvt_pk_bf16_f32 v52, v38, v39
  v_lshlrev_b32 v38, 16, v52
  v_and_b32 v39, s92, v52
  v_mul_f32 v52, v38, v51
  v_mul_f32 v53, v39, v51
  v_fma_f32 v54, -v52, v50, v38
  v_fma_f32 v55, -v53, v50, v39
  v_fmac_f32 v52, v54, v51
  v_fmac_f32 v53, v55, v51
  v_cvt_pk_bf16_f32 v27, v52, v53
  v_sub_f32 v40, v40, v49
  v_sub_f32 v41, v41, v49
  v_cvt_pk_bf16_f32 v52, v40, v41
  v_lshlrev_b32 v40, 16, v52
  v_and_b32 v41, s92, v52
  v_mul_f32 v52, v40, v51
  v_mul_f32 v53, v41, v51
  v_fma_f32 v54, -v52, v50, v40
  v_fma_f32 v55, -v53, v50, v41
  v_fmac_f32 v52, v54, v51
  v_fmac_f32 v53, v55, v51
  v_cvt_pk_bf16_f32 v28, v52, v53
  v_sub_f32 v42, v42, v49
  v_sub_f32 v43, v43, v49
  v_cvt_pk_bf16_f32 v52, v42, v43
  v_lshlrev_b32 v42, 16, v52
  v_and_b32 v43, s92, v52
  v_mul_f32 v52, v42, v51
  v_mul_f32 v53, v43, v51
  v_fma_f32 v54, -v52, v50, v42
  v_fma_f32 v55, -v53, v50, v43
  v_fmac_f32 v52, v54, v51
  v_fmac_f32 v53, v55, v51
  v_cvt_pk_bf16_f32 v29, v52, v53
  v_sub_f32 v44, v44, v49
  v_sub_f32 v45, v45, v49
  v_cvt_pk_bf16_f32 v52, v44, v45
  v_lshlrev_b32 v44, 16, v52
  v_and_b32 v45, s92, v52
  v_mul_f32 v52, v44, v51
  v_mul_f32 v53, v45, v51
  v_fma_f32 v54, -v52, v50, v44
  v_fma_f32 v55, -v53, v50, v45
  v_fmac_f32 v52, v54, v51
  v_fmac_f32 v53, v55, v51
  v_cvt_pk_bf16_f32 v30, v52, v53
  v_sub_f32 v46, v46, v49
  v_sub_f32 v47, v47, v49
  v_cvt_pk_bf16_f32 v52, v46, v47
  v_lshlrev_b32 v46, 16, v52
  v_and_b32 v47, s92, v52
  v_mul_f32 v52, v46, v51
  v_mul_f32 v53, v47, v51
  v_fma_f32 v54, -v52, v50, v46
  v_fma_f32 v55, -v53, v50, v47
  v_fmac_f32 v52, v54, v51
  v_fmac_f32 v53, v55, v51
  v_cvt_pk_bf16_f32 v31, v52, v53
  v_perm_b32 v32, v24, v24, s90
  v_perm_b32 v33, v24, v24, s91
  v_perm_b32 v34, v25, v25, s90
  v_perm_b32 v35, v25, v25, s91
  v_perm_b32 v36, v26, v26, s90
  v_perm_b32 v37, v26, v26, s91
  v_perm_b32 v38, v27, v27, s90
  v_perm_b32 v39, v27, v27, s91
  v_perm_b32 v40, v28, v28, s90
  v_perm_b32 v41, v28, v28, s91
  v_perm_b32 v42, v29, v29, s90
  v_perm_b32 v43, v29, v29, s91
  v_perm_b32 v44, v30, v30, s90
  v_perm_b32 v45, v30, v30, s91
  v_perm_b32 v46, v31, v31, s90
  v_perm_b32 v47, v31, v31, s91
  ds_write_b128 v18, v[32:35] offset:0
  ds_write_b128 v18, v[36:39] offset:16
  ds_write_b128 v18, v[40:43] offset:2048
  ds_write_b128 v18, v[44:47] offset:2064
  ds_read_b128 v[32:35], v17 offset:4096
  ds_read_b128 v[36:39], v17 offset:4112
  ds_read_b128 v[40:43], v17 offset:6144
  ds_read_b128 v[44:47], v17 offset:6160
  s_waitcnt lgkmcnt(0)
  v_and_b32 v32, s92, v32
  v_and_b32 v33, s92, v33
  v_and_b32 v34, s92, v34
  v_and_b32 v35, s92, v35
  v_and_b32 v36, s92, v36
  v_and_b32 v37, s92, v37
  v_and_b32 v38, s92, v38
  v_and_b32 v39, s92, v39
  v_and_b32 v40, s92, v40
  v_and_b32 v41, s92, v41
  v_and_b32 v42, s92, v42
  v_and_b32 v43, s92, v43
  v_and_b32 v44, s92, v44
  v_and_b32 v45, s92, v45
  v_and_b32 v46, s92, v46
  v_and_b32 v47, s92, v47
  v_add_f32 v48, v32, v33
  v_add_f32 v49, v34, v35
  v_add_f32 v50, v36, v37
  v_add_f32 v51, v38, v39
  v_add_f32 v48, v48, v40
  v_add_f32 v48, v48, v41
  v_add_f32 v49, v49, v42
  v_add_f32 v49, v49, v43
  v_add_f32 v50, v50, v44
  v_add_f32 v50, v50, v45
  v_add_f32 v51, v51, v46
  v_add_f32 v51, v51, v47
  v_add_f32 v48, v48, v49
  v_add_f32 v50, v50, v51
  v_add_f32 v48, v48, v50
  s_nop 1
  v_add_f32_dpp v48, v48, v48 row_ror:8 row_mask:0xf bank_mask:0xf
  s_nop 1
  v_add_f32_dpp v48, v48, v48 row_ror:4 row_mask:0xf bank_mask:0xf
  s_nop 1
  v_add_f32_dpp v48, v48, v48 row_ror:2 row_mask:0xf bank_mask:0xf
  s_nop 1
  v_add_f32_dpp v48, v48, v48 row_ror:1 row_mask:0xf bank_mask:0xf
  s_nop 0
  v_readlane_b32 s86, v48, 0
  v_readlane_b32 s87, v48, 16
  v_readlane_b32 s88, v48, 32
  v_readlane_b32 s89, v48, 48
  s_nop 1
  v_mov_b32 v48, s86
  v_add_f32 v48, s87, v48
  v_add_f32 v48, s88, v48
  v_add_f32 v48, s89, v48
  v_mul_f32 v48, 0x3a800000, v48
  v_cvt_pk_bf16_f32 v49, v48, v48
  v_lshlrev_b32 v49, 16, v49
  v_mov_b32 v50, 0
  v_mov_b32 v51, 0
  v_sub_f32 v52, v32, v48
  v_fmac_f32 v50, v52, v52
  v_sub_f32 v53, v33, v48
  v_fmac_f32 v51, v53, v53
  v_sub_f32 v52, v34, v48
  v_fmac_f32 v50, v52, v52
  v_sub_f32 v53, v35, v48
  v_fmac_f32 v51, v53, v53
  v_sub_f32 v52, v36, v48
  v_fmac_f32 v50, v52, v52
  v_sub_f32 v53, v37, v48
  v_fmac_f32 v51, v53, v53
  v_sub_f32 v52, v38, v48
  v_fmac_f32 v50, v52, v52
  v_sub_f32 v53, v39, v48
  v_fmac_f32 v51, v53, v53
  v_sub_f32 v52, v40, v48
  v_fmac_f32 v50, v52, v52
  v_sub_f32 v53, v41, v48
  v_fmac_f32 v51, v53, v53
  v_sub_f32 v52, v42, v48
  v_fmac_f32 v50, v52, v52
  v_sub_f32 v53, v43, v48
  v_fmac_f32 v51, v53, v53
  v_sub_f32 v52, v44, v48
  v_fmac_f32 v50, v52, v52
  v_sub_f32 v53, v45, v48
  v_fmac_f32 v51, v53, v53
  v_sub_f32 v52, v46, v48
  v_fmac_f32 v50, v52, v52
  v_sub_f32 v53, v47, v48
  v_fmac_f32 v51, v53, v53
  v_add_f32 v50, v50, v51
  s_nop 1
  v_add_f32_dpp v50, v50, v50 row_ror:8 row_mask:0xf bank_mask:0xf
  s_nop 1
  v_add_f32_dpp v50, v50, v50 row_ror:4 row_mask:0xf bank_mask:0xf
  s_nop 1
  v_add_f32_dpp v50, v50, v50 row_ror:2 row_mask:0xf bank_mask:0xf
  s_nop 1
  v_add_f32_dpp v50, v50, v50 row_ror:1 row_mask:0xf bank_mask:0xf
  s_nop 0
  v_readlane_b32 s86, v50, 0
  v_readlane_b32 s87, v50, 16
  v_readlane_b32 s88, v50, 32
  v_readlane_b32 s89, v50, 48
  s_nop 1
  v_mov_b32 v50, s86
  v_add_f32 v50, s87, v50
  v_add_f32 v50, s88, v50
  v_add_f32 v50, s89, v50
  v_mul_f32 v50, 0x3a800000, v50
  v_cvt_pk_bf16_f32 v50, v50, v50
  v_lshlrev_b32 v50, 16, v50
  v_add_f32 v50, 0x3727c5ac, v50
  v_cvt_pk_bf16_f32 v50, v50, v50
  v_lshlrev_b32 v50, 16, v50
  v_sqrt_f32 v50, v50
  s_nop 0
  v_cvt_pk_bf16_f32 v50, v50, v50
  v_lshlrev_b32 v50, 16, v50
  v_rcp_f32 v51, v50
  s_nop 0
  v_sub_f32 v32, v32, v49
  v_sub_f32 v33, v33, v49
  v_cvt_pk_bf16_f32 v52, v32, v33
  v_lshlrev_b32 v32, 16, v52
  v_and_b32 v33, s92, v52
  v_mul_f32 v52, v32, v51
  v_mul_f32 v53, v33, v51
  v_fma_f32 v54, -v52, v50, v32
  v_fma_f32 v55, -v53, v50, v33
  v_fmac_f32 v52, v54, v51
  v_fmac_f32 v53, v55, v51
  v_cvt_pk_bf16_f32 v24, v52, v53
  v_sub_f32 v34, v34, v49
  v_sub_f32 v35, v35, v49
  v_cvt_pk_bf16_f32 v52, v34, v35
  v_lshlrev_b32 v34, 16, v52
  v_and_b32 v35, s92, v52
  v_mul_f32 v52, v34, v51
  v_mul_f32 v53, v35, v51
  v_fma_f32 v54, -v52, v50, v34
  v_fma_f32 v55, -v53, v50, v35
  v_fmac_f32 v52, v54, v51
  v_fmac_f32 v53, v55, v51
  v_cvt_pk_bf16_f32 v25, v52, v53
  v_sub_f32 v36, v36, v49
  v_sub_f32 v37, v37, v49
  v_cvt_pk_bf16_f32 v52, v36, v37
  v_lshlrev_b32 v36, 16, v52
  v_and_b32 v37, s92, v52
  v_mul_f32 v52, v36, v51
  v_mul_f32 v53, v37, v51
  v_fma_f32 v54, -v52, v50, v36
  v_fma_f32 v55, -v53, v50, v37
  v_fmac_f32 v52, v54, v51
  v_fmac_f32 v53, v55, v51
  v_cvt_pk_bf16_f32 v26, v52, v53
  v_sub_f32 v38, v38, v49
  v_sub_f32 v39, v39, v49
  v_cvt_pk_bf16_f32 v52, v38, v39
  v_lshlrev_b32 v38, 16, v52
  v_and_b32 v39, s92, v52
  v_mul_f32 v52, v38, v51
  v_mul_f32 v53, v39, v51
  v_fma_f32 v54, -v52, v50, v38
  v_fma_f32 v55, -v53, v50, v39
  v_fmac_f32 v52, v54, v51
  v_fmac_f32 v53, v55, v51
  v_cvt_pk_bf16_f32 v27, v52, v53
  v_sub_f32 v40, v40, v49
  v_sub_f32 v41, v41, v49
  v_cvt_pk_bf16_f32 v52, v40, v41
  v_lshlrev_b32 v40, 16, v52
  v_and_b32 v41, s92, v52
  v_mul_f32 v52, v40, v51
  v_mul_f32 v53, v41, v51
  v_fma_f32 v54, -v52, v50, v40
  v_fma_f32 v55, -v53, v50, v41
  v_fmac_f32 v52, v54, v51
  v_fmac_f32 v53, v55, v51
  v_cvt_pk_bf16_f32 v28, v52, v53
  v_sub_f32 v42, v42, v49
  v_sub_f32 v43, v43, v49
  v_cvt_pk_bf16_f32 v52, v42, v43
  v_lshlrev_b32 v42, 16, v52
  v_and_b32 v43, s92, v52
  v_mul_f32 v52, v42, v51
  v_mul_f32 v53, v43, v51
  v_fma_f32 v54, -v52, v50, v42
  v_fma_f32 v55, -v53, v50, v43
  v_fmac_f32 v52, v54, v51
  v_fmac_f32 v53, v55, v51
  v_cvt_pk_bf16_f32 v29, v52, v53
  v_sub_f32 v44, v44, v49
  v_sub_f32 v45, v45, v49
  v_cvt_pk_bf16_f32 v52, v44, v45
  v_lshlrev_b32 v44, 16, v52
  v_and_b32 v45, s92, v52
  v_mul_f32 v52, v44, v51
  v_mul_f32 v53, v45, v51
  v_fma_f32 v54, -v52, v50, v44
  v_fma_f32 v55, -v53, v50, v45
  v_fmac_f32 v52, v54, v51
  v_fmac_f32 v53, v55, v51
  v_cvt_pk_bf16_f32 v30, v52, v53
  v_sub_f32 v46, v46, v49
  v_sub_f32 v47, v47, v49
  v_cvt_pk_bf16_f32 v52, v46, v47
  v_lshlrev_b32 v46, 16, v52
  v_and_b32 v47, s92, v52
  v_mul_f32 v52, v46, v51
  v_mul_f32 v53, v47, v51
  v_fma_f32 v54, -v52, v50, v46
  v_fma_f32 v55, -v53, v50, v47
  v_fmac_f32 v52, v54, v51
  v_fmac_f32 v53, v55, v51
  v_cvt_pk_bf16_f32 v31, v52, v53
  v_perm_b32 v32, v24, v24, s90
  v_perm_b32 v33, v24, v24, s91
  v_perm_b32 v34, v25, v25, s90
  v_perm_b32 v35, v25, v25, s91
  v_perm_b32 v36, v26, v26, s90
  v_perm_b32 v37, v26, v26, s91
  v_perm_b32 v38, v27, v27, s90
  v_perm_b32 v39, v27, v27, s91
  v_perm_b32 v40, v28, v28, s90
  v_perm_b32 v41, v28, v28, s91
  v_perm_b32 v42, v29, v29, s90
  v_perm_b32 v43, v29, v29, s91
  v_perm_b32 v44, v30, v30, s90
  v_perm_b32 v45, v30, v30, s91
  v_perm_b32 v46, v31, v31, s90
  v_perm_b32 v47, v31, v31, s91
  ds_write_b128 v18, v[32:35] offset:4096
  ds_write_b128 v18, v[36:39] offset:4112
  ds_write_b128 v18, v[40:43] offset:6144
  ds_write_b128 v18, v[44:47] offset:6160
  s_lshl_b32 s72, s68, 10
  s_lshl_b32 s73, s78, 8
  s_add_u32 s72, s72, s73
  s_add_u32 s72, s72, 81920
  v_add_u32 v18, s72, v21
  s_waitcnt lgkmcnt(0)
  s_mov_b64 exec, 1
  v_mov_b32 v19, 1
  ds_add_u32 v7, v19 offset:31040
  s_mov_b64 exec, -1
  s_add_u32 s79, s79, 4
L_lspin_14:
  ds_read_b32 v19, v7 offset:31040
  s_waitcnt lgkmcnt(0)
  v_readfirstlane_b32 s72, v19
  s_nop 0
  s_cmp_ge_u32 s72, s79
  s_cbranch_scc1 L_lspin_14_ok
  s_branch L_lspin_14
L_lspin_14_ok:
  v_mov_b32 v48, 0
  v_mov_b32 v49, 0
  v_mov_b32 v50, 0
  v_mov_b32 v51, 0
  v_mov_b32 v52, 0
  v_mov_b32 v53, 0
  v_mov_b32 v54, 0
  v_mov_b32 v55, 0
  v_mov_b32 v56, 0
  v_mov_b32 v57, 0
  v_mov_b32 v58, 0
  v_mov_b32 v59, 0
  v_mov_b32 v60, 0
  v_mov_b32 v61, 0
  v_mov_b32 v62, 0
  v_mov_b32 v63, 0
  ds_read_b128 v[32:35], v18 offset:0
  s_waitcnt lgkmcnt(0)
  ds_read_b128 v[36:39], v18 offset:8192
  v_and_b32 v40, v32, v8
  v_and_b32 v41, v32, v9
  v_and_b32 v42, v32, v10
  v_and_b32 v43, v32, v11
  s_waitcnt vmcnt(15)
  s_nop 1
  v_mfma_f32_16x16x32_bf16 v[48:51], v[40:43], a[64:67], v[48:51]
  v_and_b32 v44, v33, v8
  v_and_b32 v45, v33, v9
  v_and_b32 v46, v33, v10
  v_and_b32 v47, v33, v11
  s_waitcnt vmcnt(14)
  s_nop 1
  v_mfma_f32_16x16x32_bf16 v[48:51], v[44:47], a[68:71], v[48:51]
  v_and_b32 v40, v34, v8
  v_and_b32 v41, v34, v9
  v_and_b32 v42, v34, v10
  v_and_b32 v43, v34, v11
  s_waitcnt vmcnt(13)
  s_nop 1
  v_mfma_f32_16x16x32_bf16 v[48:51], v[40:43], a[72:75], v[48:51]
  v_and_b32 v44, v35, v8
  v_and_b32 v45, v35, v9
  v_and_b32 v46, v35, v10
  v_and_b32 v47, v35, v11
  s_waitcnt vmcnt(12)
  s_nop 1
  v_mfma_f32_16x16x32_bf16 v[48:51], v[44:47], a[76:79], v[48:51]
  s_waitcnt lgkmcnt(0)
  ds_read_b128 v[32:35], v18 offset:16384
  v_and_b32 v40, v36, v8
  v_and_b32 v41, v36, v9
  v_and_b32 v42, v36, v10
  v_and_b32 v43, v36, v11
  s_nop 1
  v_mfma_f32_16x16x32_bf16 v[52:55], v[40:43], a[64:67], v[52:55]
  v_and_b32 v44, v37, v8
  v_and_b32 v45, v37, v9
  v_and_b32 v46, v37, v10
  v_and_b32 v47, v37, v11
  s_nop 1
  v_mfma_f32_16x16x32_bf16 v[52:55], v[44:47], a[68:71], v[52:55]
  v_and_b32 v40, v38, v8
  v_and_b32 v41, v38, v9
  v_and_b32 v42, v38, v10
  v_and_b32 v43, v38, v11
  s_nop 1
  v_mfma_f32_16x16x32_bf16 v[52:55], v[40:43], a[72:75], v[52:55]
  v_and_b32 v44, v39, v8
  v_and_b32 v45, v39, v9
  v_and_b32 v46, v39, v10
  v_and_b32 v47, v39, v11
  s_nop 1
  v_mfma_f32_16x16x32_bf16 v[52:55], v[44:47], a[76:79], v[52:55]
  s_waitcnt lgkmcnt(0)
  ds_read_b128 v[36:39], v18 offset:24576
  v_and_b32 v40, v32, v8
  v_and_b32 v41, v32, v9
  v_and_b32 v42, v32, v10
  v_and_b32 v43, v32, v11
  s_nop 1
  v_mfma_f32_16x16x32_bf16 v[56:59], v[40:43], a[64:67], v[56:59]
  v_and_b32 v44, v33, v8
  v_and_b32 v45, v33, v9
  v_and_b32 v46, v33, v10
  v_and_b32 v47, v33, v11
  s_nop 1
  v_mfma_f32_16x16x32_bf16 v[56:59], v[44:47], a[68:71], v[56:59]
  v_and_b32 v40, v34, v8
  v_and_b32 v41, v34, v9
  v_and_b32 v42, v34, v10
  v_and_b32 v43, v34, v11
  s_nop 1
  v_mfma_f32_16x16x32_bf16 v[56:59], v[40:43], a[72:75], v[56:59]
  v_and_b32 v44, v35, v8
  v_and_b32 v45, v35, v9
  v_and_b32 v46, v35, v10
  v_and_b32 v47, v35, v11
  s_nop 1
  v_mfma_f32_16x16x32_bf16 v[56:59], v[44:47], a[76:79], v[56:59]
  s_waitcnt lgkmcnt(0)
  ds_read_b128 v[32:35], v18 offset:64
  v_and_b32 v40, v36, v8
  v_and_b32 v41, v36, v9
  v_and_b32 v42, v36, v10
  v_and_b32 v43, v36, v11
  s_nop 1
  v_mfma_f32_16x16x32_bf16 v[60:63], v[40:43], a[64:67], v[60:63]
  v_and_b32 v44, v37, v8
  v_and_b32 v45, v37, v9
  v_and_b32 v46, v37, v10
  v_and_b32 v47, v37, v11
  s_nop 1
  v_mfma_f32_16x16x32_bf16 v[60:63], v[44:47], a[68:71], v[60:63]
  v_and_b32 v40, v38, v8
  v_and_b32 v41, v38, v9
  v_and_b32 v42, v38, v10
  v_and_b32 v43, v38, v11
  s_nop 1
  v_mfma_f32_16x16x32_bf16 v[60:63], v[40:43], a[72:75], v[60:63]
  v_and_b32 v44, v39, v8
  v_and_b32 v45, v39, v9
  v_and_b32 v46, v39, v10
  v_and_b32 v47, v39, v11
  s_nop 1
  v_mfma_f32_16x16x32_bf16 v[60:63], v[44:47], a[76:79], v[60:63]
  s_waitcnt lgkmcnt(0)
  ds_read_b128 v[36:39], v18 offset:8256
  v_and_b32 v40, v32, v8
  v_and_b32 v41, v32, v9
  v_and_b32 v42, v32, v10
  v_and_b32 v43, v32, v11
  s_waitcnt vmcnt(11)
  s_nop 1
  v_mfma_f32_16x16x32_bf16 v[48:51], v[40:43], a[80:83], v[48:51]
  v_and_b32 v44, v33, v8
  v_and_b32 v45, v33, v9
  v_and_b32 v46, v33, v10
  v_and_b32 v47, v33, v11
  s_waitcnt vmcnt(10)
  s_nop 1
  v_mfma_f32_16x16x32_bf16 v[48:51], v[44:47], a[84:87], v[48:51]
  v_and_b32 v40, v34, v8
  v_and_b32 v41, v34, v9
  v_and_b32 v42, v34, v10
  v_and_b32 v43, v34, v11
  s_waitcnt vmcnt(9)
  s_nop 1
  v_mfma_f32_16x16x32_bf16 v[48:51], v[40:43], a[88:91], v[48:51]
  v_and_b32 v44, v35, v8
  v_and_b32 v45, v35, v9
  v_and_b32 v46, v35, v10
  v_and_b32 v47, v35, v11
  s_waitcnt vmcnt(8)
  s_nop 1
  v_mfma_f32_16x16x32_bf16 v[48:51], v[44:47], a[92:95], v[48:51]
  s_waitcnt lgkmcnt(0)
  ds_read_b128 v[32:35], v18 offset:16448
  v_and_b32 v40, v36, v8
  v_and_b32 v41, v36, v9
  v_and_b32 v42, v36, v10
  v_and_b32 v43, v36, v11
  s_nop 1
  v_mfma_f32_16x16x32_bf16 v[52:55], v[40:43], a[80:83], v[52:55]
  v_and_b32 v44, v37, v8
  v_and_b32 v45, v37, v9
  v_and_b32 v46, v37, v10
  v_and_b32 v47, v37, v11
  s_nop 1
  v_mfma_f32_16x16x32_bf16 v[52:55], v[44:47], a[84:87], v[52:55]
  v_and_b32 v40, v38, v8
  v_and_b32 v41, v38, v9
  v_and_b32 v42, v38, v10
  v_and_b32 v43, v38, v11
  s_nop 1
  v_mfma_f32_16x16x32_bf16 v[52:55], v[40:43], a[88:91], v[52:55]
  v_and_b32 v44, v39, v8
  v_and_b32 v45, v39, v9
  v_and_b32 v46, v39, v10
  v_and_b32 v47, v39, v11
  s_nop 1
  v_mfma_f32_16x16x32_bf16 v[52:55], v[44:47], a[92:95], v[52:55]
  s_waitcnt lgkmcnt(0)
  ds_read_b128 v[36:39], v18 offset:24640
  v_and_b32 v40, v32, v8
  v_and_b32 v41, v32, v9
  v_and_b32 v42, v32, v10
  v_and_b32 v43, v32, v11
  s_nop 1
  v_mfma_f32_16x16x32_bf16 v[56:59], v[40:43], a[80:83], v[56:59]
  v_and_b32 v44, v33, v8
  v_and_b32 v45, v33, v9
  v_and_b32 v46, v33, v10
  v_and_b32 v47, v33, v11
  s_nop 1
  v_mfma_f32_16x16x32_bf16 v[56:59], v[44:47], a[84:87], v[56:59]
  v_and_b32 v40, v34, v8
  v_and_b32 v41, v34, v9
  v_and_b32 v42, v34, v10
  v_and_b32 v43, v34, v11
  s_nop 1
  v_mfma_f32_16x16x32_bf16 v[56:59], v[40:43], a[88:91], v[56:59]
  v_and_b32 v44, v35, v8
  v_and_b32 v45, v35, v9
  v_and_b32 v46, v35, v10
  v_and_b32 v47, v35, v11
  s_nop 1
  v_mfma_f32_16x16x32_bf16 v[56:59], v[44:47], a[92:95], v[56:59]
  s_waitcnt lgkmcnt(0)
  ds_read_b128 v[32:35], v18 offset:128
  v_and_b32 v40, v36, v8
  v_and_b32 v41, v36, v9
  v_and_b32 v42, v36, v10
  v_and_b32 v43, v36, v11
  s_nop 1
  v_mfma_f32_16x16x32_bf16 v[60:63], v[40:43], a[80:83], v[60:63]
  v_and_b32 v44, v37, v8
  v_and_b32 v45, v37, v9
  v_and_b32 v46, v37, v10
  v_and_b32 v47, v37, v11
  s_nop 1
  v_mfma_f32_16x16x32_bf16 v[60:63], v[44:47], a[84:87], v[60:63]
  v_and_b32 v40, v38, v8
  v_and_b32 v41, v38, v9
  v_and_b32 v42, v38, v10
  v_and_b32 v43, v38, v11
  s_nop 1
  v_mfma_f32_16x16x32_bf16 v[60:63], v[40:43], a[88:91], v[60:63]
  v_and_b32 v44, v39, v8
  v_and_b32 v45, v39, v9
  v_and_b32 v46, v39, v10
  v_and_b32 v47, v39, v11
  s_nop 1
  v_mfma_f32_16x16x32_bf16 v[60:63], v[44:47], a[92:95], v[60:63]
  s_waitcnt lgkmcnt(0)
  ds_read_b128 v[36:39], v18 offset:8320
  v_and_b32 v40, v32, v8
  v_and_b32 v41, v32, v9
  v_and_b32 v42, v32, v10
  v_and_b32 v43, v32, v11
  s_waitcnt vmcnt(7)
  s_nop 1
  v_mfma_f32_16x16x32_bf16 v[48:51], v[40:43], a[96:99], v[48:51]
  v_and_b32 v44, v33, v8
  v_and_b32 v45, v33, v9
  v_and_b32 v46, v33, v10
  v_and_b32 v47, v33, v11
  s_waitcnt vmcnt(6)
  s_nop 1
  v_mfma_f32_16x16x32_bf16 v[48:51], v[44:47], a[100:103], v[48:51]
  v_and_b32 v40, v34, v8
  v_and_b32 v41, v34, v9
  v_and_b32 v42, v34, v10
  v_and_b32 v43, v34, v11
  s_waitcnt vmcnt(5)
  s_nop 1
  v_mfma_f32_16x16x32_bf16 v[48:51], v[40:43], a[104:107], v[48:51]
  v_and_b32 v44, v35, v8
  v_and_b32 v45, v35, v9
  v_and_b32 v46, v35, v10
  v_and_b32 v47, v35, v11
  s_waitcnt vmcnt(4)
  s_nop 1
  v_mfma_f32_16x16x32_bf16 v[48:51], v[44:47], a[108:111], v[48:51]
  s_waitcnt lgkmcnt(0)
  ds_read_b128 v[32:35], v18 offset:16512
  v_and_b32 v40, v36, v8
  v_and_b32 v41, v36, v9
  v_and_b32 v42, v36, v10
  v_and_b32 v43, v36, v11
  s_nop 1
  v_mfma_f32_16x16x32_bf16 v[52:55], v[40:43], a[96:99], v[52:55]
  v_and_b32 v44, v37, v8
  v_and_b32 v45, v37, v9
  v_and_b32 v46, v37, v10
  v_and_b32 v47, v37, v11
  s_nop 1
  v_mfma_f32_16x16x32_bf16 v[52:55], v[44:47], a[100:103], v[52:55]
  v_and_b32 v40, v38, v8
  v_and_b32 v41, v38, v9
  v_and_b32 v42, v38, v10
  v_and_b32 v43, v38, v11
  s_nop 1
  v_mfma_f32_16x16x32_bf16 v[52:55], v[40:43], a[104:107], v[52:55]
  v_and_b32 v44, v39, v8
  v_and_b32 v45, v39, v9
  v_and_b32 v46, v39, v10
  v_and_b32 v47, v39, v11
  s_nop 1
  v_mfma_f32_16x16x32_bf16 v[52:55], v[44:47], a[108:111], v[52:55]
  s_waitcnt lgkmcnt(0)
  ds_read_b128 v[36:39], v18 offset:24704
  v_and_b32 v40, v32, v8
  v_and_b32 v41, v32, v9
  v_and_b32 v42, v32, v10
  v_and_b32 v43, v32, v11
  s_nop 1
  v_mfma_f32_16x16x32_bf16 v[56:59], v[40:43], a[96:99], v[56:59]
  v_and_b32 v44, v33, v8
  v_and_b32 v45, v33, v9
  v_and_b32 v46, v33, v10
  v_and_b32 v47, v33, v11
  s_nop 1
  v_mfma_f32_16x16x32_bf16 v[56:59], v[44:47], a[100:103], v[56:59]
  v_and_b32 v40, v34, v8
  v_and_b32 v41, v34, v9
  v_and_b32 v42, v34, v10
  v_and_b32 v43, v34, v11
  s_nop 1
  v_mfma_f32_16x16x32_bf16 v[56:59], v[40:43], a[104:107], v[56:59]
  v_and_b32 v44, v35, v8
  v_and_b32 v45, v35, v9
  v_and_b32 v46, v35, v10
  v_and_b32 v47, v35, v11
  s_nop 1
  v_mfma_f32_16x16x32_bf16 v[56:59], v[44:47], a[108:111], v[56:59]
  s_waitcnt lgkmcnt(0)
  ds_read_b128 v[32:35], v18 offset:192
  v_and_b32 v40, v36, v8
  v_and_b32 v41, v36, v9
  v_and_b32 v42, v36, v10
  v_and_b32 v43, v36, v11
  s_nop 1
  v_mfma_f32_16x16x32_bf16 v[60:63], v[40:43], a[96:99], v[60:63]
  v_and_b32 v44, v37, v8
  v_and_b32 v45, v37, v9
  v_and_b32 v46, v37, v10
  v_and_b32 v47, v37, v11
  s_nop 1
  v_mfma_f32_16x16x32_bf16 v[60:63], v[44:47], a[100:103], v[60:63]
  v_and_b32 v40, v38, v8
  v_and_b32 v41, v38, v9
  v_and_b32 v42, v38, v10
  v_and_b32 v43, v38, v11
  s_nop 1
  v_mfma_f32_16x16x32_bf16 v[60:63], v[40:43], a[104:107], v[60:63]
  v_and_b32 v44, v39, v8
  v_and_b32 v45, v39, v9
  v_and_b32 v46, v39, v10
  v_and_b32 v47, v39, v11
  s_nop 1
  v_mfma_f32_16x16x32_bf16 v[60:63], v[44:47], a[108:111], v[60:63]
  s_waitcnt lgkmcnt(0)
  ds_read_b128 v[36:39], v18 offset:8384
  v_and_b32 v40, v32, v8
  v_and_b32 v41, v32, v9
  v_and_b32 v42, v32, v10
  v_and_b32 v43, v32, v11
  s_waitcnt vmcnt(3)
  s_nop 1
  v_mfma_f32_16x16x32_bf16 v[48:51], v[40:43], a[112:115], v[48:51]
  v_and_b32 v44, v33, v8
  v_and_b32 v45, v33, v9
  v_and_b32 v46, v33, v10
  v_and_b32 v47, v33, v11
  s_waitcnt vmcnt(2)
  s_nop 1
  v_mfma_f32_16x16x32_bf16 v[48:51], v[44:47], a[116:119], v[48:51]
  v_and_b32 v40, v34, v8
  v_and_b32 v41, v34, v9
  v_and_b32 v42, v34, v10
  v_and_b32 v43, v34, v11
  s_waitcnt vmcnt(1)
  s_nop 1
  v_mfma_f32_16x16x32_bf16 v[48:51], v[40:43], a[120:123], v[48:51]
  v_and_b32 v44, v35, v8
  v_and_b32 v45, v35, v9
  v_and_b32 v46, v35, v10
  v_and_b32 v47, v35, v11
  s_waitcnt vmcnt(0)
  s_nop 1
  v_mfma_f32_16x16x32_bf16 v[48:51], v[44:47], a[124:127], v[48:51]
  s_waitcnt lgkmcnt(0)
  ds_read_b128 v[32:35], v18 offset:16576
  v_and_b32 v40, v36, v8
  v_and_b32 v41, v36, v9
  v_and_b32 v42, v36, v10
  v_and_b32 v43, v36, v11
  s_nop 1
  v_mfma_f32_16x16x32_bf16 v[52:55], v[40:43], a[112:115], v[52:55]
  v_and_b32 v44, v37, v8
  v_and_b32 v45, v37, v9
  v_and_b32 v46, v37, v10
  v_and_b32 v47, v37, v11
  s_nop 1
  v_mfma_f32_16x16x32_bf16 v[52:55], v[44:47], a[116:119], v[52:55]
  v_and_b32 v40, v38, v8
  v_and_b32 v41, v38, v9
  v_and_b32 v42, v38, v10
  v_and_b32 v43, v38, v11
  s_nop 1
  v_mfma_f32_16x16x32_bf16 v[52:55], v[40:43], a[120:123], v[52:55]
  v_and_b32 v44, v39, v8
  v_and_b32 v45, v39, v9
  v_and_b32 v46, v39, v10
  v_and_b32 v47, v39, v11
  s_nop 1
  v_mfma_f32_16x16x32_bf16 v[52:55], v[44:47], a[124:127], v[52:55]
  s_waitcnt lgkmcnt(0)
  ds_read_b128 v[36:39], v18 offset:24768
  v_and_b32 v40, v32, v8
  v_and_b32 v41, v32, v9
  v_and_b32 v42, v32, v10
  v_and_b32 v43, v32, v11
  s_nop 1
  v_mfma_f32_16x16x32_bf16 v[56:59], v[40:43], a[112:115], v[56:59]
  v_and_b32 v44, v33, v8
  v_and_b32 v45, v33, v9
  v_and_b32 v46, v33, v10
  v_and_b32 v47, v33, v11
  s_nop 1
  v_mfma_f32_16x16x32_bf16 v[56:59], v[44:47], a[116:119], v[56:59]
  v_and_b32 v40, v34, v8
  v_and_b32 v41, v34, v9
  v_and_b32 v42, v34, v10
  v_and_b32 v43, v34, v11
  s_nop 1
  v_mfma_f32_16x16x32_bf16 v[56:59], v[40:43], a[120:123], v[56:59]
  v_and_b32 v44, v35, v8
  v_and_b32 v45, v35, v9
  v_and_b32 v46, v35, v10
  v_and_b32 v47, v35, v11
  s_nop 1
  v_mfma_f32_16x16x32_bf16 v[56:59], v[44:47], a[124:127], v[56:59]
  s_waitcnt lgkmcnt(0)
  v_and_b32 v40, v36, v8
  v_and_b32 v41, v36, v9
  v_and_b32 v42, v36, v10
  v_and_b32 v43, v36, v11
  s_nop 1
  v_mfma_f32_16x16x32_bf16 v[60:63], v[40:43], a[112:115], v[60:63]
  v_and_b32 v44, v37, v8
  v_and_b32 v45, v37, v9
  v_and_b32 v46, v37, v10
  v_and_b32 v47, v37, v11
  s_nop 1
  v_mfma_f32_16x16x32_bf16 v[60:63], v[44:47], a[116:119], v[60:63]
  v_and_b32 v40, v38, v8
  v_and_b32 v41, v38, v9
  v_and_b32 v42, v38, v10
  v_and_b32 v43, v38, v11
  s_nop 1
  v_mfma_f32_16x16x32_bf16 v[60:63], v[40:43], a[120:123], v[60:63]
  v_and_b32 v44, v39, v8
  v_and_b32 v45, v39, v9
  v_and_b32 v46, v39, v10
  v_and_b32 v47, v39, v11
  s_nop 1
  v_mfma_f32_16x16x32_bf16 v[60:63], v[44:47], a[124:127], v[60:63]
  s_nop 9
  ds_write_b128 v22, v[48:51] offset:32768
  ds_write_b128 v22, v[52:55] offset:33792
  ds_write_b128 v22, v[56:59] offset:34816
  ds_write_b128 v22, v[60:63] offset:35840
  s_waitcnt lgkmcnt(0)
  s_mov_b64 exec, 1
  v_mov_b32 v19, 1
  ds_add_u32 v7, v19 offset:31040
  s_mov_b64 exec, -1
  s_add_u32 s79, s79, 4
L_lspin_15:
  ds_read_b32 v19, v7 offset:31040
  s_waitcnt lgkmcnt(0)
  v_readfirstlane_b32 s72, v19
  s_nop 0
  s_cmp_ge_u32 s72, s79
  s_cbranch_scc1 L_lspin_15_ok
  s_branch L_lspin_15
L_lspin_15_ok:
  ds_read_b128 v[48:51], v23 offset:32768
  ds_read_b128 v[52:55], v23 offset:36864
  ds_read_b128 v[56:59], v23 offset:40960
  ds_read_b128 v[60:63], v23 offset:45056
  s_waitcnt lgkmcnt(0)
  v_add_f32 v48, v48, v52
  v_add_f32 v56, v56, v60
  v_add_f32 v49, v49, v53
  v_add_f32 v57, v57, v61
  v_add_f32 v50, v50, v54
  v_add_f32 v58, v58, v62
  v_add_f32 v51, v51, v55
  v_add_f32 v59, v59, v63
  v_add_f32 v48, v48, v56
  v_add_f32 v49, v49, v57
  v_add_f32 v50, v50, v58
  v_add_f32 v51, v51, v59
  s_lshl_b32 s71, s69, 2
  s_add_u32 s71, s71, s68
  s_lshl_b32 s71, s71, 12
  s_add_u32 s71, s71, 0
  v_mov_b32 v14, v23
  buffer_store_dwordx4 v[48:51], v14, s[48:51], s71 offen sc1
  s_waitcnt vmcnt(0)
  s_waitcnt lgkmcnt(0)
  s_mov_b64 exec, 1
  v_mov_b32 v19, 1
  ds_add_u32 v7, v19 offset:31040
  s_mov_b64 exec, -1
  s_add_u32 s79, s79, 4
L_lspin_16:
  ds_read_b32 v19, v7 offset:31040
  s_waitcnt lgkmcnt(0)
  v_readfirstlane_b32 s72, v19
  s_nop 0
  s_cmp_ge_u32 s72, s79
  s_cbranch_scc1 L_lspin_16_ok
  s_branch L_lspin_16
L_lspin_16_ok:
  s_cmp_eq_u32 s78, 0
  s_cbranch_scc0 L_sig_17
  s_lshl_b32 s72, s69, 5
  s_lshl_b32 s73, s68, 3
  s_add_u32 s72, s72, s73
  s_add_u32 s72, s72, 3153920
  v_mov_b32 v18, s76
  v_mov_b32 v19, s77
  s_mov_b64 exec, 1
  buffer_store_dwordx2 v[18:19], v7, s[48:51], s72 offen sc1
  s_mov_b64 exec, -1
L_sig_17:
  s_branch L_job_done
L_not_a:
  s_cmp_eq_u32 s67, 2
  s_cbranch_scc0 L_job_n
  s_lshl_b32 s72, s68, 2
  s_add_u32 s72, s72, s78
  s_lshl_b32 s72, s72, 17
  s_lshl_b32 s73, s69, 8
  s_add_u32 s72, s72, s73
  s_add_u32 s40, s20, s72
  s_addc_u32 s41, s21, 0
  s_sub_u32 s42, 7340032, s72
  s_mov_b32 s71, 0
  buffer_load_dwordx4 a[64:67], v13, s[40:43], s71 offen nt
  s_mov_b32 s71, 2048
  buffer_load_dwordx4 a[68:71], v13, s[40:43], s71 offen nt
  s_mov_b32 s71, 4096
  buffer_load_dwordx4 a[72:75], v13, s[40:43], s71 offen nt
  s_mov_b32 s71, 6144
  buffer_load_dwordx4 a[76:79], v13, s[40:43], s71 offen nt
  s_mov_b32 s71, 32768
  buffer_load_dwordx4 a[80:83], v13, s[40:43], s71 offen nt
  s_mov_b32 s71, 34816
  buffer_load_dwordx4 a[84:87], v13, s[40:43], s71 offen nt
  s_mov_b32 s71, 36864
  buffer_load_dwordx4 a[88:91], v13, s[40:43], s71 offen nt
  s_mov_b32 s71, 38912
  buffer_load_dwordx4 a[92:95], v13, s[40:43], s71 offen nt
  s_mov_b32 s71, 65536
  buffer_load_dwordx4 a[96:99], v13, s[40:43], s71 offen nt
  s_mov_b32 s71, 67584
  buffer_load_dwordx4 a[100:103], v13, s[40:43], s71 offen nt
  s_mov_b32 s71, 69632
  buffer_load_dwordx4 a[104:107], v13, s[40:43], s71 offen nt
  s_mov_b32 s71, 71680
  buffer_load_dwordx4 a[108:111], v13, s[40:43], s71 offen nt
  s_mov_b32 s71, 98304
  buffer_load_dwordx4 a[112:115], v13, s[40:43], s71 offen nt
  s_mov_b32 s71, 100352
  buffer_load_dwordx4 a[116:119], v13, s[40:43], s71 offen nt
  s_mov_b32 s71, 102400
  buffer_load_dwordx4 a[120:123], v13, s[40:43], s71 offen nt
  s_mov_b32 s71, 104448
  buffer_load_dwordx4 a[124:127], v13, s[40:43], s71 offen nt
  s_mov_b32 s56, s18
  s_mov_b32 s57, s19
  s_mov_b32 s58, 7168
  s_mov_b32 s59, 0x00020000
  s_lshl_b32 s71, s68, 9
  buffer_load_dwordx2 v[24:25], v6, s[56:59], s71 offen
  s_cmp_eq_u32 s78, 0
  s_cbranch_scc0 L_bw_18
  v_and_b32 v14, 7, v1
  v_lshlrev_b32 v14, 3, v14
  s_lshl_b32 s74, s68, 6
  s_add_u32 s74, s74, 3153920
  s_mov_b32 s75, 0
L_spin_20:
  buffer_load_dwordx2 v[16:17], v14, s[48:51], s74 offen sc1
  s_waitcnt vmcnt(0)
  v_cmp_ne_u64 vcc, s[76:77], v[16:17]
  s_add_u32 s75, s75, 1
  s_cmp_ge_u32 s75, 0x4000
  s_cbranch_scc1 L_ok_19
  s_nop 1
  s_cbranch_vccz L_ok_19
  s_sleep 64
  s_branch L_spin_20
L_ok_19:
L_bw_18:
  s_waitcnt lgkmcnt(0)
  s_mov_b64 exec, 1
  v_mov_b32 v19, 1
  ds_add_u32 v7, v19 offset:31040
  s_mov_b64 exec, -1
  s_add_u32 s79, s79, 4
L_lspin_21:
  ds_read_b32 v19, v7 offset:31040
  s_waitcnt lgkmcnt(0)
  v_readfirstlane_b32 s72, v19
  s_nop 0
  s_cmp_ge_u32 s72, s79
  s_cbranch_scc1 L_lspin_21_ok
  s_branch L_lspin_21
L_lspin_21_ok:
  v_lshrrev_b32 v16, 5, v1
  v_and_b32 v17, 31, v1
  v_lshlrev_b32 v17, 4, v17
  v_lshl_add_u32 v17, v16, 14, v17
  s_lshl_b32 s72, s68, 15
  s_lshl_b32 s73, s78, 10
  s_add_u32 s72, s72, s73
  s_add_u32 s71, s72, 0
  buffer_load_dwordx4 v[64:67], v17, s[48:51], s71 offen sc1
  s_add_u32 s71, s72, 4096
  buffer_load_dwordx4 v[68:71], v17, s[48:51], s71 offen sc1
  s_add_u32 s71, s72, 8192
  buffer_load_dwordx4 v[72:75], v17, s[48:51], s71 offen sc1
  s_add_u32 s71, s72, 12288
  buffer_load_dwordx4 v[76:79], v17, s[48:51], s71 offen sc1
  s_add_u32 s71, s72, 512
  buffer_load_dwordx4 v[80:83], v17, s[48:51], s71 offen sc1
  s_add_u32 s71, s72, 4608
  buffer_load_dwordx4 v[84:87], v17, s[48:51], s71 offen sc1
  s_add_u32 s71, s72, 8704
  buffer_load_dwordx4 v[88:91], v17, s[48:51], s71 offen sc1
  s_add_u32 s71, s72, 12800
  buffer_load_dwordx4 v[92:95], v17, s[48:51], s71 offen sc1
  s_waitcnt vmcnt(8)
  v_lshlrev_b32 v32, 16, v24
  v_and_b32 v33, s92, v24
  v_lshlrev_b32 v34, 16, v25
  v_and_b32 v35, s92, v25
  s_lshl_b32 s72, s78, 13
  s_add_u32 s72, s72, 81920
  v_add_u32 v17, s72, v4
  v_mov_b32 v14, 0x3d372713
  s_waitcnt vmcnt(0)
  v_add_f32 v36, v64, v68
  v_add_f32 v36, v36, v72
  v_add_f32 v36, v36, v76
  v_cvt_pk_bf16_f32 v36, v36, v36
  v_lshlrev_b32 v36, 16, v36
  v_add_f32 v36, v36, v32
  v_cvt_pk_bf16_f32 v36, v36, v36
  v_lshlrev_b32 v36, 16, v36
  v_mul_f32 v44, v36, v36
  v_mul_f32 v44, v44, v36
  v_fma_f32 v44, v44, v14, v36
  v_mul_f32 v44, 0xc0135761, v44
  v_exp_f32 v44, v44
  s_nop 0
  v_add_f32 v44, 1.0, v44
  v_rcp_f32 v44, v44
  s_nop 0
  v_mul_f32 v36, v36, v44
  v_cvt_pk_bf16_f32 v36, v36, v36
  v_add_f32 v37, v65, v69
  v_add_f32 v37, v37, v73
  v_add_f32 v37, v37, v77
  v_cvt_pk_bf16_f32 v37, v37, v37
  v_lshlrev_b32 v37, 16, v37
  v_add_f32 v37, v37, v33
  v_cvt_pk_bf16_f32 v37, v37, v37
  v_lshlrev_b32 v37, 16, v37
  v_mul_f32 v45, v37, v37
  v_mul_f32 v45, v45, v37
  v_fma_f32 v45, v45, v14, v37
  v_mul_f32 v45, 0xc0135761, v45
  v_exp_f32 v45, v45
  s_nop 0
  v_add_f32 v45, 1.0, v45
  v_rcp_f32 v45, v45
  s_nop 0
  v_mul_f32 v37, v37, v45
  v_cvt_pk_bf16_f32 v37, v37, v37
  v_add_f32 v38, v66, v70
  v_add_f32 v38, v38, v74
  v_add_f32 v38, v38, v78
  v_cvt_pk_bf16_f32 v38, v38, v38
  v_lshlrev_b32 v38, 16, v38
  v_add_f32 v38, v38, v34
  v_cvt_pk_bf16_f32 v38, v38, v38
  v_lshlrev_b32 v38, 16, v38
  v_mul_f32 v46, v38, v38
  v_mul_f32 v46, v46, v38
  v_fma_f32 v46, v46, v14, v38
  v_mul_f32 v46, 0xc0135761, v46
  v_exp_f32 v46, v46
  s_nop 0
  v_add_f32 v46, 1.0, v46
  v_rcp_f32 v46, v46
  s_nop 0
  v_mul_f32 v38, v38, v46
  v_cvt_pk_bf16_f32 v38, v38, v38
  v_add_f32 v39, v67, v71
  v_add_f32 v39, v39, v75
  v_add_f32 v39, v39, v79
  v_cvt_pk_bf16_f32 v39, v39, v39
  v_lshlrev_b32 v39, 16, v39
  v_add_f32 v39, v39, v35
  v_cvt_pk_bf16_f32 v39, v39, v39
  v_lshlrev_b32 v39, 16, v39
  v_mul_f32 v47, v39, v39
  v_mul_f32 v47, v47, v39
  v_fma_f32 v47, v47, v14, v39
  v_mul_f32 v47, 0xc0135761, v47
  v_exp_f32 v47, v47
  s_nop 0
  v_add_f32 v47, 1.0, v47
  v_rcp_f32 v47, v47
  s_nop 0
  v_mul_f32 v39, v39, v47
  v_cvt_pk_bf16_f32 v39, v39, v39
  ds_write_b128 v17, v[36:39] offset:0
  v_add_f32 v40, v80, v84
  v_add_f32 v40, v40, v88
  v_add_f32 v40, v40, v92
  v_cvt_pk_bf16_f32 v40, v40, v40
  v_lshlrev_b32 v40, 16, v40
  v_add_f32 v40, v40, v32
  v_cvt_pk_bf16_f32 v40, v40, v40
  v_lshlrev_b32 v40, 16, v40
  v_mul_f32 v44, v40, v40
  v_mul_f32 v44, v44, v40
  v_fma_f32 v44, v44, v14, v40
  v_mul_f32 v44, 0xc0135761, v44
  v_exp_f32 v44, v44
  s_nop 0
  v_add_f32 v44, 1.0, v44
  v_rcp_f32 v44, v44
  s_nop 0
  v_mul_f32 v40, v40, v44
  v_cvt_pk_bf16_f32 v40, v40, v40
  v_add_f32 v41, v81, v85
  v_add_f32 v41, v41, v89
  v_add_f32 v41, v41, v93
  v_cvt_pk_bf16_f32 v41, v41, v41
  v_lshlrev_b32 v41, 16, v41
  v_add_f32 v41, v41, v33
  v_cvt_pk_bf16_f32 v41, v41, v41
  v_lshlrev_b32 v41, 16, v41
  v_mul_f32 v45, v41, v41
  v_mul_f32 v45, v45, v41
  v_fma_f32 v45, v45, v14, v41
  v_mul_f32 v45, 0xc0135761, v45
  v_exp_f32 v45, v45
  s_nop 0
  v_add_f32 v45, 1.0, v45
  v_rcp_f32 v45, v45
  s_nop 0
  v_mul_f32 v41, v41, v45
  v_cvt_pk_bf16_f32 v41, v41, v41
  v_add_f32 v42, v82, v86
  v_add_f32 v42, v42, v90
  v_add_f32 v42, v42, v94
  v_cvt_pk_bf16_f32 v42, v42, v42
  v_lshlrev_b32 v42, 16, v42
  v_add_f32 v42, v42, v34
  v_cvt_pk_bf16_f32 v42, v42, v42
  v_lshlrev_b32 v42, 16, v42
  v_mul_f32 v46, v42, v42
  v_mul_f32 v46, v46, v42
  v_fma_f32 v46, v46, v14, v42
  v_mul_f32 v46, 0xc0135761, v46
  v_exp_f32 v46, v46
  s_nop 0
  v_add_f32 v46, 1.0, v46
  v_rcp_f32 v46, v46
  s_nop 0
  v_mul_f32 v42, v42, v46
  v_cvt_pk_bf16_f32 v42, v42, v42
  v_add_f32 v43, v83, v87
  v_add_f32 v43, v43, v91
  v_add_f32 v43, v43, v95
  v_cvt_pk_bf16_f32 v43, v43, v43
  v_lshlrev_b32 v43, 16, v43
  v_add_f32 v43, v43, v35
  v_cvt_pk_bf16_f32 v43, v43, v43
  v_lshlrev_b32 v43, 16, v43
  v_mul_f32 v47, v43, v43
  v_mul_f32 v47, v47, v43
  v_fma_f32 v47, v47, v14, v43
  v_mul_f32 v47, 0xc0135761, v47
  v_exp_f32 v47, v47
  s_nop 0
  v_add_f32 v47, 1.0, v47
  v_rcp_f32 v47, v47
  s_nop 0
  v_mul_f32 v43, v43, v47
  v_cvt_pk_bf16_f32 v43, v43, v43
  ds_write_b128 v17, v[40:43] offset:4096
  s_lshl_b32 s73, s78, 8
  s_add_u32 s72, s73, 81920
  v_add_u32 v18, s72, v21
  s_waitcnt lgkmcnt(0)
  s_mov_b64 exec, 1
  v_mov_b32 v19, 1
  ds_add_u32 v7, v19 offset:31040
  s_mov_b64 exec, -1
  s_add_u32 s79, s79, 4
L_lspin_22:
  ds_read_b32 v19, v7 offset:31040
  s_waitcnt lgkmcnt(0)
  v_readfirstlane_b32 s72, v19
  s_nop 0
  s_cmp_ge_u32 s72, s79
  s_cbranch_scc1 L_lspin_22_ok
  s_branch L_lspin_22
L_lspin_22_ok:
  v_mov_b32 v48, 0
  v_mov_b32 v49, 0
  v_mov_b32 v50, 0
  v_mov_b32 v51, 0
  v_mov_b32 v52, 0
  v_mov_b32 v53, 0
  v_mov_b32 v54, 0
  v_mov_b32 v55, 0
  v_mov_b32 v56, 0
  v_mov_b32 v57, 0
  v_mov_b32 v58, 0
  v_mov_b32 v59, 0
  v_mov_b32 v60, 0
  v_mov_b32 v61, 0
  v_mov_b32 v62, 0
  v_mov_b32 v63, 0
  ds_read_b128 v[32:35], v18 offset:0
  s_waitcnt lgkmcnt(0)
  ds_read_b128 v[36:39], v18 offset:8192
  v_and_b32 v40, v32, v8
  v_and_b32 v41, v32, v9
  v_and_b32 v42, v32, v10
  v_and_b32 v43, v32, v11
  s_nop 1
  v_mfma_f32_16x16x32_bf16 v[48:51], v[40:43], a[64:67], v[48:51]
  v_and_b32 v44, v33, v8
  v_and_b32 v45, v33, v9
  v_and_b32 v46, v33, v10
  v_and_b32 v47, v33, v11
  s_nop 1
  v_mfma_f32_16x16x32_bf16 v[48:51], v[44:47], a[68:71], v[48:51]
  v_and_b32 v40, v34, v8
  v_and_b32 v41, v34, v9
  v_and_b32 v42, v34, v10
  v_and_b32 v43, v34, v11
  s_nop 1
  v_mfma_f32_16x16x32_bf16 v[48:51], v[40:43], a[72:75], v[48:51]
  v_and_b32 v44, v35, v8
  v_and_b32 v45, v35, v9
  v_and_b32 v46, v35, v10
  v_and_b32 v47, v35, v11
  s_nop 1
  v_mfma_f32_16x16x32_bf16 v[48:51], v[44:47], a[76:79], v[48:51]
  s_waitcnt lgkmcnt(0)
  ds_read_b128 v[32:35], v18 offset:16384
  v_and_b32 v40, v36, v8
  v_and_b32 v41, v36, v9
  v_and_b32 v42, v36, v10
  v_and_b32 v43, v36, v11
  s_nop 1
  v_mfma_f32_16x16x32_bf16 v[52:55], v[40:43], a[64:67], v[52:55]
  v_and_b32 v44, v37, v8
  v_and_b32 v45, v37, v9
  v_and_b32 v46, v37, v10
  v_and_b32 v47, v37, v11
  s_nop 1
  v_mfma_f32_16x16x32_bf16 v[52:55], v[44:47], a[68:71], v[52:55]
  v_and_b32 v40, v38, v8
  v_and_b32 v41, v38, v9
  v_and_b32 v42, v38, v10
  v_and_b32 v43, v38, v11
  s_nop 1
  v_mfma_f32_16x16x32_bf16 v[52:55], v[40:43], a[72:75], v[52:55]
  v_and_b32 v44, v39, v8
  v_and_b32 v45, v39, v9
  v_and_b32 v46, v39, v10
  v_and_b32 v47, v39, v11
  s_nop 1
  v_mfma_f32_16x16x32_bf16 v[52:55], v[44:47], a[76:79], v[52:55]
  s_waitcnt lgkmcnt(0)
  ds_read_b128 v[36:39], v18 offset:24576
  v_and_b32 v40, v32, v8
  v_and_b32 v41, v32, v9
  v_and_b32 v42, v32, v10
  v_and_b32 v43, v32, v11
  s_nop 1
  v_mfma_f32_16x16x32_bf16 v[56:59], v[40:43], a[64:67], v[56:59]
  v_and_b32 v44, v33, v8
  v_and_b32 v45, v33, v9
  v_and_b32 v46, v33, v10
  v_and_b32 v47, v33, v11
  s_nop 1
  v_mfma_f32_16x16x32_bf16 v[56:59], v[44:47], a[68:71], v[56:59]
  v_and_b32 v40, v34, v8
  v_and_b32 v41, v34, v9
  v_and_b32 v42, v34, v10
  v_and_b32 v43, v34, v11
  s_nop 1
  v_mfma_f32_16x16x32_bf16 v[56:59], v[40:43], a[72:75], v[56:59]
  v_and_b32 v44, v35, v8
  v_and_b32 v45, v35, v9
  v_and_b32 v46, v35, v10
  v_and_b32 v47, v35, v11
  s_nop 1
  v_mfma_f32_16x16x32_bf16 v[56:59], v[44:47], a[76:79], v[56:59]
  s_waitcnt lgkmcnt(0)
  ds_read_b128 v[32:35], v18 offset:64
  v_and_b32 v40, v36, v8
  v_and_b32 v41, v36, v9
  v_and_b32 v42, v36, v10
  v_and_b32 v43, v36, v11
  s_nop 1
  v_mfma_f32_16x16x32_bf16 v[60:63], v[40:43], a[64:67], v[60:63]
  v_and_b32 v44, v37, v8
  v_and_b32 v45, v37, v9
  v_and_b32 v46, v37, v10
  v_and_b32 v47, v37, v11
  s_nop 1
  v_mfma_f32_16x16x32_bf16 v[60:63], v[44:47], a[68:71], v[60:63]
  v_and_b32 v40, v38, v8
  v_and_b32 v41, v38, v9
  v_and_b32 v42, v38, v10
  v_and_b32 v43, v38, v11
  s_nop 1
  v_mfma_f32_16x16x32_bf16 v[60:63], v[40:43], a[72:75], v[60:63]
  v_and_b32 v44, v39, v8
  v_and_b32 v45, v39, v9
  v_and_b32 v46, v39, v10
  v_and_b32 v47, v39, v11
  s_nop 1
  v_mfma_f32_16x16x32_bf16 v[60:63], v[44:47], a[76:79], v[60:63]
  s_waitcnt lgkmcnt(0)
  ds_read_b128 v[36:39], v18 offset:8256
  v_and_b32 v40, v32, v8
  v_and_b32 v41, v32, v9
  v_and_b32 v42, v32, v10
  v_and_b32 v43, v32, v11
  s_nop 1
  v_mfma_f32_16x16x32_bf16 v[48:51], v[40:43], a[80:83], v[48:51]
  v_and_b32 v44, v33, v8
  v_and_b32 v45, v33, v9
  v_and_b32 v46, v33, v10
  v_and_b32 v47, v33, v11
  s_nop 1
  v_mfma_f32_16x16x32_bf16 v[48:51], v[44:47], a[84:87], v[48:51]
  v_and_b32 v40, v34, v8
  v_and_b32 v41, v34, v9
  v_and_b32 v42, v34, v10
  v_and_b32 v43, v34, v11
  s_nop 1
  v_mfma_f32_16x16x32_bf16 v[48:51], v[40:43], a[88:91], v[48:51]
  v_and_b32 v44, v35, v8
  v_and_b32 v45, v35, v9
  v_and_b32 v46, v35, v10
  v_and_b32 v47, v35, v11
  s_nop 1
  v_mfma_f32_16x16x32_bf16 v[48:51], v[44:47], a[92:95], v[48:51]
  s_waitcnt lgkmcnt(0)
  ds_read_b128 v[32:35], v18 offset:16448
  v_and_b32 v40, v36, v8
  v_and_b32 v41, v36, v9
  v_and_b32 v42, v36, v10
  v_and_b32 v43, v36, v11
  s_nop 1
  v_mfma_f32_16x16x32_bf16 v[52:55], v[40:43], a[80:83], v[52:55]
  v_and_b32 v44, v37, v8
  v_and_b32 v45, v37, v9
  v_and_b32 v46, v37, v10
  v_and_b32 v47, v37, v11
  s_nop 1
  v_mfma_f32_16x16x32_bf16 v[52:55], v[44:47], a[84:87], v[52:55]
  v_and_b32 v40, v38, v8
  v_and_b32 v41, v38, v9
  v_and_b32 v42, v38, v10
  v_and_b32 v43, v38, v11
  s_nop 1
  v_mfma_f32_16x16x32_bf16 v[52:55], v[40:43], a[88:91], v[52:55]
  v_and_b32 v44, v39, v8
  v_and_b32 v45, v39, v9
  v_and_b32 v46, v39, v10
  v_and_b32 v47, v39, v11
  s_nop 1
  v_mfma_f32_16x16x32_bf16 v[52:55], v[44:47], a[92:95], v[52:55]
  s_waitcnt lgkmcnt(0)
  ds_read_b128 v[36:39], v18 offset:24640
  v_and_b32 v40, v32, v8
  v_and_b32 v41, v32, v9
  v_and_b32 v42, v32, v10
  v_and_b32 v43, v32, v11
  s_nop 1
  v_mfma_f32_16x16x32_bf16 v[56:59], v[40:43], a[80:83], v[56:59]
  v_and_b32 v44, v33, v8
  v_and_b32 v45, v33, v9
  v_and_b32 v46, v33, v10
  v_and_b32 v47, v33, v11
  s_nop 1
  v_mfma_f32_16x16x32_bf16 v[56:59], v[44:47], a[84:87], v[56:59]
  v_and_b32 v40, v34, v8
  v_and_b32 v41, v34, v9
  v_and_b32 v42, v34, v10
  v_and_b32 v43, v34, v11
  s_nop 1
  v_mfma_f32_16x16x32_bf16 v[56:59], v[40:43], a[88:91], v[56:59]
  v_and_b32 v44, v35, v8
  v_and_b32 v45, v35, v9
  v_and_b32 v46, v35, v10
  v_and_b32 v47, v35, v11
  s_nop 1
  v_mfma_f32_16x16x32_bf16 v[56:59], v[44:47], a[92:95], v[56:59]
  s_waitcnt lgkmcnt(0)
  ds_read_b128 v[32:35], v18 offset:128
  v_and_b32 v40, v36, v8
  v_and_b32 v41, v36, v9
  v_and_b32 v42, v36, v10
  v_and_b32 v43, v36, v11
  s_nop 1
  v_mfma_f32_16x16x32_bf16 v[60:63], v[40:43], a[80:83], v[60:63]
  v_and_b32 v44, v37, v8
  v_and_b32 v45, v37, v9
  v_and_b32 v46, v37, v10
  v_and_b32 v47, v37, v11
  s_nop 1
  v_mfma_f32_16x16x32_bf16 v[60:63], v[44:47], a[84:87], v[60:63]
  v_and_b32 v40, v38, v8
  v_and_b32 v41, v38, v9
  v_and_b32 v42, v38, v10
  v_and_b32 v43, v38, v11
  s_nop 1
  v_mfma_f32_16x16x32_bf16 v[60:63], v[40:43], a[88:91], v[60:63]
  v_and_b32 v44, v39, v8
  v_and_b32 v45, v39, v9
  v_and_b32 v46, v39, v10
  v_and_b32 v47, v39, v11
  s_nop 1
  v_mfma_f32_16x16x32_bf16 v[60:63], v[44:47], a[92:95], v[60:63]
  s_waitcnt lgkmcnt(0)
  ds_read_b128 v[36:39], v18 offset:8320
  v_and_b32 v40, v32, v8
  v_and_b32 v41, v32, v9
  v_and_b32 v42, v32, v10
  v_and_b32 v43, v32, v11
  s_nop 1
  v_mfma_f32_16x16x32_bf16 v[48:51], v[40:43], a[96:99], v[48:51]
  v_and_b32 v44, v33, v8
  v_and_b32 v45, v33, v9
  v_and_b32 v46, v33, v10
  v_and_b32 v47, v33, v11
  s_nop 1
  v_mfma_f32_16x16x32_bf16 v[48:51], v[44:47], a[100:103], v[48:51]
  v_and_b32 v40, v34, v8
  v_and_b32 v41, v34, v9
  v_and_b32 v42, v34, v10
  v_and_b32 v43, v34, v11
  s_nop 1
  v_mfma_f32_16x16x32_bf16 v[48:51], v[40:43], a[104:107], v[48:51]
  v_and_b32 v44, v35, v8
  v_and_b32 v45, v35, v9
  v_and_b32 v46, v35, v10
  v_and_b32 v47, v35, v11
  s_nop 1
  v_mfma_f32_16x16x32_bf16 v[48:51], v[44:47], a[108:111], v[48:51]
  s_waitcnt lgkmcnt(0)
  ds_read_b128 v[32:35], v18 offset:16512
  v_and_b32 v40, v36, v8
  v_and_b32 v41, v36, v9
  v_and_b32 v42, v36, v10
  v_and_b32 v43, v36, v11
  s_nop 1
  v_mfma_f32_16x16x32_bf16 v[52:55], v[40:43], a[96:99], v[52:55]
  v_and_b32 v44, v37, v8
  v_and_b32 v45, v37, v9
  v_and_b32 v46, v37, v10
  v_and_b32 v47, v37, v11
  s_nop 1
  v_mfma_f32_16x16x32_bf16 v[52:55], v[44:47], a[100:103], v[52:55]
  v_and_b32 v40, v38, v8
  v_and_b32 v41, v38, v9
  v_and_b32 v42, v38, v10
  v_and_b32 v43, v38, v11
  s_nop 1
  v_mfma_f32_16x16x32_bf16 v[52:55], v[40:43], a[104:107], v[52:55]
  v_and_b32 v44, v39, v8
  v_and_b32 v45, v39, v9
  v_and_b32 v46, v39, v10
  v_and_b32 v47, v39, v11
  s_nop 1
  v_mfma_f32_16x16x32_bf16 v[52:55], v[44:47], a[108:111], v[52:55]
  s_waitcnt lgkmcnt(0)
  ds_read_b128 v[36:39], v18 offset:24704
  v_and_b32 v40, v32, v8
  v_and_b32 v41, v32, v9
  v_and_b32 v42, v32, v10
  v_and_b32 v43, v32, v11
  s_nop 1
  v_mfma_f32_16x16x32_bf16 v[56:59], v[40:43], a[96:99], v[56:59]
  v_and_b32 v44, v33, v8
  v_and_b32 v45, v33, v9
  v_and_b32 v46, v33, v10
  v_and_b32 v47, v33, v11
  s_nop 1
  v_mfma_f32_16x16x32_bf16 v[56:59], v[44:47], a[100:103], v[56:59]
  v_and_b32 v40, v34, v8
  v_and_b32 v41, v34, v9
  v_and_b32 v42, v34, v10
  v_and_b32 v43, v34, v11
  s_nop 1
  v_mfma_f32_16x16x32_bf16 v[56:59], v[40:43], a[104:107], v[56:59]
  v_and_b32 v44, v35, v8
  v_and_b32 v45, v35, v9
  v_and_b32 v46, v35, v10
  v_and_b32 v47, v35, v11
  s_nop 1
  v_mfma_f32_16x16x32_bf16 v[56:59], v[44:47], a[108:111], v[56:59]
  s_waitcnt lgkmcnt(0)
  ds_read_b128 v[32:35], v18 offset:192
  v_and_b32 v40, v36, v8
  v_and_b32 v41, v36, v9
  v_and_b32 v42, v36, v10
  v_and_b32 v43, v36, v11
  s_nop 1
  v_mfma_f32_16x16x32_bf16 v[60:63], v[40:43], a[96:99], v[60:63]
  v_and_b32 v44, v37, v8
  v_and_b32 v45, v37, v9
  v_and_b32 v46, v37, v10
  v_and_b32 v47, v37, v11
  s_nop 1
  v_mfma_f32_16x16x32_bf16 v[60:63], v[44:47], a[100:103], v[60:63]
  v_and_b32 v40, v38, v8
  v_and_b32 v41, v38, v9
  v_and_b32 v42, v38, v10
  v_and_b32 v43, v38, v11
  s_nop 1
  v_mfma_f32_16x16x32_bf16 v[60:63], v[40:43], a[104:107], v[60:63]
  v_and_b32 v44, v39, v8
  v_and_b32 v45, v39, v9
  v_and_b32 v46, v39, v10
  v_and_b32 v47, v39, v11
  s_nop 1
  v_mfma_f32_16x16x32_bf16 v[60:63], v[44:47], a[108:111], v[60:63]
  s_waitcnt lgkmcnt(0)
  ds_read_b128 v[36:39], v18 offset:8384
  v_and_b32 v40, v32, v8
  v_and_b32 v41, v32, v9
  v_and_b32 v42, v32, v10
  v_and_b32 v43, v32, v11
  s_nop 1
  v_mfma_f32_16x16x32_bf16 v[48:51], v[40:43], a[112:115], v[48:51]
  v_and_b32 v44, v33, v8
  v_and_b32 v45, v33, v9
  v_and_b32 v46, v33, v10
  v_and_b32 v47, v33, v11
  s_nop 1
  v_mfma_f32_16x16x32_bf16 v[48:51], v[44:47], a[116:119], v[48:51]
  v_and_b32 v40, v34, v8
  v_and_b32 v41, v34, v9
  v_and_b32 v42, v34, v10
  v_and_b32 v43, v34, v11
  s_nop 1
  v_mfma_f32_16x16x32_bf16 v[48:51], v[40:43], a[120:123], v[48:51]
  v_and_b32 v44, v35, v8
  v_and_b32 v45, v35, v9
  v_and_b32 v46, v35, v10
  v_and_b32 v47, v35, v11
  s_nop 1
  v_mfma_f32_16x16x32_bf16 v[48:51], v[44:47], a[124:127], v[48:51]
  s_waitcnt lgkmcnt(0)
  ds_read_b128 v[32:35], v18 offset:16576
  v_and_b32 v40, v36, v8
  v_and_b32 v41, v36, v9
  v_and_b32 v42, v36, v10
  v_and_b32 v43, v36, v11
  s_nop 1
  v_mfma_f32_16x16x32_bf16 v[52:55], v[40:43], a[112:115], v[52:55]
  v_and_b32 v44, v37, v8
  v_and_b32 v45, v37, v9
  v_and_b32 v46, v37, v10
  v_and_b32 v47, v37, v11
  s_nop 1
  v_mfma_f32_16x16x32_bf16 v[52:55], v[44:47], a[116:119], v[52:55]
  v_and_b32 v40, v38, v8
  v_and_b32 v41, v38, v9
  v_and_b32 v42, v38, v10
  v_and_b32 v43, v38, v11
  s_nop 1
  v_mfma_f32_16x16x32_bf16 v[52:55], v[40:43], a[120:123], v[52:55]
  v_and_b32 v44, v39, v8
  v_and_b32 v45, v39, v9
  v_and_b32 v46, v39, v10
  v_and_b32 v47, v39, v11
  s_nop 1
  v_mfma_f32_16x16x32_bf16 v[52:55], v[44:47], a[124:127], v[52:55]
  s_waitcnt lgkmcnt(0)
  ds_read_b128 v[36:39], v18 offset:24768
  v_and_b32 v40, v32, v8
  v_and_b32 v41, v32, v9
  v_and_b32 v42, v32, v10
  v_and_b32 v43, v32, v11
  s_nop 1
  v_mfma_f32_16x16x32_bf16 v[56:59], v[40:43], a[112:115], v[56:59]
  v_and_b32 v44, v33, v8
  v_and_b32 v45, v33, v9
  v_and_b32 v46, v33, v10
  v_and_b32 v47, v33, v11
  s_nop 1
  v_mfma_f32_16x16x32_bf16 v[56:59], v[44:47], a[116:119], v[56:59]
  v_and_b32 v40, v34, v8
  v_and_b32 v41, v34, v9
  v_and_b32 v42, v34, v10
  v_and_b32 v43, v34, v11
  s_nop 1
  v_mfma_f32_16x16x32_bf16 v[56:59], v[40:43], a[120:123], v[56:59]
  v_and_b32 v44, v35, v8
  v_and_b32 v45, v35, v9
  v_and_b32 v46, v35, v10
  v_and_b32 v47, v35, v11
  s_nop 1
  v_mfma_f32_16x16x32_bf16 v[56:59], v[44:47], a[124:127], v[56:59]
  s_waitcnt lgkmcnt(0)
  v_and_b32 v40, v36, v8
  v_and_b32 v41, v36, v9
  v_and_b32 v42, v36, v10
  v_and_b32 v43, v36, v11
  s_nop 1
  v_mfma_f32_16x16x32_bf16 v[60:63], v[40:43], a[112:115], v[60:63]
  v_and_b32 v44, v37, v8
  v_and_b32 v45, v37, v9
  v_and_b32 v46, v37, v10
  v_and_b32 v47, v37, v11
  s_nop 1
  v_mfma_f32_16x16x32_bf16 v[60:63], v[44:47], a[116:119], v[60:63]
  v_and_b32 v40, v38, v8
  v_and_b32 v41, v38, v9
  v_and_b32 v42, v38, v10
  v_and_b32 v43, v38, v11
  s_nop 1
  v_mfma_f32_16x16x32_bf16 v[60:63], v[40:43], a[120:123], v[60:63]
  v_and_b32 v44, v39, v8
  v_and_b32 v45, v39, v9
  v_and_b32 v46, v39, v10
  v_and_b32 v47, v39, v11
  s_nop 1
  v_mfma_f32_16x16x32_bf16 v[60:63], v[44:47], a[124:127], v[60:63]
  s_nop 9
  ds_write_b128 v22, v[48:51] offset:32768
  ds_write_b128 v22, v[52:55] offset:33792
  ds_write_b128 v22, v[56:59] offset:34816
  ds_write_b128 v22, v[60:63] offset:35840
  s_waitcnt lgkmcnt(0)
  s_mov_b64 exec, 1
  v_mov_b32 v19, 1
  ds_add_u32 v7, v19 offset:31040
  s_mov_b64 exec, -1
  s_add_u32 s79, s79, 4
L_lspin_23:
  ds_read_b32 v19, v7 offset:31040
  s_waitcnt lgkmcnt(0)
  v_readfirstlane_b32 s72, v19
  s_nop 0
  s_cmp_ge_u32 s72, s79
  s_cbranch_scc1 L_lspin_23_ok
  s_branch L_lspin_23
L_lspin_23_ok:
  ds_read_b128 v[48:51], v23 offset:32768
  ds_read_b128 v[52:55], v23 offset:36864
  ds_read_b128 v[56:59], v23 offset:40960
  ds_read_b128 v[60:63], v23 offset:45056
  s_waitcnt lgkmcnt(0)
  v_add_f32 v48, v48, v52
  v_add_f32 v56, v56, v60
  v_add_f32 v49, v49, v53
  v_add_f32 v57, v57, v61
  v_add_f32 v50, v50, v54
  v_add_f32 v58, v58, v62
  v_add_f32 v51, v51, v55
  v_add_f32 v59, v59, v63
  v_add_f32 v48, v48, v56
  v_add_f32 v49, v49, v57
  v_add_f32 v50, v50, v58
  v_add_f32 v51, v51, v59
  s_lshl_b32 s71, s68, 3
  s_add_u32 s71, s71, s69
  s_lshl_b32 s71, s71, 12
  s_add_u32 s71, s71, 524288
  v_mov_b32 v14, v23
  buffer_store_dwordx4 v[48:51], v14, s[48:51], s71 offen sc1
  s_waitcnt vmcnt(0)
  s_waitcnt lgkmcnt(0)
  s_mov_b64 exec, 1
  v_mov_b32 v19, 1
  ds_add_u32 v7, v19 offset:31040
  s_mov_b64 exec, -1
  s_add_u32 s79, s79, 4
L_lspin_24:
  ds_read_b32 v19, v7 offset:31040
  s_waitcnt lgkmcnt(0)
  v_readfirstlane_b32 s72, v19
  s_nop 0
  s_cmp_ge_u32 s72, s79
  s_cbranch_scc1 L_lspin_24_ok
  s_branch L_lspin_24
L_lspin_24_ok:
  s_cmp_eq_u32 s78, 0
  s_cbranch_scc0 L_sig_25
  s_lshr_b32 s72, s69, 1
  s_lshl_b32 s72, s72, 8
  s_lshl_b32 s73, s68, 4
  s_add_u32 s72, s72, s73
  s_and_b32 s73, s69, 1
  s_lshl_b32 s73, s73, 3
  s_add_u32 s72, s72, s73
  s_add_u32 s72, s72, 3158016
  v_mov_b32 v18, s76
  v_mov_b32 v19, s77
  s_mov_b64 exec, 1
  buffer_store_dwordx2 v[18:19], v7, s[48:51], s72 offen sc1
  s_mov_b64 exec, -1
L_sig_25:
  s_branch L_job_done
L_job_n:
  s_cmp_eq_u32 s78, 0
  s_cbranch_scc0 L_job_done
  s_lshr_b32 s72, s2, 3
  s_sub_u32 s69, s72, 28
  s_and_b32 s68, s2, 7
  s_mov_b32 s56, s22
  s_mov_b32 s57, s23
  s_mov_b32 s58, 2048
  s_mov_b32 s59, 0x00020000
  s_lshl_b32 s72, s69, 9
  buffer_load_dwordx2 v[24:25], v6, s[56:59], s72 offen
  v_min_u32 v14, 27, v1
  v_lshlrev_b32 v14, 3, v14
  s_lshl_b32 s74, s69, 8
  s_add_u32 s74, s74, 3158016
  s_mov_b32 s75, 0
L_spin_27:
  buffer_load_dwordx2 v[16:17], v14, s[48:51], s74 offen sc1
  s_waitcnt vmcnt(0)
  v_cmp_ne_u64 vcc, s[76:77], v[16:17]
  s_add_u32 s75, s75, 1
  s_cmp_ge_u32 s75, 0x4000
  s_cbranch_scc1 L_ok_26
  s_nop 1
  s_cbranch_vccz L_ok_26
  s_sleep 64
  s_branch L_spin_27
L_ok_26:
  s_lshl_b32 s72, s68, 12
  s_lshl_b32 s73, s69, 10
  s_add_u32 s72, s72, s73
  v_lshrrev_b32 v16, 5, v1
  v_and_b32 v17, 31, v1
  v_lshlrev_b32 v17, 4, v17
  v_lshl_add_u32 v17, v16, 12, v17
  s_lshl_b32 s73, s69, 13
  s_lshl_b32 s74, s68, 9
  s_add_u32 s73, s73, s74
  s_add_u32 s71, s73, 524288
  buffer_load_dwordx4 v[64:67], v17, s[48:51], s71 offen sc1
  s_add_u32 s71, s73, 557056
  buffer_load_dwordx4 v[68:71], v17, s[48:51], s71 offen sc1
  s_add_u32 s71, s73, 589824
  buffer_load_dwordx4 v[72:75], v17, s[48:51], s71 offen sc1
  s_add_u32 s71, s73, 622592
  buffer_load_dwordx4 v[76:79], v17, s[48:51], s71 offen sc1
  s_add_u32 s71, s73, 655360
  buffer_load_dwordx4 v[80:83], v17, s[48:51], s71 offen sc1
  s_add_u32 s71, s73, 688128
  buffer_load_dwordx4 v[84:87], v17, s[48:51], s71 offen sc1
  s_add_u32 s71, s73, 720896
  buffer_load_dwordx4 v[88:91], v17, s[48:51], s71 offen sc1
  s_add_u32 s71, s73, 753664
  buffer_load_dwordx4 v[92:95], v17, s[48:51], s71 offen sc1
  s_add_u32 s71, s73, 786432
  buffer_load_dwordx4 v[96:99], v17, s[48:51], s71 offen sc1
  s_add_u32 s71, s73, 819200
  buffer_load_dwordx4 v[100:103], v17, s[48:51], s71 offen sc1
  s_add_u32 s71, s73, 851968
  buffer_load_dwordx4 v[104:107], v17, s[48:51], s71 offen sc1
  s_add_u32 s71, s73, 884736
  buffer_load_dwordx4 v[108:111], v17, s[48:51], s71 offen sc1
  s_add_u32 s71, s73, 917504
  buffer_load_dwordx4 v[112:115], v17, s[48:51], s71 offen sc1
  s_add_u32 s71, s73, 950272
  buffer_load_dwordx4 v[116:119], v17, s[48:51], s71 offen sc1
  v_lshlrev_b32 v32, 16, v24
  v_and_b32 v33, s92, v24
  v_lshlrev_b32 v34, 16, v25
  v_and_b32 v35, s92, v25
  s_waitcnt vmcnt(0)
  v_add_f32 v64, v64, v68
  v_add_f32 v65, v65, v69
  v_add_f32 v66, v66, v70
  v_add_f32 v67, v67, v71
  v_add_f32 v64, v64, v72
  v_add_f32 v65, v65, v73
  v_add_f32 v66, v66, v74
  v_add_f32 v67, v67, v75
  v_add_f32 v64, v64, v76
  v_add_f32 v65, v65, v77
  v_add_f32 v66, v66, v78
  v_add_f32 v67, v67, v79
  v_add_f32 v64, v64, v80
  v_add_f32 v65, v65, v81
  v_add_f32 v66, v66, v82
  v_add_f32 v67, v67, v83
  v_add_f32 v64, v64, v84
  v_add_f32 v65, v65, v85
  v_add_f32 v66, v66, v86
  v_add_f32 v67, v67, v87
  v_add_f32 v64, v64, v88
  v_add_f32 v65, v65, v89
  v_add_f32 v66, v66, v90
  v_add_f32 v67, v67, v91
  v_add_f32 v64, v64, v92
  v_add_f32 v65, v65, v93
  v_add_f32 v66, v66, v94
  v_add_f32 v67, v67, v95
  v_add_f32 v64, v64, v96
  v_add_f32 v65, v65, v97
  v_add_f32 v66, v66, v98
  v_add_f32 v67, v67, v99
  v_add_f32 v64, v64, v100
  v_add_f32 v65, v65, v101
  v_add_f32 v66, v66, v102
  v_add_f32 v67, v67, v103
  v_add_f32 v64, v64, v104
  v_add_f32 v65, v65, v105
  v_add_f32 v66, v66, v106
  v_add_f32 v67, v67, v107
  v_add_f32 v64, v64, v108
  v_add_f32 v65, v65, v109
  v_add_f32 v66, v66, v110
  v_add_f32 v67, v67, v111
  v_add_f32 v64, v64, v112
  v_add_f32 v65, v65, v113
  v_add_f32 v66, v66, v114
  v_add_f32 v67, v67, v115
  v_add_f32 v64, v64, v116
  v_add_f32 v65, v65, v117
  v_add_f32 v66, v66, v118
  v_add_f32 v67, v67, v119
  v_cvt_pk_bf16_f32 v64, v64, v64
  v_lshlrev_b32 v64, 16, v64
  v_add_f32 v64, v64, v32
  v_cvt_pk_bf16_f32 v64, v64, v64
  v_lshlrev_b32 v64, 16, v64
  v_cvt_pk_bf16_f32 v65, v65, v65
  v_lshlrev_b32 v65, 16, v65
  v_add_f32 v65, v65, v33
  v_cvt_pk_bf16_f32 v65, v65, v65
  v_lshlrev_b32 v65, 16, v65
  v_cvt_pk_bf16_f32 v66, v66, v66
  v_lshlrev_b32 v66, 16, v66
  v_add_f32 v66, v66, v34
  v_cvt_pk_bf16_f32 v66, v66, v66
  v_lshlrev_b32 v66, 16, v66
  v_cvt_pk_bf16_f32 v67, v67, v67
  v_lshlrev_b32 v67, 16, v67
  v_add_f32 v67, v67, v35
  v_cvt_pk_bf16_f32 v67, v67, v67
  v_lshlrev_b32 v67, 16, v67
  s_add_u32 s71, s72, 3178496
  buffer_store_dwordx4 v[64:67], v4, s[48:51], s71 offen sc1
  s_lshl_b32 s72, s68, 2
  s_add_u32 s72, s72, s69
  s_lshl_b32 s72, s72, 6
  s_add_u32 s72, s72, 3162112
  s_waitcnt vmcnt(0)
  v_mov_b32 v18, s76
  v_mov_b32 v19, s77
  s_mov_b64 exec, 1
  buffer_store_dwordx2 v[18:19], v7, s[48:51], s72 offen sc1
  s_mov_b64 exec, -1
L_job_done:
L_lspin_28:
  ds_read_b32 v19, v7 offset:31060
  s_waitcnt lgkmcnt(0)
  v_readfirstlane_b32 s72, v19
  s_nop 0
  s_cmp_ge_u32 s72, 1
  s_cbranch_scc1 L_lspin_28_ok
  s_sleep 64
  s_branch L_lspin_28
L_lspin_28_ok:
  s_lshl_b32 s72, s66, 18
  s_lshl_b32 s73, s64, 8
  s_add_u32 s72, s72, s73
  s_add_u32 s40, s12, s72
  s_addc_u32 s41, s13, 0
  s_sub_u32 s42, 0x800000, s72
  s_mov_b32 s71, 0
  buffer_load_dwordx4 a[0:3], v13, s[40:43], s71 offen
  s_mov_b32 s71, 2048
  buffer_load_dwordx4 a[4:7], v13, s[40:43], s71 offen
  s_mov_b32 s71, 4096
  buffer_load_dwordx4 a[8:11], v13, s[40:43], s71 offen
  s_mov_b32 s71, 6144
  buffer_load_dwordx4 a[12:15], v13, s[40:43], s71 offen
  s_mov_b32 s71, 32768
  buffer_load_dwordx4 a[16:19], v13, s[40:43], s71 offen
  s_mov_b32 s71, 34816
  buffer_load_dwordx4 a[20:23], v13, s[40:43], s71 offen
  s_mov_b32 s71, 36864
  buffer_load_dwordx4 a[24:27], v13, s[40:43], s71 offen
  s_mov_b32 s71, 38912
  buffer_load_dwordx4 a[28:31], v13, s[40:43], s71 offen
  s_mov_b32 s71, 65536
  buffer_load_dwordx4 a[32:35], v13, s[40:43], s71 offen
  s_mov_b32 s71, 67584
  buffer_load_dwordx4 a[36:39], v13, s[40:43], s71 offen
  s_mov_b32 s71, 69632
  buffer_load_dwordx4 a[40:43], v13, s[40:43], s71 offen
  s_mov_b32 s71, 71680
  buffer_load_dwordx4 a[44:47], v13, s[40:43], s71 offen
  s_mov_b32 s71, 98304
  buffer_load_dwordx4 a[48:51], v13, s[40:43], s71 offen
  s_mov_b32 s71, 100352
  buffer_load_dwordx4 a[52:55], v13, s[40:43], s71 offen
  s_mov_b32 s71, 102400
  buffer_load_dwordx4 a[56:59], v13, s[40:43], s71 offen
  s_mov_b32 s71, 104448
  buffer_load_dwordx4 a[60:63], v13, s[40:43], s71 offen
  s_mov_b32 s71, 131072
  buffer_load_dwordx4 a[64:67], v13, s[40:43], s71 offen
  s_mov_b32 s71, 133120
  buffer_load_dwordx4 a[68:71], v13, s[40:43], s71 offen
  s_mov_b32 s71, 135168
  buffer_load_dwordx4 a[72:75], v13, s[40:43], s71 offen
  s_mov_b32 s71, 137216
  buffer_load_dwordx4 a[76:79], v13, s[40:43], s71 offen
  s_mov_b32 s71, 163840
  buffer_load_dwordx4 a[80:83], v13, s[40:43], s71 offen
  s_mov_b32 s71, 165888
  buffer_load_dwordx4 a[84:87], v13, s[40:43], s71 offen
  s_mov_b32 s71, 167936
  buffer_load_dwordx4 a[88:91], v13, s[40:43], s71 offen
  s_mov_b32 s71, 169984
  buffer_load_dwordx4 a[92:95], v13, s[40:43], s71 offen
  s_mov_b32 s71, 196608
  buffer_load_dwordx4 a[96:99], v13, s[40:43], s71 offen
  s_mov_b32 s71, 198656
  buffer_load_dwordx4 a[100:103], v13, s[40:43], s71 offen
  s_mov_b32 s71, 200704
  buffer_load_dwordx4 a[104:107], v13, s[40:43], s71 offen
  s_mov_b32 s71, 202752
  buffer_load_dwordx4 a[108:111], v13, s[40:43], s71 offen
  s_mov_b32 s71, 229376
  buffer_load_dwordx4 a[112:115], v13, s[40:43], s71 offen
  s_mov_b32 s71, 231424
  buffer_load_dwordx4 a[116:119], v13, s[40:43], s71 offen
  s_mov_b32 s71, 233472
  buffer_load_dwordx4 a[120:123], v13, s[40:43], s71 offen
  s_mov_b32 s71, 235520
  buffer_load_dwordx4 a[124:127], v13, s[40:43], s71 offen
  s_cmp_eq_u32 s78, 0
  s_cbranch_scc0 L_tail
  v_lshlrev_b32 v14, 2, v3
  s_lshl_b32 s73, s2, 6
  buffer_load_dword v26, v14, s[44:47], s73 offen
  s_lshl_b32 s74, s65, 2
  s_lshr_b32 s72, s66, 3
  s_add_u32 s74, s74, s72
  s_lshl_b32 s74, s74, 6
  s_add_u32 s74, s74, 3162112
  s_waitcnt vmcnt(0)
  v_lshlrev_b32 v24, 16, v26
  v_and_b32 v25, s92, v26
L_lspin_29:
  ds_read_b32 v19, v7 offset:31056
  s_waitcnt lgkmcnt(0)
  v_readfirstlane_b32 s72, v19
  s_nop 0
  s_cmp_ge_u32 s72, 1
  s_cbranch_scc1 L_lspin_29_ok
  s_sleep 64
  s_branch L_lspin_29
L_lspin_29_ok:
  s_mov_b32 s75, 0
L_spin_31:
  buffer_load_dwordx2 v[16:17], v7, s[48:51], s74 offen sc1
  s_waitcnt vmcnt(0)
  v_cmp_ne_u64 vcc, s[76:77], v[16:17]
  s_add_u32 s75, s75, 1
  s_cmp_ge_u32 s75, 0x4000
  s_cbranch_scc1 L_ok_30
  s_nop 1
  s_cbranch_vccz L_ok_30
  s_sleep 64
  s_branch L_spin_31
L_ok_30:
  v_lshlrev_b32 v14, 3, v3
  s_lshl_b32 s72, s2, 7
  s_add_u32 s72, s72, 3178496
  buffer_load_dwordx2 v[26:27], v14, s[48:51], s72 offen sc1
  s_branch L_tail
.section .rodata,"a"
.p2align 6
.amdhsa_kernel parallel_sum__mha_block_cached__mixer_channel_mlp__decode_kernel
  .amdhsa_next_free_vgpr 256
  .amdhsa_next_free_sgpr 102
  .amdhsa_accum_offset 128
  .amdhsa_group_segment_fixed_size 0
  .amdhsa_kernarg_size 104
  .amdhsa_user_sgpr_count 2
  .amdhsa_user_sgpr_kernarg_segment_ptr 1
  .amdhsa_system_sgpr_workgroup_id_x 1
.end_amdhsa_kernel
```
